```python
import torch

def _softmax(x, axis=-1):
    return torch.softmax(x, dim=axis)
def _gelu(x):
    return torch.nn.functional.gelu(x, approximate="tanh")
def _silu(x):
    return torch.nn.functional.silu(x)
def _sigmoid(x):
    return torch.sigmoid(x)
def _layernorm(x, axis=-1, eps=1e-5):
    m = x.mean(dim=axis, keepdim=True)
    v = x.var(dim=axis, keepdim=True, unbiased=False)
    return (x - m) / torch.sqrt(v + eps)
def _scatter_add(tgt, idx, src, axis=0):
    return tgt.clone().index_add_(axis, idx, src)
def _segment_sum(src, seg, n):
    out = torch.zeros((n,) + src.shape[1:], dtype=src.dtype)
    return out.index_add_(0, seg, src)
def _pad(x, pw):
    flat = tuple(v for pair in reversed(pw) for v in pair)
    return torch.nn.functional.pad(x, flat)

kernel_name = 'recurrent_scan__sliding_block_cached__mixer_token_mlp__prompt'

def setup_inputs():

    _w = (lambda a: (lambda t: t.to(torch.bfloat16) if t.is_floating_point() else t)(torch.as_tensor(a)))
    def _A_setup():
        B, Sq, D = 1, 2048, 512
        Hq, Hkv, Sk, Dh = 32, 8, 2048, 128
        assert Hq % Hkv == 0, (Hq, Hkv)
        return {
            "x": _w((lambda *s: torch.randn(*s, dtype=torch.bfloat16) * 0.05)(B, Sq, D)),
            "k_cache": _w((lambda *s: torch.randn(*s, dtype=torch.bfloat16) * 1.6)(B, Hkv, Sk, Dh)),
            "v_cache": _w((lambda *s: torch.randn(*s, dtype=torch.bfloat16) * 0.8)(B, Hkv, Sk, Dh)),
            "wq": _w((lambda *s: torch.randn(*s, dtype=torch.bfloat16) * 1.6)(D, Hq * Dh) * (D ** -0.5)),
            "wo": _w((lambda *s: torch.randn(*s, dtype=torch.bfloat16) * 0.8)(Hq * Dh, D) * ((Hq * Dh) ** -0.5)),
        }
    _A_in = _A_setup()

    def _B_setup():
        B, S, D, F = 1, 2048, 512, 1792
        return {
            "x": _w((lambda *s: torch.randn(*s, dtype=torch.bfloat16) * 0.05)(B, S, D)),
            "w1": _w((lambda *s: torch.randn(*s, dtype=torch.bfloat16) * 1.6)(S, F) * (S ** -0.5)),
            "b1": _w((lambda *s: torch.randn(*s, dtype=torch.bfloat16) * 1.6)(F) * 0.02),
            "w2": _w((lambda *s: torch.randn(*s, dtype=torch.bfloat16) * 0.2)(F, S) * (F ** -0.5)),
            "b2": _w((lambda *s: torch.randn(*s, dtype=torch.bfloat16) * 0.2)(S) * 0.02),
        }
    _B_in = _B_setup()

    return {
        "A_x": _A_in["x"],
        "A_k_cache": _A_in["k_cache"],
        "A_v_cache": _A_in["v_cache"],
        "A_wq": _A_in["wq"],
        "A_wo": _A_in["wo"],
        "B_x": _B_in["x"],
        "B_w1": _B_in["w1"],
        "B_b1": _B_in["b1"],
        "B_w2": _B_in["w2"],
        "B_b2": _B_in["b2"],
    }

def reference(A_x, A_k_cache, A_v_cache, A_wq, A_wo, B_x, B_w1, B_b1, B_w2, B_b2):
    def _A_ref(x, k_cache, v_cache, wq, wo):
        B, Sq, D = x.shape
        Hq, Dh = 32, 128
        Hkv, Sk = k_cache.shape[1], k_cache.shape[2]
        W = min(4096, max(256, Sk // 4))
        rep = Hq // Hkv
        q = (lambda x, *d: x.permute(*d))((x @ wq).reshape(B, Sq, Hq, Dh), 0, 2, 1, 3)
        k = (lambda x, n, axis: torch.repeat_interleave(x, n, dim=axis))(k_cache[:, :, Sk - W:, :], rep, axis=1)
        v = (lambda x, n, axis: torch.repeat_interleave(x, n, dim=axis))(v_cache[:, :, Sk - W:, :], rep, axis=1)
        scores = torch.einsum("bhqd,bhkd->bhqk", q, k) * (Dh ** -0.5)
        p = _softmax(scores, axis=-1)
        o = torch.einsum("bhqk,bhkd->bhqd", p, v)
        return (lambda x, *d: x.permute(*d))(o, 0, 2, 1, 3).reshape(B, Sq, Hq * Dh) @ wo

    def _B_ref(x, w1, b1, w2, b2):
        B, S, D = x.shape
        h = _layernorm(x, axis=-1)
        u = torch.einsum("bsd,sf->bdf", h, w1) + b1
        u = _gelu(u)
        y = torch.einsum("bdf,fs->bds", u, w2) + b2
        return (lambda x, *d: x.permute(*d))(y, 0, 2, 1)

    x = A_x
    xn = _layernorm(x, axis=-1)
    s = _A_ref(xn, A_k_cache, A_v_cache, A_wq, A_wo)
    g = _silu(_B_ref(xn, B_w1, B_b1, B_w2, B_b2))
    return x + s * g
```

```asm
; @launch kernel=main_kernel grid=(480,1,1) block=(512,1,1) lds=163840
; @launch kernel=final_kernel grid=(256,1,1) block=(512,1,1) lds=163840
.amdgcn_target "amdgcn-amd-amdhsa--gfx950"
.text
.globl main_kernel
.p2align 8
.type main_kernel,@function
main_kernel:
    s_cmp_ge_u32 s2, 480
    s_cbranch_scc1 L_main_done
    s_cmp_ge_u32 s2, 256
    s_cbranch_scc1 L_gemm1
    s_load_dwordx2 s[92:93], s[0:1], 88
    s_load_dwordx2 s[58:59], s[0:1], 0
    s_load_dwordx4 s[68:71], s[0:1], 8
    s_load_dwordx4 s[44:47], s[0:1], 24
    s_load_dwordx2 s[4:5], s[0:1], 48
    s_load_dwordx2 s[48:49], s[0:1], 96
    v_and_b32 v1, 63, v0
    v_lshrrev_b32 v252, 6, v0
    s_nop 0
    v_readfirstlane_b32 s34, v252
    s_and_b32 s32, s2, 7
    s_lshr_b32 s33, s2, 3
    s_waitcnt lgkmcnt(0)
    s_add_u32 s8, s48, 2097152
    s_addc_u32 s9, s49, 0
    s_and_b32 s9, s9, 0xffff
    s_mov_b32 s10, 2097152
    s_mov_b32 s11, 0x20000
    s_mov_b32 s12, s68
    s_and_b32 s13, s69, 0xffff
    s_mov_b32 s14, 4194304
    s_mov_b32 s15, 0x20000
    s_mov_b32 s72, s70
    s_and_b32 s73, s71, 0xffff
    s_mov_b32 s74, 4194304
    s_mov_b32 s75, 0x20000
    s_mov_b32 s76, s58
    s_and_b32 s77, s59, 0xffff
    s_mov_b32 s78, 2097152
    s_mov_b32 s79, 0x20000
    s_mov_b32 s96, s92
    s_and_b32 s97, s93, 0xffff
    s_mov_b32 s98, 256
    s_mov_b32 s99, 0x20000
    s_mov_b32 s16, s4
    s_and_b32 s17, s5, 0xffff
    s_mov_b32 s18, 7340032
    s_mov_b32 s19, 0x20000
    s_mov_b32 s20, s44
    s_and_b32 s21, s45, 0xffff
    s_mov_b32 s22, 4194304
    s_mov_b32 s23, 0x20000
    s_mov_b32 s24, s46
    s_and_b32 s25, s47, 0xffff
    s_mov_b32 s26, 4194304
    s_mov_b32 s27, 0x20000
    s_add_u32 s28, s48, 8388608
    s_addc_u32 s29, s49, 0
    s_and_b32 s29, s29, 0xffff
    s_mov_b32 s30, 16777216
    s_mov_b32 s31, 0x20000
    s_lshr_b32 s35, s34, 1
    s_and_b32 s36, s34, 1
    s_mov_b32 s50, 0x3e0293ee
    s_mov_b32 s51, 0x41000000
    v_lshlrev_b32 v26, 4, v1
    s_lshl_b32 s57, s33, 16
    s_lshl_b32 s40, s34, 13
    s_add_u32 s57, s57, s40
    v_lshrrev_b32 v252, 3, v1
    v_and_b32 v253, 7, v1
    v_lshlrev_b32 v254, 4, v253
    v_lshl_add_u32 v254, v252, 10, v254
    buffer_load_dwordx4 v[32:35], v254, s[76:79], s57 offen offset:0
    buffer_load_dwordx4 v[36:39], v254, s[76:79], s57 offen offset:128
    buffer_load_dwordx4 v[40:43], v254, s[76:79], s57 offen offset:256
    buffer_load_dwordx4 v[44:47], v254, s[76:79], s57 offen offset:384
    buffer_load_dwordx4 v[48:51], v254, s[76:79], s57 offen offset:512
    buffer_load_dwordx4 v[52:55], v254, s[76:79], s57 offen offset:640
    buffer_load_dwordx4 v[56:59], v254, s[76:79], s57 offen offset:768
    buffer_load_dwordx4 v[60:63], v254, s[76:79], s57 offen offset:896
    s_lshl_b32 s56, s34, 3
    v_add_u32 v252, s56, v252
    v_bfe_u32 v254, v252, 1, 3
    v_xor_b32 v253, v253, v254
    v_lshlrev_b32 v253, 4, v253
    v_lshl_add_u32 v239, v252, 7, v253
    v_xor_b32 v2, 0, v1
    v_lshlrev_b32 v2, 4, v2
    v_xor_b32 v3, 4, v1
    v_lshlrev_b32 v3, 4, v3
    v_add_u32 v3, 7168, v3
    v_xor_b32 v4, 8, v1
    v_lshlrev_b32 v4, 4, v4
    v_add_u32 v4, 14336, v4
    v_xor_b32 v5, 12, v1
    v_lshlrev_b32 v5, 4, v5
    v_add_u32 v5, 21504, v5
    s_lshl_b32 s39, s36, 3
    v_lshrrev_b32 v252, 4, v1
    v_and_b32 v253, 15, v1
    s_add_u32 s40, s39, 0
    v_add_u32 v254, s40, v252
    v_xor_b32 v254, v253, v254
    v_lshlrev_b32 v254, 4, v254
    v_lshl_add_u32 v6, v252, 8, v254
    s_add_u32 s40, s39, 4
    v_add_u32 v254, s40, v252
    v_xor_b32 v254, v253, v254
    v_lshlrev_b32 v254, 4, v254
    v_lshl_add_u32 v7, v252, 8, v254
    v_lshlrev_b32 v254, 2, v252
    v_xor_b32 v254, v253, v254
    v_lshlrev_b32 v254, 4, v254
    v_lshl_add_u32 v8, v252, 8, v254
    s_lshl_b32 s41, s34, 12
    s_lshl_b32 s42, s34, 11
    s_lshl_b32 s52, s34, 15
    s_lshl_b32 s40, s32, 10
    s_add_u32 s52, s52, s40
    s_lshl_b32 s53, s32, 19
    s_add_u32 s53, s53, s42
    s_add_u32 s53, s53, 393216
    s_lshl_b32 s54, s32, 19
    s_add_u32 s54, s54, s41
    s_add_u32 m0, s41, 65536
    s_add_u32 s40, s52, 0
    buffer_load_dwordx4 v2, s[20:23], s40 offen offset:0 lds
    buffer_load_dwordx4 v3, s[20:23], s40 offen offset:1024 lds
    buffer_load_dwordx4 v4, s[20:23], s40 offen offset:2048 lds
    buffer_load_dwordx4 v5, s[20:23], s40 offen offset:3072 lds
    s_add_u32 m0, s41, 98304
    s_add_u32 s40, s52, 262144
    buffer_load_dwordx4 v2, s[20:23], s40 offen offset:0 lds
    buffer_load_dwordx4 v3, s[20:23], s40 offen offset:1024 lds
    buffer_load_dwordx4 v4, s[20:23], s40 offen offset:2048 lds
    buffer_load_dwordx4 v5, s[20:23], s40 offen offset:3072 lds
    s_lshl_b32 s94, s33, 3
    s_add_u32 s94, s94, s34
    v_and_b32 v252, 15, v1
    v_lshrrev_b32 v253, 3, v252
    v_and_b32 v254, 7, v252
    v_lshlrev_b32 v254, 7, v254
    v_lshl_add_u32 v253, v253, 13, v254
    s_lshl_b32 s94, s94, 14
    s_lshl_b32 s95, s32, 10
    s_add_u32 s94, s94, s95
    buffer_load_dword v248, v253, s[20:23], s94 offen
    s_lshl_b32 s94, s33, 3
    s_add_u32 s94, s94, s34
    v_and_b32 v252, 15, v1
    v_lshlrev_b32 v253, 7, v252
    v_and_b32 v253, 0x180, v253
    s_lshl_b32 s95, s32, 19
    s_lshl_b32 s94, s94, 9
    s_add_u32 s94, s94, s95
    s_add_u32 s94, s94, 393216
    buffer_load_dword v249, v253, s[12:15], s94 offen
    buffer_load_dword v250, v253, s[72:75], s94 offen
    v_lshrrev_b32 v252, 5, v1
    v_lshlrev_b32 v252, 3, v252
    v_bfe_u32 v254, v1, 2, 2
    v_add_u32 v252, v252, v254
    v_lshlrev_b32 v252, 10, v252
    v_bfe_u32 v253, v1, 4, 1
    v_lshlrev_b32 v253, 5, v253
    v_and_b32 v254, 1, v1
    v_lshl_add_u32 v253, v254, 4, v253
    v_bfe_u32 v254, v1, 1, 1
    v_lshl_add_u32 v253, v254, 3, v253
    v_bfe_u32 v254, v1, 2, 2
    v_lshlrev_b32 v254, 6, v254
    s_lshl_b32 s40, s35, 8
    v_add_u32 v255, s40, v253
    v_add_u32 v255, v255, v252
    v_add_u32 v255, v255, v254
    v_xor_b32 v9, 0, v255
    v_xor_b32 v10, 64, v255
    v_xor_b32 v11, 128, v255
    v_xor_b32 v12, 192, v255
    v_and_b32 v252, 31, v1
    v_lshrrev_b32 v253, 5, v1
    v_bfe_u32 v254, v252, 1, 3
    v_xor_b32 v254, v254, v253
    v_lshlrev_b32 v254, 4, v254
    v_lshl_add_u32 v254, v252, 7, v254
    s_lshl_b32 s40, s36, 12
    v_add_u32 v13, s40, v254
    v_and_b32 v252, 19, v1
    v_bfe_u32 v254, v1, 2, 1
    v_lshl_add_u32 v252, v254, 3, v252
    v_bfe_u32 v254, v1, 3, 1
    v_lshl_add_u32 v252, v254, 2, v252
    v_and_b32 v254, 15, v252
    v_xor_b32 v254, v254, v253
    v_lshlrev_b32 v254, 4, v254
    v_lshl_add_u32 v254, v252, 8, v254
    v_xor_b32 v14, 0, v254
    v_xor_b32 v15, 32, v254
    v_xor_b32 v16, 64, v254
    v_xor_b32 v17, 96, v254
    v_xor_b32 v18, 128, v254
    v_xor_b32 v19, 160, v254
    v_xor_b32 v20, 192, v254
    v_xor_b32 v21, 224, v254
    v_lshrrev_b32 v252, 5, v1
    v_lshlrev_b32 v252, 3, v252
    v_bfe_u32 v254, v1, 2, 2
    v_add_u32 v252, v252, v254
    v_lshlrev_b32 v252, 8, v252
    v_bfe_u32 v253, v1, 4, 1
    v_lshlrev_b32 v253, 5, v253
    v_and_b32 v254, 1, v1
    v_lshl_add_u32 v253, v254, 4, v253
    v_bfe_u32 v254, v1, 1, 1
    v_lshl_add_u32 v253, v254, 3, v253
    v_bfe_u32 v254, v1, 2, 2
    v_lshlrev_b32 v254, 6, v254
    v_add_u32 v255, v252, v253
    v_add_u32 v255, v255, v254
    v_xor_b32 v22, 0, v255
    v_xor_b32 v23, 64, v255
    v_xor_b32 v24, 128, v255
    v_xor_b32 v25, 192, v255
    s_mov_b32 s88, 0xffff0000
    s_mov_b32 s89, 0x3b000000
    s_mov_b32 s90, 0x3727c5ac
    s_waitcnt vmcnt(18)
    v_lshlrev_b32 v64, 16, v32
    v_and_b32 v65, s88, v32
    v_lshlrev_b32 v66, 16, v33
    v_and_b32 v67, s88, v33
    v_lshlrev_b32 v68, 16, v34
    v_and_b32 v69, s88, v34
    v_lshlrev_b32 v70, 16, v35
    v_and_b32 v71, s88, v35
    s_waitcnt vmcnt(17)
    v_lshlrev_b32 v72, 16, v36
    v_and_b32 v73, s88, v36
    v_lshlrev_b32 v74, 16, v37
    v_and_b32 v75, s88, v37
    v_lshlrev_b32 v76, 16, v38
    v_and_b32 v77, s88, v38
    v_lshlrev_b32 v78, 16, v39
    v_and_b32 v79, s88, v39
    s_waitcnt vmcnt(16)
    v_lshlrev_b32 v80, 16, v40
    v_and_b32 v81, s88, v40
    v_lshlrev_b32 v82, 16, v41
    v_and_b32 v83, s88, v41
    v_lshlrev_b32 v84, 16, v42
    v_and_b32 v85, s88, v42
    v_lshlrev_b32 v86, 16, v43
    v_and_b32 v87, s88, v43
    s_waitcnt vmcnt(15)
    v_lshlrev_b32 v88, 16, v44
    v_and_b32 v89, s88, v44
    v_lshlrev_b32 v90, 16, v45
    v_and_b32 v91, s88, v45
    v_lshlrev_b32 v92, 16, v46
    v_and_b32 v93, s88, v46
    v_lshlrev_b32 v94, 16, v47
    v_and_b32 v95, s88, v47
    s_waitcnt vmcnt(14)
    v_lshlrev_b32 v96, 16, v48
    v_and_b32 v97, s88, v48
    v_lshlrev_b32 v98, 16, v49
    v_and_b32 v99, s88, v49
    v_lshlrev_b32 v100, 16, v50
    v_and_b32 v101, s88, v50
    v_lshlrev_b32 v102, 16, v51
    v_and_b32 v103, s88, v51
    s_waitcnt vmcnt(13)
    v_lshlrev_b32 v104, 16, v52
    v_and_b32 v105, s88, v52
    v_lshlrev_b32 v106, 16, v53
    v_and_b32 v107, s88, v53
    v_lshlrev_b32 v108, 16, v54
    v_and_b32 v109, s88, v54
    v_lshlrev_b32 v110, 16, v55
    v_and_b32 v111, s88, v55
    s_waitcnt vmcnt(12)
    v_lshlrev_b32 v112, 16, v56
    v_and_b32 v113, s88, v56
    v_lshlrev_b32 v114, 16, v57
    v_and_b32 v115, s88, v57
    v_lshlrev_b32 v116, 16, v58
    v_and_b32 v117, s88, v58
    v_lshlrev_b32 v118, 16, v59
    v_and_b32 v119, s88, v59
    s_waitcnt vmcnt(11)
    v_lshlrev_b32 v120, 16, v60
    v_and_b32 v121, s88, v60
    v_lshlrev_b32 v122, 16, v61
    v_and_b32 v123, s88, v61
    v_lshlrev_b32 v124, 16, v62
    v_and_b32 v125, s88, v62
    v_lshlrev_b32 v126, 16, v63
    v_and_b32 v127, s88, v63
    v_pk_add_f32 v[196:197], v[64:65], v[66:67]
    v_pk_add_f32 v[198:199], v[68:69], v[70:71]
    v_pk_add_f32 v[196:197], v[196:197], v[72:73]
    v_pk_add_f32 v[198:199], v[198:199], v[74:75]
    v_pk_add_f32 v[196:197], v[196:197], v[76:77]
    v_pk_add_f32 v[198:199], v[198:199], v[78:79]
    v_pk_add_f32 v[196:197], v[196:197], v[80:81]
    v_pk_add_f32 v[198:199], v[198:199], v[82:83]
    v_pk_add_f32 v[196:197], v[196:197], v[84:85]
    v_pk_add_f32 v[198:199], v[198:199], v[86:87]
    v_pk_add_f32 v[196:197], v[196:197], v[88:89]
    v_pk_add_f32 v[198:199], v[198:199], v[90:91]
    v_pk_add_f32 v[196:197], v[196:197], v[92:93]
    v_pk_add_f32 v[198:199], v[198:199], v[94:95]
    v_pk_add_f32 v[196:197], v[196:197], v[96:97]
    v_pk_add_f32 v[198:199], v[198:199], v[98:99]
    v_pk_add_f32 v[196:197], v[196:197], v[100:101]
    v_pk_add_f32 v[198:199], v[198:199], v[102:103]
    v_pk_add_f32 v[196:197], v[196:197], v[104:105]
    v_pk_add_f32 v[198:199], v[198:199], v[106:107]
    v_pk_add_f32 v[196:197], v[196:197], v[108:109]
    v_pk_add_f32 v[198:199], v[198:199], v[110:111]
    v_pk_add_f32 v[196:197], v[196:197], v[112:113]
    v_pk_add_f32 v[198:199], v[198:199], v[114:115]
    v_pk_add_f32 v[196:197], v[196:197], v[116:117]
    v_pk_add_f32 v[198:199], v[198:199], v[118:119]
    v_pk_add_f32 v[196:197], v[196:197], v[120:121]
    v_pk_add_f32 v[198:199], v[198:199], v[122:123]
    v_pk_add_f32 v[196:197], v[196:197], v[124:125]
    v_pk_add_f32 v[198:199], v[198:199], v[126:127]
    v_pk_add_f32 v[196:197], v[196:197], v[198:199]
    v_add_f32 v192, v196, v197
    s_nop 1
    v_add_f32_dpp v192, v192, v192 quad_perm:[1,0,3,2] row_mask:0xf bank_mask:0xf
    s_nop 1
    v_add_f32_dpp v192, v192, v192 quad_perm:[2,3,0,1] row_mask:0xf bank_mask:0xf
    s_nop 1
    v_add_f32_dpp v192, v192, v192 row_half_mirror row_mask:0xf bank_mask:0xf
    v_mul_f32 v192, s89, v192
    v_pk_add_f32 v[128:129], v[64:65], v[192:193] op_sel_hi:[1,0] neg_lo:[0,1] neg_hi:[0,1]
    v_pk_add_f32 v[130:131], v[66:67], v[192:193] op_sel_hi:[1,0] neg_lo:[0,1] neg_hi:[0,1]
    v_pk_add_f32 v[132:133], v[68:69], v[192:193] op_sel_hi:[1,0] neg_lo:[0,1] neg_hi:[0,1]
    v_pk_add_f32 v[134:135], v[70:71], v[192:193] op_sel_hi:[1,0] neg_lo:[0,1] neg_hi:[0,1]
    v_pk_add_f32 v[136:137], v[72:73], v[192:193] op_sel_hi:[1,0] neg_lo:[0,1] neg_hi:[0,1]
    v_pk_add_f32 v[138:139], v[74:75], v[192:193] op_sel_hi:[1,0] neg_lo:[0,1] neg_hi:[0,1]
    v_pk_add_f32 v[140:141], v[76:77], v[192:193] op_sel_hi:[1,0] neg_lo:[0,1] neg_hi:[0,1]
    v_pk_add_f32 v[142:143], v[78:79], v[192:193] op_sel_hi:[1,0] neg_lo:[0,1] neg_hi:[0,1]
    v_pk_add_f32 v[144:145], v[80:81], v[192:193] op_sel_hi:[1,0] neg_lo:[0,1] neg_hi:[0,1]
    v_pk_add_f32 v[146:147], v[82:83], v[192:193] op_sel_hi:[1,0] neg_lo:[0,1] neg_hi:[0,1]
    v_pk_add_f32 v[148:149], v[84:85], v[192:193] op_sel_hi:[1,0] neg_lo:[0,1] neg_hi:[0,1]
    v_pk_add_f32 v[150:151], v[86:87], v[192:193] op_sel_hi:[1,0] neg_lo:[0,1] neg_hi:[0,1]
    v_pk_add_f32 v[152:153], v[88:89], v[192:193] op_sel_hi:[1,0] neg_lo:[0,1] neg_hi:[0,1]
    v_pk_add_f32 v[154:155], v[90:91], v[192:193] op_sel_hi:[1,0] neg_lo:[0,1] neg_hi:[0,1]
    v_pk_add_f32 v[156:157], v[92:93], v[192:193] op_sel_hi:[1,0] neg_lo:[0,1] neg_hi:[0,1]
    v_pk_add_f32 v[158:159], v[94:95], v[192:193] op_sel_hi:[1,0] neg_lo:[0,1] neg_hi:[0,1]
    v_pk_add_f32 v[160:161], v[96:97], v[192:193] op_sel_hi:[1,0] neg_lo:[0,1] neg_hi:[0,1]
    v_pk_add_f32 v[162:163], v[98:99], v[192:193] op_sel_hi:[1,0] neg_lo:[0,1] neg_hi:[0,1]
    v_pk_add_f32 v[164:165], v[100:101], v[192:193] op_sel_hi:[1,0] neg_lo:[0,1] neg_hi:[0,1]
    v_pk_add_f32 v[166:167], v[102:103], v[192:193] op_sel_hi:[1,0] neg_lo:[0,1] neg_hi:[0,1]
    v_pk_add_f32 v[168:169], v[104:105], v[192:193] op_sel_hi:[1,0] neg_lo:[0,1] neg_hi:[0,1]
    v_pk_add_f32 v[170:171], v[106:107], v[192:193] op_sel_hi:[1,0] neg_lo:[0,1] neg_hi:[0,1]
    v_pk_add_f32 v[172:173], v[108:109], v[192:193] op_sel_hi:[1,0] neg_lo:[0,1] neg_hi:[0,1]
    v_pk_add_f32 v[174:175], v[110:111], v[192:193] op_sel_hi:[1,0] neg_lo:[0,1] neg_hi:[0,1]
    v_pk_add_f32 v[176:177], v[112:113], v[192:193] op_sel_hi:[1,0] neg_lo:[0,1] neg_hi:[0,1]
    v_pk_add_f32 v[178:179], v[114:115], v[192:193] op_sel_hi:[1,0] neg_lo:[0,1] neg_hi:[0,1]
    v_pk_add_f32 v[180:181], v[116:117], v[192:193] op_sel_hi:[1,0] neg_lo:[0,1] neg_hi:[0,1]
    v_pk_add_f32 v[182:183], v[118:119], v[192:193] op_sel_hi:[1,0] neg_lo:[0,1] neg_hi:[0,1]
    v_pk_add_f32 v[184:185], v[120:121], v[192:193] op_sel_hi:[1,0] neg_lo:[0,1] neg_hi:[0,1]
    v_pk_add_f32 v[186:187], v[122:123], v[192:193] op_sel_hi:[1,0] neg_lo:[0,1] neg_hi:[0,1]
    v_pk_add_f32 v[188:189], v[124:125], v[192:193] op_sel_hi:[1,0] neg_lo:[0,1] neg_hi:[0,1]
    v_pk_add_f32 v[190:191], v[126:127], v[192:193] op_sel_hi:[1,0] neg_lo:[0,1] neg_hi:[0,1]
    v_pk_mul_f32 v[196:197], v[128:129], v[128:129]
    v_pk_mul_f32 v[198:199], v[130:131], v[130:131]
    v_pk_fma_f32 v[196:197], v[132:133], v[132:133], v[196:197]
    v_pk_fma_f32 v[198:199], v[134:135], v[134:135], v[198:199]
    v_pk_fma_f32 v[196:197], v[136:137], v[136:137], v[196:197]
    v_pk_fma_f32 v[198:199], v[138:139], v[138:139], v[198:199]
    v_pk_fma_f32 v[196:197], v[140:141], v[140:141], v[196:197]
    v_pk_fma_f32 v[198:199], v[142:143], v[142:143], v[198:199]
    v_pk_fma_f32 v[196:197], v[144:145], v[144:145], v[196:197]
    v_pk_fma_f32 v[198:199], v[146:147], v[146:147], v[198:199]
    v_pk_fma_f32 v[196:197], v[148:149], v[148:149], v[196:197]
    v_pk_fma_f32 v[198:199], v[150:151], v[150:151], v[198:199]
    v_pk_fma_f32 v[196:197], v[152:153], v[152:153], v[196:197]
    v_pk_fma_f32 v[198:199], v[154:155], v[154:155], v[198:199]
    v_pk_fma_f32 v[196:197], v[156:157], v[156:157], v[196:197]
    v_pk_fma_f32 v[198:199], v[158:159], v[158:159], v[198:199]
    v_pk_fma_f32 v[196:197], v[160:161], v[160:161], v[196:197]
    v_pk_fma_f32 v[198:199], v[162:163], v[162:163], v[198:199]
    v_pk_fma_f32 v[196:197], v[164:165], v[164:165], v[196:197]
    v_pk_fma_f32 v[198:199], v[166:167], v[166:167], v[198:199]
    v_pk_fma_f32 v[196:197], v[168:169], v[168:169], v[196:197]
    v_pk_fma_f32 v[198:199], v[170:171], v[170:171], v[198:199]
    v_pk_fma_f32 v[196:197], v[172:173], v[172:173], v[196:197]
    v_pk_fma_f32 v[198:199], v[174:175], v[174:175], v[198:199]
    v_pk_fma_f32 v[196:197], v[176:177], v[176:177], v[196:197]
    v_pk_fma_f32 v[198:199], v[178:179], v[178:179], v[198:199]
    v_pk_fma_f32 v[196:197], v[180:181], v[180:181], v[196:197]
    v_pk_fma_f32 v[198:199], v[182:183], v[182:183], v[198:199]
    v_pk_fma_f32 v[196:197], v[184:185], v[184:185], v[196:197]
    v_pk_fma_f32 v[198:199], v[186:187], v[186:187], v[198:199]
    v_pk_fma_f32 v[196:197], v[188:189], v[188:189], v[196:197]
    v_pk_fma_f32 v[198:199], v[190:191], v[190:191], v[198:199]
    v_pk_add_f32 v[196:197], v[196:197], v[198:199]
    v_add_f32 v194, v196, v197
    s_nop 1
    v_add_f32_dpp v194, v194, v194 quad_perm:[1,0,3,2] row_mask:0xf bank_mask:0xf
    s_nop 1
    v_add_f32_dpp v194, v194, v194 quad_perm:[2,3,0,1] row_mask:0xf bank_mask:0xf
    s_nop 1
    v_add_f32_dpp v194, v194, v194 row_half_mirror row_mask:0xf bank_mask:0xf
    v_mul_f32 v194, s89, v194
    v_cvt_pk_bf16_f32 v192, v192, v192
    v_lshlrev_b32 v192, 16, v192
    v_cvt_pk_bf16_f32 v194, v194, v194
    v_lshlrev_b32 v194, 16, v194
    v_add_f32 v194, s90, v194
    v_cvt_pk_bf16_f32 v194, v194, v194
    v_lshlrev_b32 v194, 16, v194
    v_sqrt_f32 v194, v194
    s_nop 0
    v_cvt_pk_bf16_f32 v194, v194, v194
    v_lshlrev_b32 v194, 16, v194
    v_rcp_f32 v194, v194
    v_pk_add_f32 v[128:129], v[64:65], v[192:193] op_sel_hi:[1,0] neg_lo:[0,1] neg_hi:[0,1]
    v_pk_add_f32 v[130:131], v[66:67], v[192:193] op_sel_hi:[1,0] neg_lo:[0,1] neg_hi:[0,1]
    v_pk_add_f32 v[132:133], v[68:69], v[192:193] op_sel_hi:[1,0] neg_lo:[0,1] neg_hi:[0,1]
    v_pk_add_f32 v[134:135], v[70:71], v[192:193] op_sel_hi:[1,0] neg_lo:[0,1] neg_hi:[0,1]
    v_cvt_pk_bf16_f32 v64, v128, v129
    v_cvt_pk_bf16_f32 v65, v130, v131
    v_cvt_pk_bf16_f32 v66, v132, v133
    v_cvt_pk_bf16_f32 v67, v134, v135
    v_lshlrev_b32 v128, 16, v64
    v_and_b32 v129, s88, v64
    v_lshlrev_b32 v130, 16, v65
    v_and_b32 v131, s88, v65
    v_lshlrev_b32 v132, 16, v66
    v_and_b32 v133, s88, v66
    v_lshlrev_b32 v134, 16, v67
    v_and_b32 v135, s88, v67
    v_pk_mul_f32 v[128:129], v[128:129], v[194:195] op_sel_hi:[1,0]
    v_pk_mul_f32 v[130:131], v[130:131], v[194:195] op_sel_hi:[1,0]
    v_pk_mul_f32 v[132:133], v[132:133], v[194:195] op_sel_hi:[1,0]
    v_pk_mul_f32 v[134:135], v[134:135], v[194:195] op_sel_hi:[1,0]
    v_cvt_pk_bf16_f32 v32, v128, v129
    v_cvt_pk_bf16_f32 v33, v130, v131
    v_cvt_pk_bf16_f32 v34, v132, v133
    v_cvt_pk_bf16_f32 v35, v134, v135
    ds_write_b128 v239, v[32:35] offset:0
    v_pk_add_f32 v[136:137], v[72:73], v[192:193] op_sel_hi:[1,0] neg_lo:[0,1] neg_hi:[0,1]
    v_pk_add_f32 v[138:139], v[74:75], v[192:193] op_sel_hi:[1,0] neg_lo:[0,1] neg_hi:[0,1]
    v_pk_add_f32 v[140:141], v[76:77], v[192:193] op_sel_hi:[1,0] neg_lo:[0,1] neg_hi:[0,1]
    v_pk_add_f32 v[142:143], v[78:79], v[192:193] op_sel_hi:[1,0] neg_lo:[0,1] neg_hi:[0,1]
    v_cvt_pk_bf16_f32 v72, v136, v137
    v_cvt_pk_bf16_f32 v73, v138, v139
    v_cvt_pk_bf16_f32 v74, v140, v141
    v_cvt_pk_bf16_f32 v75, v142, v143
    v_lshlrev_b32 v136, 16, v72
    v_and_b32 v137, s88, v72
    v_lshlrev_b32 v138, 16, v73
    v_and_b32 v139, s88, v73
    v_lshlrev_b32 v140, 16, v74
    v_and_b32 v141, s88, v74
    v_lshlrev_b32 v142, 16, v75
    v_and_b32 v143, s88, v75
    v_pk_mul_f32 v[136:137], v[136:137], v[194:195] op_sel_hi:[1,0]
    v_pk_mul_f32 v[138:139], v[138:139], v[194:195] op_sel_hi:[1,0]
    v_pk_mul_f32 v[140:141], v[140:141], v[194:195] op_sel_hi:[1,0]
    v_pk_mul_f32 v[142:143], v[142:143], v[194:195] op_sel_hi:[1,0]
    v_cvt_pk_bf16_f32 v36, v136, v137
    v_cvt_pk_bf16_f32 v37, v138, v139
    v_cvt_pk_bf16_f32 v38, v140, v141
    v_cvt_pk_bf16_f32 v39, v142, v143
    ds_write_b128 v239, v[36:39] offset:8192
    v_pk_add_f32 v[144:145], v[80:81], v[192:193] op_sel_hi:[1,0] neg_lo:[0,1] neg_hi:[0,1]
    v_pk_add_f32 v[146:147], v[82:83], v[192:193] op_sel_hi:[1,0] neg_lo:[0,1] neg_hi:[0,1]
    v_pk_add_f32 v[148:149], v[84:85], v[192:193] op_sel_hi:[1,0] neg_lo:[0,1] neg_hi:[0,1]
    v_pk_add_f32 v[150:151], v[86:87], v[192:193] op_sel_hi:[1,0] neg_lo:[0,1] neg_hi:[0,1]
    v_cvt_pk_bf16_f32 v80, v144, v145
    v_cvt_pk_bf16_f32 v81, v146, v147
    v_cvt_pk_bf16_f32 v82, v148, v149
    v_cvt_pk_bf16_f32 v83, v150, v151
    v_lshlrev_b32 v144, 16, v80
    v_and_b32 v145, s88, v80
    v_lshlrev_b32 v146, 16, v81
    v_and_b32 v147, s88, v81
    v_lshlrev_b32 v148, 16, v82
    v_and_b32 v149, s88, v82
    v_lshlrev_b32 v150, 16, v83
    v_and_b32 v151, s88, v83
    v_pk_mul_f32 v[144:145], v[144:145], v[194:195] op_sel_hi:[1,0]
    v_pk_mul_f32 v[146:147], v[146:147], v[194:195] op_sel_hi:[1,0]
    v_pk_mul_f32 v[148:149], v[148:149], v[194:195] op_sel_hi:[1,0]
    v_pk_mul_f32 v[150:151], v[150:151], v[194:195] op_sel_hi:[1,0]
    v_cvt_pk_bf16_f32 v40, v144, v145
    v_cvt_pk_bf16_f32 v41, v146, v147
    v_cvt_pk_bf16_f32 v42, v148, v149
    v_cvt_pk_bf16_f32 v43, v150, v151
    ds_write_b128 v239, v[40:43] offset:16384
    v_pk_add_f32 v[152:153], v[88:89], v[192:193] op_sel_hi:[1,0] neg_lo:[0,1] neg_hi:[0,1]
    v_pk_add_f32 v[154:155], v[90:91], v[192:193] op_sel_hi:[1,0] neg_lo:[0,1] neg_hi:[0,1]
    v_pk_add_f32 v[156:157], v[92:93], v[192:193] op_sel_hi:[1,0] neg_lo:[0,1] neg_hi:[0,1]
    v_pk_add_f32 v[158:159], v[94:95], v[192:193] op_sel_hi:[1,0] neg_lo:[0,1] neg_hi:[0,1]
    v_cvt_pk_bf16_f32 v88, v152, v153
    v_cvt_pk_bf16_f32 v89, v154, v155
    v_cvt_pk_bf16_f32 v90, v156, v157
    v_cvt_pk_bf16_f32 v91, v158, v159
    v_lshlrev_b32 v152, 16, v88
    v_and_b32 v153, s88, v88
    v_lshlrev_b32 v154, 16, v89
    v_and_b32 v155, s88, v89
    v_lshlrev_b32 v156, 16, v90
    v_and_b32 v157, s88, v90
    v_lshlrev_b32 v158, 16, v91
    v_and_b32 v159, s88, v91
    v_pk_mul_f32 v[152:153], v[152:153], v[194:195] op_sel_hi:[1,0]
    v_pk_mul_f32 v[154:155], v[154:155], v[194:195] op_sel_hi:[1,0]
    v_pk_mul_f32 v[156:157], v[156:157], v[194:195] op_sel_hi:[1,0]
    v_pk_mul_f32 v[158:159], v[158:159], v[194:195] op_sel_hi:[1,0]
    v_cvt_pk_bf16_f32 v44, v152, v153
    v_cvt_pk_bf16_f32 v45, v154, v155
    v_cvt_pk_bf16_f32 v46, v156, v157
    v_cvt_pk_bf16_f32 v47, v158, v159
    ds_write_b128 v239, v[44:47] offset:24576
    v_pk_add_f32 v[160:161], v[96:97], v[192:193] op_sel_hi:[1,0] neg_lo:[0,1] neg_hi:[0,1]
    v_pk_add_f32 v[162:163], v[98:99], v[192:193] op_sel_hi:[1,0] neg_lo:[0,1] neg_hi:[0,1]
    v_pk_add_f32 v[164:165], v[100:101], v[192:193] op_sel_hi:[1,0] neg_lo:[0,1] neg_hi:[0,1]
    v_pk_add_f32 v[166:167], v[102:103], v[192:193] op_sel_hi:[1,0] neg_lo:[0,1] neg_hi:[0,1]
    v_cvt_pk_bf16_f32 v96, v160, v161
    v_cvt_pk_bf16_f32 v97, v162, v163
    v_cvt_pk_bf16_f32 v98, v164, v165
    v_cvt_pk_bf16_f32 v99, v166, v167
    v_lshlrev_b32 v160, 16, v96
    v_and_b32 v161, s88, v96
    v_lshlrev_b32 v162, 16, v97
    v_and_b32 v163, s88, v97
    v_lshlrev_b32 v164, 16, v98
    v_and_b32 v165, s88, v98
    v_lshlrev_b32 v166, 16, v99
    v_and_b32 v167, s88, v99
    v_pk_mul_f32 v[160:161], v[160:161], v[194:195] op_sel_hi:[1,0]
    v_pk_mul_f32 v[162:163], v[162:163], v[194:195] op_sel_hi:[1,0]
    v_pk_mul_f32 v[164:165], v[164:165], v[194:195] op_sel_hi:[1,0]
    v_pk_mul_f32 v[166:167], v[166:167], v[194:195] op_sel_hi:[1,0]
    v_cvt_pk_bf16_f32 v48, v160, v161
    v_cvt_pk_bf16_f32 v49, v162, v163
    v_cvt_pk_bf16_f32 v50, v164, v165
    v_cvt_pk_bf16_f32 v51, v166, v167
    ds_write_b128 v239, v[48:51] offset:32768
    v_pk_add_f32 v[168:169], v[104:105], v[192:193] op_sel_hi:[1,0] neg_lo:[0,1] neg_hi:[0,1]
    v_pk_add_f32 v[170:171], v[106:107], v[192:193] op_sel_hi:[1,0] neg_lo:[0,1] neg_hi:[0,1]
    v_pk_add_f32 v[172:173], v[108:109], v[192:193] op_sel_hi:[1,0] neg_lo:[0,1] neg_hi:[0,1]
    v_pk_add_f32 v[174:175], v[110:111], v[192:193] op_sel_hi:[1,0] neg_lo:[0,1] neg_hi:[0,1]
    v_cvt_pk_bf16_f32 v104, v168, v169
    v_cvt_pk_bf16_f32 v105, v170, v171
    v_cvt_pk_bf16_f32 v106, v172, v173
    v_cvt_pk_bf16_f32 v107, v174, v175
    v_lshlrev_b32 v168, 16, v104
    v_and_b32 v169, s88, v104
    v_lshlrev_b32 v170, 16, v105
    v_and_b32 v171, s88, v105
    v_lshlrev_b32 v172, 16, v106
    v_and_b32 v173, s88, v106
    v_lshlrev_b32 v174, 16, v107
    v_and_b32 v175, s88, v107
    v_pk_mul_f32 v[168:169], v[168:169], v[194:195] op_sel_hi:[1,0]
    v_pk_mul_f32 v[170:171], v[170:171], v[194:195] op_sel_hi:[1,0]
    v_pk_mul_f32 v[172:173], v[172:173], v[194:195] op_sel_hi:[1,0]
    v_pk_mul_f32 v[174:175], v[174:175], v[194:195] op_sel_hi:[1,0]
    v_cvt_pk_bf16_f32 v52, v168, v169
    v_cvt_pk_bf16_f32 v53, v170, v171
    v_cvt_pk_bf16_f32 v54, v172, v173
    v_cvt_pk_bf16_f32 v55, v174, v175
    ds_write_b128 v239, v[52:55] offset:40960
    v_pk_add_f32 v[176:177], v[112:113], v[192:193] op_sel_hi:[1,0] neg_lo:[0,1] neg_hi:[0,1]
    v_pk_add_f32 v[178:179], v[114:115], v[192:193] op_sel_hi:[1,0] neg_lo:[0,1] neg_hi:[0,1]
    v_pk_add_f32 v[180:181], v[116:117], v[192:193] op_sel_hi:[1,0] neg_lo:[0,1] neg_hi:[0,1]
    v_pk_add_f32 v[182:183], v[118:119], v[192:193] op_sel_hi:[1,0] neg_lo:[0,1] neg_hi:[0,1]
    v_cvt_pk_bf16_f32 v112, v176, v177
    v_cvt_pk_bf16_f32 v113, v178, v179
    v_cvt_pk_bf16_f32 v114, v180, v181
    v_cvt_pk_bf16_f32 v115, v182, v183
    v_lshlrev_b32 v176, 16, v112
    v_and_b32 v177, s88, v112
    v_lshlrev_b32 v178, 16, v113
    v_and_b32 v179, s88, v113
    v_lshlrev_b32 v180, 16, v114
    v_and_b32 v181, s88, v114
    v_lshlrev_b32 v182, 16, v115
    v_and_b32 v183, s88, v115
    v_pk_mul_f32 v[176:177], v[176:177], v[194:195] op_sel_hi:[1,0]
    v_pk_mul_f32 v[178:179], v[178:179], v[194:195] op_sel_hi:[1,0]
    v_pk_mul_f32 v[180:181], v[180:181], v[194:195] op_sel_hi:[1,0]
    v_pk_mul_f32 v[182:183], v[182:183], v[194:195] op_sel_hi:[1,0]
    v_cvt_pk_bf16_f32 v56, v176, v177
    v_cvt_pk_bf16_f32 v57, v178, v179
    v_cvt_pk_bf16_f32 v58, v180, v181
    v_cvt_pk_bf16_f32 v59, v182, v183
    ds_write_b128 v239, v[56:59] offset:49152
    v_pk_add_f32 v[184:185], v[120:121], v[192:193] op_sel_hi:[1,0] neg_lo:[0,1] neg_hi:[0,1]
    v_pk_add_f32 v[186:187], v[122:123], v[192:193] op_sel_hi:[1,0] neg_lo:[0,1] neg_hi:[0,1]
    v_pk_add_f32 v[188:189], v[124:125], v[192:193] op_sel_hi:[1,0] neg_lo:[0,1] neg_hi:[0,1]
    v_pk_add_f32 v[190:191], v[126:127], v[192:193] op_sel_hi:[1,0] neg_lo:[0,1] neg_hi:[0,1]
    v_cvt_pk_bf16_f32 v120, v184, v185
    v_cvt_pk_bf16_f32 v121, v186, v187
    v_cvt_pk_bf16_f32 v122, v188, v189
    v_cvt_pk_bf16_f32 v123, v190, v191
    v_lshlrev_b32 v184, 16, v120
    v_and_b32 v185, s88, v120
    v_lshlrev_b32 v186, 16, v121
    v_and_b32 v187, s88, v121
    v_lshlrev_b32 v188, 16, v122
    v_and_b32 v189, s88, v122
    v_lshlrev_b32 v190, 16, v123
    v_and_b32 v191, s88, v123
    v_pk_mul_f32 v[184:185], v[184:185], v[194:195] op_sel_hi:[1,0]
    v_pk_mul_f32 v[186:187], v[186:187], v[194:195] op_sel_hi:[1,0]
    v_pk_mul_f32 v[188:189], v[188:189], v[194:195] op_sel_hi:[1,0]
    v_pk_mul_f32 v[190:191], v[190:191], v[194:195] op_sel_hi:[1,0]
    v_cvt_pk_bf16_f32 v60, v184, v185
    v_cvt_pk_bf16_f32 v61, v186, v187
    v_cvt_pk_bf16_f32 v62, v188, v189
    v_cvt_pk_bf16_f32 v63, v190, v191
    ds_write_b128 v239, v[60:63] offset:57344
    s_waitcnt vmcnt(7) lgkmcnt(0)
    s_barrier
    v_add_u32 v240, 65536, v9
    v_add_u32 v241, 65536, v10
    v_add_u32 v242, 65536, v11
    v_add_u32 v243, 65536, v12
    v_xor_b32 v244, 0, v13
    v_xor_b32 v245, 32, v13
    ds_read_b128 v[128:131], v244 offset:0
    ds_read_b64_tr_b16 v[136:137], v240 offset:0
    ds_read_b64_tr_b16 v[138:139], v240 offset:4096
    ds_read_b64_tr_b16 v[140:141], v241 offset:0
    ds_read_b64_tr_b16 v[142:143], v241 offset:4096
    ds_read_b64_tr_b16 v[144:145], v242 offset:0
    ds_read_b64_tr_b16 v[146:147], v242 offset:4096
    ds_read_b64_tr_b16 v[148:149], v243 offset:0
    ds_read_b64_tr_b16 v[150:151], v243 offset:4096
    ds_read_b128 v[132:135], v245 offset:0
    ds_read_b64_tr_b16 v[152:153], v240 offset:16384
    ds_read_b64_tr_b16 v[154:155], v240 offset:20480
    ds_read_b64_tr_b16 v[156:157], v241 offset:16384
    ds_read_b64_tr_b16 v[158:159], v241 offset:20480
    ds_read_b64_tr_b16 v[160:161], v242 offset:16384
    ds_read_b64_tr_b16 v[162:163], v242 offset:20480
    ds_read_b64_tr_b16 v[164:165], v243 offset:16384
    ds_read_b64_tr_b16 v[166:167], v243 offset:20480
    s_add_u32 m0, s41, 131072
    s_add_u32 s40, s52, 524288
    buffer_load_dwordx4 v2, s[20:23], s40 offen offset:0 lds
    buffer_load_dwordx4 v3, s[20:23], s40 offen offset:1024 lds
    buffer_load_dwordx4 v4, s[20:23], s40 offen offset:2048 lds
    buffer_load_dwordx4 v5, s[20:23], s40 offen offset:3072 lds
    s_waitcnt vmcnt(7) lgkmcnt(0)
    s_barrier
    v_add_u32 v240, 98304, v9
    v_add_u32 v241, 98304, v10
    v_add_u32 v242, 98304, v11
    v_add_u32 v243, 98304, v12
    v_xor_b32 v244, 64, v13
    v_xor_b32 v245, 96, v13
    v_mfma_f32_32x32x16_bf16 v[64:79], v[136:139], v[128:131], 0
    ds_read_b128 v[168:171], v244 offset:0
    ds_read_b64_tr_b16 v[176:177], v240 offset:0
    ds_read_b64_tr_b16 v[178:179], v240 offset:4096
    ds_read_b64_tr_b16 v[180:181], v241 offset:0
    ds_read_b64_tr_b16 v[182:183], v241 offset:4096
    ds_read_b64_tr_b16 v[184:185], v242 offset:0
    ds_read_b64_tr_b16 v[186:187], v242 offset:4096
    v_mfma_f32_32x32x16_bf16 v[80:95], v[140:143], v[128:131], 0
    ds_read_b64_tr_b16 v[188:189], v243 offset:0
    ds_read_b64_tr_b16 v[190:191], v243 offset:4096
    ds_read_b128 v[172:175], v245 offset:0
    ds_read_b64_tr_b16 v[192:193], v240 offset:16384
    ds_read_b64_tr_b16 v[194:195], v240 offset:20480
    ds_read_b64_tr_b16 v[196:197], v241 offset:16384
    v_mfma_f32_32x32x16_bf16 v[96:111], v[144:147], v[128:131], 0
    ds_read_b64_tr_b16 v[198:199], v241 offset:20480
    ds_read_b64_tr_b16 v[200:201], v242 offset:16384
    ds_read_b64_tr_b16 v[202:203], v242 offset:20480
    ds_read_b64_tr_b16 v[204:205], v243 offset:16384
    ds_read_b64_tr_b16 v[206:207], v243 offset:20480
    s_add_u32 m0, s41, 65536
    s_add_u32 s40, s52, 786432
    v_mfma_f32_32x32x16_bf16 v[112:127], v[148:151], v[128:131], 0
    buffer_load_dwordx4 v2, s[20:23], s40 offen offset:0 lds
    buffer_load_dwordx4 v3, s[20:23], s40 offen offset:1024 lds
    buffer_load_dwordx4 v4, s[20:23], s40 offen offset:2048 lds
    buffer_load_dwordx4 v5, s[20:23], s40 offen offset:3072 lds
    s_add_u32 s91, s56, s32
    s_bfe_u32 s94, s91, 0x30001
    v_mfma_f32_32x32x16_bf16 v[64:79], v[152:155], v[132:135], v[64:79]
    v_and_b32 v60, 7, v1
    v_xor_b32 v60, s94, v60
    v_lshlrev_b32 v60, 4, v60
    v_lshrrev_b32 v61, 3, v1
    v_lshl_add_u32 v60, v61, 13, v60
    s_lshl_b32 s94, s91, 7
    v_add_u32 v60, s94, v60
    v_mfma_f32_32x32x16_bf16 v[80:95], v[156:159], v[132:135], v[80:95]
    ds_read_b128 v[52:55], v60
    s_waitcnt lgkmcnt(0)
    v_lshlrev_b32 v32, 16, v52
    v_and_b32 v33, s88, v52
    v_lshlrev_b32 v34, 16, v53
    v_and_b32 v35, s88, v53
    v_lshlrev_b32 v36, 16, v54
    v_mfma_f32_32x32x16_bf16 v[96:111], v[160:163], v[132:135], v[96:111]
    v_and_b32 v37, s88, v54
    v_lshlrev_b32 v38, 16, v55
    v_and_b32 v39, s88, v55
    v_add_f32 v48, v32, v33
    v_add_f32 v48, v48, v34
    v_add_f32 v48, v48, v35
    v_add_f32 v48, v48, v36
    v_mfma_f32_32x32x16_bf16 v[112:127], v[164:167], v[132:135], v[112:127]
    v_add_f32 v48, v48, v37
    v_add_f32 v48, v48, v38
    v_add_f32 v48, v48, v39
    s_nop 1
    v_add_f32_dpp v48, v48, v48 quad_perm:[1,0,3,2] row_mask:0xf bank_mask:0xf
    s_nop 1
    v_add_f32_dpp v48, v48, v48 quad_perm:[2,3,0,1] row_mask:0xf bank_mask:0xf
    s_nop 1
    v_add_f32_dpp v48, v48, v48 row_half_mirror row_mask:0xf bank_mask:0xf
    s_waitcnt vmcnt(4) lgkmcnt(0)
    s_barrier
    v_add_u32 v240, 131072, v9
    v_add_u32 v241, 131072, v10
    v_add_u32 v242, 131072, v11
    v_add_u32 v243, 131072, v12
    v_xor_b32 v244, 0, v13
    v_xor_b32 v245, 32, v13
    v_mfma_f32_32x32x16_bf16 v[64:79], v[176:179], v[168:171], v[64:79]
    ds_read_b128 v[128:131], v244 offset:8192
    ds_read_b64_tr_b16 v[136:137], v240 offset:0
    ds_read_b64_tr_b16 v[138:139], v240 offset:4096
    ds_read_b64_tr_b16 v[140:141], v241 offset:0
    ds_read_b64_tr_b16 v[142:143], v241 offset:4096
    ds_read_b64_tr_b16 v[144:145], v242 offset:0
    ds_read_b64_tr_b16 v[146:147], v242 offset:4096
    v_mfma_f32_32x32x16_bf16 v[80:95], v[180:183], v[168:171], v[80:95]
    ds_read_b64_tr_b16 v[148:149], v243 offset:0
    ds_read_b64_tr_b16 v[150:151], v243 offset:4096
    ds_read_b128 v[132:135], v245 offset:8192
    ds_read_b64_tr_b16 v[152:153], v240 offset:16384
    ds_read_b64_tr_b16 v[154:155], v240 offset:20480
    ds_read_b64_tr_b16 v[156:157], v241 offset:16384
    v_mfma_f32_32x32x16_bf16 v[96:111], v[184:187], v[168:171], v[96:111]
    ds_read_b64_tr_b16 v[158:159], v241 offset:20480
    ds_read_b64_tr_b16 v[160:161], v242 offset:16384
    ds_read_b64_tr_b16 v[162:163], v242 offset:20480
    ds_read_b64_tr_b16 v[164:165], v243 offset:16384
    ds_read_b64_tr_b16 v[166:167], v243 offset:20480
    s_add_u32 m0, s41, 98304
    s_add_u32 s40, s52, 1048576
    v_mfma_f32_32x32x16_bf16 v[112:127], v[188:191], v[168:171], v[112:127]
    buffer_load_dwordx4 v2, s[20:23], s40 offen offset:0 lds
    buffer_load_dwordx4 v3, s[20:23], s40 offen offset:1024 lds
    buffer_load_dwordx4 v4, s[20:23], s40 offen offset:2048 lds
    buffer_load_dwordx4 v5, s[20:23], s40 offen offset:3072 lds
    v_add_f32_dpp v48, v48, v48 row_mirror row_mask:0xf bank_mask:0xf
    v_mov_b32 v50, v48
    v_mfma_f32_32x32x16_bf16 v[64:79], v[192:195], v[172:175], v[64:79]
    s_nop 0
    v_permlane16_swap_b32 v48, v50
    v_add_f32 v48, v48, v50
    v_mov_b32 v50, v48
    s_nop 1
    v_permlane32_swap_b32 v48, v50
    v_add_f32 v48, v48, v50
    v_mul_f32 v48, s89, v48
    v_sub_f32 v40, v32, v48
    v_mfma_f32_32x32x16_bf16 v[80:95], v[196:199], v[172:175], v[80:95]
    v_sub_f32 v41, v33, v48
    v_sub_f32 v42, v34, v48
    v_sub_f32 v43, v35, v48
    v_sub_f32 v44, v36, v48
    v_sub_f32 v45, v37, v48
    v_sub_f32 v46, v38, v48
    v_mfma_f32_32x32x16_bf16 v[96:111], v[200:203], v[172:175], v[96:111]
    v_sub_f32 v47, v39, v48
    v_mul_f32 v49, v40, v40
    v_fmac_f32 v49, v41, v41
    v_fmac_f32 v49, v42, v42
    v_fmac_f32 v49, v43, v43
    v_fmac_f32 v49, v44, v44
    v_fmac_f32 v49, v45, v45
    v_mfma_f32_32x32x16_bf16 v[112:127], v[204:207], v[172:175], v[112:127]
    v_fmac_f32 v49, v46, v46
    v_fmac_f32 v49, v47, v47
    s_nop 1
    v_add_f32_dpp v49, v49, v49 quad_perm:[1,0,3,2] row_mask:0xf bank_mask:0xf
    s_nop 1
    v_add_f32_dpp v49, v49, v49 quad_perm:[2,3,0,1] row_mask:0xf bank_mask:0xf
    s_nop 1
    v_add_f32_dpp v49, v49, v49 row_half_mirror row_mask:0xf bank_mask:0xf
    s_nop 1
    v_add_f32_dpp v49, v49, v49 row_mirror row_mask:0xf bank_mask:0xf
    s_waitcnt vmcnt(4) lgkmcnt(0)
    s_barrier
    v_add_u32 v240, 65536, v9
    v_add_u32 v241, 65536, v10
    v_add_u32 v242, 65536, v11
    v_add_u32 v243, 65536, v12
    v_xor_b32 v244, 64, v13
    v_xor_b32 v245, 96, v13
    v_mfma_f32_32x32x16_bf16 v[64:79], v[136:139], v[128:131], v[64:79]
    ds_read_b128 v[168:171], v244 offset:8192
    ds_read_b64_tr_b16 v[176:177], v240 offset:0
    ds_read_b64_tr_b16 v[178:179], v240 offset:4096
    ds_read_b64_tr_b16 v[180:181], v241 offset:0
    ds_read_b64_tr_b16 v[182:183], v241 offset:4096
    ds_read_b64_tr_b16 v[184:185], v242 offset:0
    ds_read_b64_tr_b16 v[186:187], v242 offset:4096
    v_mfma_f32_32x32x16_bf16 v[80:95], v[140:143], v[128:131], v[80:95]
    ds_read_b64_tr_b16 v[188:189], v243 offset:0
    ds_read_b64_tr_b16 v[190:191], v243 offset:4096
    ds_read_b128 v[172:175], v245 offset:8192
    ds_read_b64_tr_b16 v[192:193], v240 offset:16384
    ds_read_b64_tr_b16 v[194:195], v240 offset:20480
    ds_read_b64_tr_b16 v[196:197], v241 offset:16384
    v_mfma_f32_32x32x16_bf16 v[96:111], v[144:147], v[128:131], v[96:111]
    ds_read_b64_tr_b16 v[198:199], v241 offset:20480
    ds_read_b64_tr_b16 v[200:201], v242 offset:16384
    ds_read_b64_tr_b16 v[202:203], v242 offset:20480
    ds_read_b64_tr_b16 v[204:205], v243 offset:16384
    ds_read_b64_tr_b16 v[206:207], v243 offset:20480
    s_add_u32 m0, s41, 131072
    s_add_u32 s40, s52, 1310720
    v_mfma_f32_32x32x16_bf16 v[112:127], v[148:151], v[128:131], v[112:127]
    buffer_load_dwordx4 v2, s[20:23], s40 offen offset:0 lds
    buffer_load_dwordx4 v3, s[20:23], s40 offen offset:1024 lds
    buffer_load_dwordx4 v4, s[20:23], s40 offen offset:2048 lds
    buffer_load_dwordx4 v5, s[20:23], s40 offen offset:3072 lds
    v_mov_b32 v50, v49
    s_nop 1
    v_permlane16_swap_b32 v49, v50
    v_mfma_f32_32x32x16_bf16 v[64:79], v[152:155], v[132:135], v[64:79]
    v_add_f32 v49, v49, v50
    v_mov_b32 v50, v49
    s_nop 1
    v_permlane32_swap_b32 v49, v50
    v_add_f32 v49, v49, v50
    v_mul_f32 v49, s89, v49
    v_cvt_pk_bf16_f32 v48, v48, v48
    v_lshlrev_b32 v48, 16, v48
    v_mfma_f32_32x32x16_bf16 v[80:95], v[156:159], v[132:135], v[80:95]
    v_cvt_pk_bf16_f32 v49, v49, v49
    v_lshlrev_b32 v49, 16, v49
    v_add_f32 v49, s90, v49
    v_cvt_pk_bf16_f32 v49, v49, v49
    v_lshlrev_b32 v49, 16, v49
    v_sqrt_f32 v49, v49
    v_mfma_f32_32x32x16_bf16 v[96:111], v[160:163], v[132:135], v[96:111]
    v_cvt_pk_bf16_f32 v49, v49, v49
    v_lshlrev_b32 v49, 16, v49
    v_rcp_f32 v49, v49
    v_sub_f32 v40, v32, v48
    v_sub_f32 v41, v33, v48
    v_sub_f32 v42, v34, v48
    v_sub_f32 v43, v35, v48
    v_mfma_f32_32x32x16_bf16 v[112:127], v[164:167], v[132:135], v[112:127]
    v_sub_f32 v44, v36, v48
    v_sub_f32 v45, v37, v48
    v_sub_f32 v46, v38, v48
    v_sub_f32 v47, v39, v48
    v_cvt_pk_bf16_f32 v32, v40, v41
    v_cvt_pk_bf16_f32 v33, v42, v43
    s_waitcnt vmcnt(4) lgkmcnt(0)
    s_barrier
    v_add_u32 v240, 98304, v9
    v_add_u32 v241, 98304, v10
    v_add_u32 v242, 98304, v11
    v_add_u32 v243, 98304, v12
    v_xor_b32 v244, 0, v13
    v_xor_b32 v245, 32, v13
    v_mfma_f32_32x32x16_bf16 v[64:79], v[176:179], v[168:171], v[64:79]
    ds_read_b128 v[128:131], v244 offset:16384
    ds_read_b64_tr_b16 v[136:137], v240 offset:0
    ds_read_b64_tr_b16 v[138:139], v240 offset:4096
    ds_read_b64_tr_b16 v[140:141], v241 offset:0
    ds_read_b64_tr_b16 v[142:143], v241 offset:4096
    ds_read_b64_tr_b16 v[144:145], v242 offset:0
    ds_read_b64_tr_b16 v[146:147], v242 offset:4096
    v_mfma_f32_32x32x16_bf16 v[80:95], v[180:183], v[168:171], v[80:95]
    ds_read_b64_tr_b16 v[148:149], v243 offset:0
    ds_read_b64_tr_b16 v[150:151], v243 offset:4096
    ds_read_b128 v[132:135], v245 offset:16384
    ds_read_b64_tr_b16 v[152:153], v240 offset:16384
    ds_read_b64_tr_b16 v[154:155], v240 offset:20480
    ds_read_b64_tr_b16 v[156:157], v241 offset:16384
    v_mfma_f32_32x32x16_bf16 v[96:111], v[184:187], v[168:171], v[96:111]
    ds_read_b64_tr_b16 v[158:159], v241 offset:20480
    ds_read_b64_tr_b16 v[160:161], v242 offset:16384
    ds_read_b64_tr_b16 v[162:163], v242 offset:20480
    ds_read_b64_tr_b16 v[164:165], v243 offset:16384
    ds_read_b64_tr_b16 v[166:167], v243 offset:20480
    s_add_u32 m0, s41, 65536
    v_mfma_f32_32x32x16_bf16 v[112:127], v[188:191], v[168:171], v[112:127]
    s_add_u32 s40, s52, 1572864
    buffer_load_dwordx4 v2, s[20:23], s40 offen offset:0 lds
    buffer_load_dwordx4 v3, s[20:23], s40 offen offset:1024 lds
    buffer_load_dwordx4 v4, s[20:23], s40 offen offset:2048 lds
    buffer_load_dwordx4 v5, s[20:23], s40 offen offset:3072 lds
    v_cvt_pk_bf16_f32 v34, v44, v45
    v_mfma_f32_32x32x16_bf16 v[64:79], v[192:195], v[172:175], v[64:79]
    v_cvt_pk_bf16_f32 v35, v46, v47
    v_lshlrev_b32 v40, 16, v32
    v_and_b32 v41, s88, v32
    v_lshlrev_b32 v42, 16, v33
    v_and_b32 v43, s88, v33
    v_lshlrev_b32 v44, 16, v34
    v_mfma_f32_32x32x16_bf16 v[80:95], v[196:199], v[172:175], v[80:95]
    v_and_b32 v45, s88, v34
    v_lshlrev_b32 v46, 16, v35
    v_and_b32 v47, s88, v35
    v_mul_f32 v40, v40, v49
    v_mul_f32 v41, v41, v49
    v_mul_f32 v42, v42, v49
    v_mfma_f32_32x32x16_bf16 v[96:111], v[200:203], v[172:175], v[96:111]
    v_mul_f32 v43, v43, v49
    v_mul_f32 v44, v44, v49
    v_mul_f32 v45, v45, v49
    v_mul_f32 v46, v46, v49
    v_mul_f32 v47, v47, v49
    v_cvt_pk_bf16_f32 v56, v40, v41
    v_mfma_f32_32x32x16_bf16 v[112:127], v[204:207], v[172:175], v[112:127]
    v_cvt_pk_bf16_f32 v57, v42, v43
    v_cvt_pk_bf16_f32 v58, v44, v45
    v_cvt_pk_bf16_f32 v59, v46, v47
    s_lshl_b32 s94, s32, 10
    s_add_u32 s94, s94, s57
    buffer_store_dwordx4 v[56:59], v26, s[8:11], s94 offen sc1
    s_waitcnt vmcnt(5) lgkmcnt(0)
    s_barrier
    v_add_u32 v240, 131072, v9
    v_add_u32 v241, 131072, v10
    v_add_u32 v242, 131072, v11
    v_add_u32 v243, 131072, v12
    v_xor_b32 v244, 64, v13
    v_xor_b32 v245, 96, v13
    v_mfma_f32_32x32x16_bf16 v[64:79], v[136:139], v[128:131], v[64:79]
    ds_read_b128 v[168:171], v244 offset:16384
    ds_read_b64_tr_b16 v[176:177], v240 offset:0
    ds_read_b64_tr_b16 v[178:179], v240 offset:4096
    v_mfma_f32_32x32x16_bf16 v[80:95], v[140:143], v[128:131], v[80:95]
    ds_read_b64_tr_b16 v[180:181], v241 offset:0
    ds_read_b64_tr_b16 v[182:183], v241 offset:4096
    ds_read_b64_tr_b16 v[184:185], v242 offset:0
    v_mfma_f32_32x32x16_bf16 v[96:111], v[144:147], v[128:131], v[96:111]
    ds_read_b64_tr_b16 v[186:187], v242 offset:4096
    ds_read_b64_tr_b16 v[188:189], v243 offset:0
    ds_read_b64_tr_b16 v[190:191], v243 offset:4096
    v_mfma_f32_32x32x16_bf16 v[112:127], v[148:151], v[128:131], v[112:127]
    ds_read_b128 v[172:175], v245 offset:16384
    ds_read_b64_tr_b16 v[192:193], v240 offset:16384
    ds_read_b64_tr_b16 v[194:195], v240 offset:20480
    v_mfma_f32_32x32x16_bf16 v[64:79], v[152:155], v[132:135], v[64:79]
    ds_read_b64_tr_b16 v[196:197], v241 offset:16384
    ds_read_b64_tr_b16 v[198:199], v241 offset:20480
    ds_read_b64_tr_b16 v[200:201], v242 offset:16384
    v_mfma_f32_32x32x16_bf16 v[80:95], v[156:159], v[132:135], v[80:95]
    ds_read_b64_tr_b16 v[202:203], v242 offset:20480
    ds_read_b64_tr_b16 v[204:205], v243 offset:16384
    ds_read_b64_tr_b16 v[206:207], v243 offset:20480
    v_mfma_f32_32x32x16_bf16 v[96:111], v[160:163], v[132:135], v[96:111]
    s_add_u32 m0, s41, 98304
    s_add_u32 s40, s52, 1835008
    buffer_load_dwordx4 v2, s[20:23], s40 offen offset:0 lds
    v_mfma_f32_32x32x16_bf16 v[112:127], v[164:167], v[132:135], v[112:127]
    buffer_load_dwordx4 v3, s[20:23], s40 offen offset:1024 lds
    buffer_load_dwordx4 v4, s[20:23], s40 offen offset:2048 lds
    buffer_load_dwordx4 v5, s[20:23], s40 offen offset:3072 lds
    s_waitcnt vmcnt(5) lgkmcnt(0)
    s_barrier
    v_add_u32 v240, 65536, v9
    v_add_u32 v241, 65536, v10
    v_add_u32 v242, 65536, v11
    v_add_u32 v243, 65536, v12
    v_xor_b32 v244, 0, v13
    v_xor_b32 v245, 32, v13
    v_mfma_f32_32x32x16_bf16 v[64:79], v[176:179], v[168:171], v[64:79]
    ds_read_b128 v[128:131], v244 offset:24576
    ds_read_b64_tr_b16 v[136:137], v240 offset:0
    ds_read_b64_tr_b16 v[138:139], v240 offset:4096
    v_mfma_f32_32x32x16_bf16 v[80:95], v[180:183], v[168:171], v[80:95]
    ds_read_b64_tr_b16 v[140:141], v241 offset:0
    ds_read_b64_tr_b16 v[142:143], v241 offset:4096
    ds_read_b64_tr_b16 v[144:145], v242 offset:0
    v_mfma_f32_32x32x16_bf16 v[96:111], v[184:187], v[168:171], v[96:111]
    ds_read_b64_tr_b16 v[146:147], v242 offset:4096
    ds_read_b64_tr_b16 v[148:149], v243 offset:0
    ds_read_b64_tr_b16 v[150:151], v243 offset:4096
    v_mfma_f32_32x32x16_bf16 v[112:127], v[188:191], v[168:171], v[112:127]
    ds_read_b128 v[132:135], v245 offset:24576
    ds_read_b64_tr_b16 v[152:153], v240 offset:16384
    ds_read_b64_tr_b16 v[154:155], v240 offset:20480
    v_mfma_f32_32x32x16_bf16 v[64:79], v[192:195], v[172:175], v[64:79]
    ds_read_b64_tr_b16 v[156:157], v241 offset:16384
    ds_read_b64_tr_b16 v[158:159], v241 offset:20480
    ds_read_b64_tr_b16 v[160:161], v242 offset:16384
    v_mfma_f32_32x32x16_bf16 v[80:95], v[196:199], v[172:175], v[80:95]
    ds_read_b64_tr_b16 v[162:163], v242 offset:20480
    ds_read_b64_tr_b16 v[164:165], v243 offset:16384
    ds_read_b64_tr_b16 v[166:167], v243 offset:20480
    v_mfma_f32_32x32x16_bf16 v[96:111], v[200:203], v[172:175], v[96:111]
    s_add_u32 m0, s41, 131072
    s_add_u32 s40, s52, 2097152
    buffer_load_dwordx4 v2, s[20:23], s40 offen offset:0 lds
    v_mfma_f32_32x32x16_bf16 v[112:127], v[204:207], v[172:175], v[112:127]
    buffer_load_dwordx4 v3, s[20:23], s40 offen offset:1024 lds
    buffer_load_dwordx4 v4, s[20:23], s40 offen offset:2048 lds
    buffer_load_dwordx4 v5, s[20:23], s40 offen offset:3072 lds
    s_waitcnt vmcnt(4) lgkmcnt(0)
    s_barrier
    v_add_u32 v240, 98304, v9
    v_add_u32 v241, 98304, v10
    v_add_u32 v242, 98304, v11
    v_add_u32 v243, 98304, v12
    v_xor_b32 v244, 64, v13
    v_xor_b32 v245, 96, v13
    v_mfma_f32_32x32x16_bf16 v[64:79], v[136:139], v[128:131], v[64:79]
    ds_read_b128 v[168:171], v244 offset:24576
    ds_read_b64_tr_b16 v[176:177], v240 offset:0
    ds_read_b64_tr_b16 v[178:179], v240 offset:4096
    v_mfma_f32_32x32x16_bf16 v[80:95], v[140:143], v[128:131], v[80:95]
    ds_read_b64_tr_b16 v[180:181], v241 offset:0
    ds_read_b64_tr_b16 v[182:183], v241 offset:4096
    ds_read_b64_tr_b16 v[184:185], v242 offset:0
    v_mfma_f32_32x32x16_bf16 v[96:111], v[144:147], v[128:131], v[96:111]
    ds_read_b64_tr_b16 v[186:187], v242 offset:4096
    ds_read_b64_tr_b16 v[188:189], v243 offset:0
    ds_read_b64_tr_b16 v[190:191], v243 offset:4096
    v_mfma_f32_32x32x16_bf16 v[112:127], v[148:151], v[128:131], v[112:127]
    ds_read_b128 v[172:175], v245 offset:24576
    ds_read_b64_tr_b16 v[192:193], v240 offset:16384
    ds_read_b64_tr_b16 v[194:195], v240 offset:20480
    v_mfma_f32_32x32x16_bf16 v[64:79], v[152:155], v[132:135], v[64:79]
    ds_read_b64_tr_b16 v[196:197], v241 offset:16384
    ds_read_b64_tr_b16 v[198:199], v241 offset:20480
    ds_read_b64_tr_b16 v[200:201], v242 offset:16384
    v_mfma_f32_32x32x16_bf16 v[80:95], v[156:159], v[132:135], v[80:95]
    ds_read_b64_tr_b16 v[202:203], v242 offset:20480
    ds_read_b64_tr_b16 v[204:205], v243 offset:16384
    ds_read_b64_tr_b16 v[206:207], v243 offset:20480
    v_mfma_f32_32x32x16_bf16 v[96:111], v[160:163], v[132:135], v[96:111]
    s_add_u32 m0, s41, 65536
    s_add_u32 s40, s52, 2359296
    buffer_load_dwordx4 v2, s[20:23], s40 offen offset:0 lds
    v_mfma_f32_32x32x16_bf16 v[112:127], v[164:167], v[132:135], v[112:127]
    buffer_load_dwordx4 v3, s[20:23], s40 offen offset:1024 lds
    buffer_load_dwordx4 v4, s[20:23], s40 offen offset:2048 lds
    buffer_load_dwordx4 v5, s[20:23], s40 offen offset:3072 lds
    s_cmp_lg_u32 s34, 0
    s_cbranch_scc1 L_back_h
    v_mov_b32 v252, 0
    v_mov_b32 v253, 1
    s_mov_b64 exec, 1
    buffer_atomic_add v253, v252, s[96:99], 0 offen sc1
    s_mov_b64 exec, -1
L_back_h:
    s_waitcnt vmcnt(4) lgkmcnt(0)
    s_barrier
    v_add_u32 v240, 131072, v9
    v_add_u32 v241, 131072, v10
    v_add_u32 v242, 131072, v11
    v_add_u32 v243, 131072, v12
    v_xor_b32 v244, 0, v13
    v_xor_b32 v245, 32, v13
    v_mfma_f32_32x32x16_bf16 v[64:79], v[176:179], v[168:171], v[64:79]
    ds_read_b128 v[128:131], v244 offset:32768
    ds_read_b64_tr_b16 v[136:137], v240 offset:0
    ds_read_b64_tr_b16 v[138:139], v240 offset:4096
    v_mfma_f32_32x32x16_bf16 v[80:95], v[180:183], v[168:171], v[80:95]
    ds_read_b64_tr_b16 v[140:141], v241 offset:0
    ds_read_b64_tr_b16 v[142:143], v241 offset:4096
    ds_read_b64_tr_b16 v[144:145], v242 offset:0
    v_mfma_f32_32x32x16_bf16 v[96:111], v[184:187], v[168:171], v[96:111]
    ds_read_b64_tr_b16 v[146:147], v242 offset:4096
    ds_read_b64_tr_b16 v[148:149], v243 offset:0
    ds_read_b64_tr_b16 v[150:151], v243 offset:4096
    v_mfma_f32_32x32x16_bf16 v[112:127], v[188:191], v[168:171], v[112:127]
    ds_read_b128 v[132:135], v245 offset:32768
    ds_read_b64_tr_b16 v[152:153], v240 offset:16384
    ds_read_b64_tr_b16 v[154:155], v240 offset:20480
    v_mfma_f32_32x32x16_bf16 v[64:79], v[192:195], v[172:175], v[64:79]
    ds_read_b64_tr_b16 v[156:157], v241 offset:16384
    ds_read_b64_tr_b16 v[158:159], v241 offset:20480
    ds_read_b64_tr_b16 v[160:161], v242 offset:16384
    v_mfma_f32_32x32x16_bf16 v[80:95], v[196:199], v[172:175], v[80:95]
    ds_read_b64_tr_b16 v[162:163], v242 offset:20480
    ds_read_b64_tr_b16 v[164:165], v243 offset:16384
    ds_read_b64_tr_b16 v[166:167], v243 offset:20480
    v_mfma_f32_32x32x16_bf16 v[96:111], v[200:203], v[172:175], v[96:111]
    s_add_u32 m0, s41, 98304
    s_add_u32 s40, s52, 2621440
    buffer_load_dwordx4 v2, s[20:23], s40 offen offset:0 lds
    v_mfma_f32_32x32x16_bf16 v[112:127], v[204:207], v[172:175], v[112:127]
    buffer_load_dwordx4 v3, s[20:23], s40 offen offset:1024 lds
    buffer_load_dwordx4 v4, s[20:23], s40 offen offset:2048 lds
    buffer_load_dwordx4 v5, s[20:23], s40 offen offset:3072 lds
    s_waitcnt vmcnt(4) lgkmcnt(0)
    s_barrier
    v_add_u32 v240, 65536, v9
    v_add_u32 v241, 65536, v10
    v_add_u32 v242, 65536, v11
    v_add_u32 v243, 65536, v12
    v_xor_b32 v244, 64, v13
    v_xor_b32 v245, 96, v13
    v_mfma_f32_32x32x16_bf16 v[64:79], v[136:139], v[128:131], v[64:79]
    ds_read_b128 v[168:171], v244 offset:32768
    ds_read_b64_tr_b16 v[176:177], v240 offset:0
    ds_read_b64_tr_b16 v[178:179], v240 offset:4096
    v_mfma_f32_32x32x16_bf16 v[80:95], v[140:143], v[128:131], v[80:95]
    ds_read_b64_tr_b16 v[180:181], v241 offset:0
    ds_read_b64_tr_b16 v[182:183], v241 offset:4096
    ds_read_b64_tr_b16 v[184:185], v242 offset:0
    v_mfma_f32_32x32x16_bf16 v[96:111], v[144:147], v[128:131], v[96:111]
    ds_read_b64_tr_b16 v[186:187], v242 offset:4096
    ds_read_b64_tr_b16 v[188:189], v243 offset:0
    ds_read_b64_tr_b16 v[190:191], v243 offset:4096
    v_mfma_f32_32x32x16_bf16 v[112:127], v[148:151], v[128:131], v[112:127]
    ds_read_b128 v[172:175], v245 offset:32768
    ds_read_b64_tr_b16 v[192:193], v240 offset:16384
    ds_read_b64_tr_b16 v[194:195], v240 offset:20480
    v_mfma_f32_32x32x16_bf16 v[64:79], v[152:155], v[132:135], v[64:79]
    ds_read_b64_tr_b16 v[196:197], v241 offset:16384
    ds_read_b64_tr_b16 v[198:199], v241 offset:20480
    ds_read_b64_tr_b16 v[200:201], v242 offset:16384
    v_mfma_f32_32x32x16_bf16 v[80:95], v[156:159], v[132:135], v[80:95]
    ds_read_b64_tr_b16 v[202:203], v242 offset:20480
    ds_read_b64_tr_b16 v[204:205], v243 offset:16384
    ds_read_b64_tr_b16 v[206:207], v243 offset:20480
    v_mfma_f32_32x32x16_bf16 v[96:111], v[160:163], v[132:135], v[96:111]
    s_add_u32 m0, s41, 131072
    s_add_u32 s40, s52, 2883584
    buffer_load_dwordx4 v2, s[20:23], s40 offen offset:0 lds
    v_mfma_f32_32x32x16_bf16 v[112:127], v[164:167], v[132:135], v[112:127]
    buffer_load_dwordx4 v3, s[20:23], s40 offen offset:1024 lds
    buffer_load_dwordx4 v4, s[20:23], s40 offen offset:2048 lds
    buffer_load_dwordx4 v5, s[20:23], s40 offen offset:3072 lds
    s_waitcnt vmcnt(4) lgkmcnt(0)
    s_barrier
    v_add_u32 v240, 98304, v9
    v_add_u32 v241, 98304, v10
    v_add_u32 v242, 98304, v11
    v_add_u32 v243, 98304, v12
    v_xor_b32 v244, 0, v13
    v_xor_b32 v245, 32, v13
    v_mfma_f32_32x32x16_bf16 v[64:79], v[176:179], v[168:171], v[64:79]
    ds_read_b128 v[128:131], v244 offset:40960
    ds_read_b64_tr_b16 v[136:137], v240 offset:0
    ds_read_b64_tr_b16 v[138:139], v240 offset:4096
    v_mfma_f32_32x32x16_bf16 v[80:95], v[180:183], v[168:171], v[80:95]
    ds_read_b64_tr_b16 v[140:141], v241 offset:0
    ds_read_b64_tr_b16 v[142:143], v241 offset:4096
    ds_read_b64_tr_b16 v[144:145], v242 offset:0
    v_mfma_f32_32x32x16_bf16 v[96:111], v[184:187], v[168:171], v[96:111]
    ds_read_b64_tr_b16 v[146:147], v242 offset:4096
    ds_read_b64_tr_b16 v[148:149], v243 offset:0
    ds_read_b64_tr_b16 v[150:151], v243 offset:4096
    v_mfma_f32_32x32x16_bf16 v[112:127], v[188:191], v[168:171], v[112:127]
    ds_read_b128 v[132:135], v245 offset:40960
    ds_read_b64_tr_b16 v[152:153], v240 offset:16384
    ds_read_b64_tr_b16 v[154:155], v240 offset:20480
    v_mfma_f32_32x32x16_bf16 v[64:79], v[192:195], v[172:175], v[64:79]
    ds_read_b64_tr_b16 v[156:157], v241 offset:16384
    ds_read_b64_tr_b16 v[158:159], v241 offset:20480
    ds_read_b64_tr_b16 v[160:161], v242 offset:16384
    v_mfma_f32_32x32x16_bf16 v[80:95], v[196:199], v[172:175], v[80:95]
    ds_read_b64_tr_b16 v[162:163], v242 offset:20480
    ds_read_b64_tr_b16 v[164:165], v243 offset:16384
    ds_read_b64_tr_b16 v[166:167], v243 offset:20480
    v_mfma_f32_32x32x16_bf16 v[96:111], v[200:203], v[172:175], v[96:111]
    s_add_u32 m0, s41, 65536
    s_add_u32 s40, s52, 3145728
    buffer_load_dwordx4 v2, s[20:23], s40 offen offset:0 lds
    v_mfma_f32_32x32x16_bf16 v[112:127], v[204:207], v[172:175], v[112:127]
    buffer_load_dwordx4 v3, s[20:23], s40 offen offset:1024 lds
    buffer_load_dwordx4 v4, s[20:23], s40 offen offset:2048 lds
    buffer_load_dwordx4 v5, s[20:23], s40 offen offset:3072 lds
    s_waitcnt vmcnt(4) lgkmcnt(0)
    s_barrier
    v_add_u32 v240, 131072, v9
    v_add_u32 v241, 131072, v10
    v_add_u32 v242, 131072, v11
    v_add_u32 v243, 131072, v12
    v_xor_b32 v244, 64, v13
    v_xor_b32 v245, 96, v13
    v_mfma_f32_32x32x16_bf16 v[64:79], v[136:139], v[128:131], v[64:79]
    ds_read_b128 v[168:171], v244 offset:40960
    ds_read_b64_tr_b16 v[176:177], v240 offset:0
    ds_read_b64_tr_b16 v[178:179], v240 offset:4096
    v_mfma_f32_32x32x16_bf16 v[80:95], v[140:143], v[128:131], v[80:95]
    ds_read_b64_tr_b16 v[180:181], v241 offset:0
    ds_read_b64_tr_b16 v[182:183], v241 offset:4096
    ds_read_b64_tr_b16 v[184:185], v242 offset:0
    v_mfma_f32_32x32x16_bf16 v[96:111], v[144:147], v[128:131], v[96:111]
    ds_read_b64_tr_b16 v[186:187], v242 offset:4096
    ds_read_b64_tr_b16 v[188:189], v243 offset:0
    ds_read_b64_tr_b16 v[190:191], v243 offset:4096
    v_mfma_f32_32x32x16_bf16 v[112:127], v[148:151], v[128:131], v[112:127]
    ds_read_b128 v[172:175], v245 offset:40960
    ds_read_b64_tr_b16 v[192:193], v240 offset:16384
    ds_read_b64_tr_b16 v[194:195], v240 offset:20480
    v_mfma_f32_32x32x16_bf16 v[64:79], v[152:155], v[132:135], v[64:79]
    ds_read_b64_tr_b16 v[196:197], v241 offset:16384
    ds_read_b64_tr_b16 v[198:199], v241 offset:20480
    ds_read_b64_tr_b16 v[200:201], v242 offset:16384
    v_mfma_f32_32x32x16_bf16 v[80:95], v[156:159], v[132:135], v[80:95]
    ds_read_b64_tr_b16 v[202:203], v242 offset:20480
    ds_read_b64_tr_b16 v[204:205], v243 offset:16384
    ds_read_b64_tr_b16 v[206:207], v243 offset:20480
    v_mfma_f32_32x32x16_bf16 v[96:111], v[160:163], v[132:135], v[96:111]
    s_add_u32 m0, s41, 98304
    s_add_u32 s40, s52, 3407872
    buffer_load_dwordx4 v2, s[20:23], s40 offen offset:0 lds
    v_mfma_f32_32x32x16_bf16 v[112:127], v[164:167], v[132:135], v[112:127]
    buffer_load_dwordx4 v3, s[20:23], s40 offen offset:1024 lds
    buffer_load_dwordx4 v4, s[20:23], s40 offen offset:2048 lds
    buffer_load_dwordx4 v5, s[20:23], s40 offen offset:3072 lds
    s_waitcnt vmcnt(4) lgkmcnt(0)
    s_barrier
    v_add_u32 v240, 65536, v9
    v_add_u32 v241, 65536, v10
    v_add_u32 v242, 65536, v11
    v_add_u32 v243, 65536, v12
    v_xor_b32 v244, 0, v13
    v_xor_b32 v245, 32, v13
    v_mfma_f32_32x32x16_bf16 v[64:79], v[176:179], v[168:171], v[64:79]
    ds_read_b128 v[128:131], v244 offset:49152
    ds_read_b64_tr_b16 v[136:137], v240 offset:0
    ds_read_b64_tr_b16 v[138:139], v240 offset:4096
    v_mfma_f32_32x32x16_bf16 v[80:95], v[180:183], v[168:171], v[80:95]
    ds_read_b64_tr_b16 v[140:141], v241 offset:0
    ds_read_b64_tr_b16 v[142:143], v241 offset:4096
    ds_read_b64_tr_b16 v[144:145], v242 offset:0
    v_mfma_f32_32x32x16_bf16 v[96:111], v[184:187], v[168:171], v[96:111]
    ds_read_b64_tr_b16 v[146:147], v242 offset:4096
    ds_read_b64_tr_b16 v[148:149], v243 offset:0
    ds_read_b64_tr_b16 v[150:151], v243 offset:4096
    v_mfma_f32_32x32x16_bf16 v[112:127], v[188:191], v[168:171], v[112:127]
    ds_read_b128 v[132:135], v245 offset:49152
    ds_read_b64_tr_b16 v[152:153], v240 offset:16384
    ds_read_b64_tr_b16 v[154:155], v240 offset:20480
    v_mfma_f32_32x32x16_bf16 v[64:79], v[192:195], v[172:175], v[64:79]
    ds_read_b64_tr_b16 v[156:157], v241 offset:16384
    ds_read_b64_tr_b16 v[158:159], v241 offset:20480
    ds_read_b64_tr_b16 v[160:161], v242 offset:16384
    v_mfma_f32_32x32x16_bf16 v[80:95], v[196:199], v[172:175], v[80:95]
    ds_read_b64_tr_b16 v[162:163], v242 offset:20480
    ds_read_b64_tr_b16 v[164:165], v243 offset:16384
    ds_read_b64_tr_b16 v[166:167], v243 offset:20480
    v_mfma_f32_32x32x16_bf16 v[96:111], v[200:203], v[172:175], v[96:111]
    s_add_u32 m0, s41, 131072
    s_add_u32 s40, s52, 3670016
    buffer_load_dwordx4 v2, s[20:23], s40 offen offset:0 lds
    v_mfma_f32_32x32x16_bf16 v[112:127], v[204:207], v[172:175], v[112:127]
    buffer_load_dwordx4 v3, s[20:23], s40 offen offset:1024 lds
    buffer_load_dwordx4 v4, s[20:23], s40 offen offset:2048 lds
    buffer_load_dwordx4 v5, s[20:23], s40 offen offset:3072 lds
    s_waitcnt vmcnt(4) lgkmcnt(0)
    s_barrier
    v_add_u32 v240, 98304, v9
    v_add_u32 v241, 98304, v10
    v_add_u32 v242, 98304, v11
    v_add_u32 v243, 98304, v12
    v_xor_b32 v244, 64, v13
    v_xor_b32 v245, 96, v13
    v_mfma_f32_32x32x16_bf16 v[64:79], v[136:139], v[128:131], v[64:79]
    ds_read_b128 v[168:171], v244 offset:49152
    ds_read_b64_tr_b16 v[176:177], v240 offset:0
    ds_read_b64_tr_b16 v[178:179], v240 offset:4096
    v_mfma_f32_32x32x16_bf16 v[80:95], v[140:143], v[128:131], v[80:95]
    ds_read_b64_tr_b16 v[180:181], v241 offset:0
    ds_read_b64_tr_b16 v[182:183], v241 offset:4096
    ds_read_b64_tr_b16 v[184:185], v242 offset:0
    v_mfma_f32_32x32x16_bf16 v[96:111], v[144:147], v[128:131], v[96:111]
    ds_read_b64_tr_b16 v[186:187], v242 offset:4096
    ds_read_b64_tr_b16 v[188:189], v243 offset:0
    ds_read_b64_tr_b16 v[190:191], v243 offset:4096
    v_mfma_f32_32x32x16_bf16 v[112:127], v[148:151], v[128:131], v[112:127]
    ds_read_b128 v[172:175], v245 offset:49152
    ds_read_b64_tr_b16 v[192:193], v240 offset:16384
    ds_read_b64_tr_b16 v[194:195], v240 offset:20480
    v_mfma_f32_32x32x16_bf16 v[64:79], v[152:155], v[132:135], v[64:79]
    ds_read_b64_tr_b16 v[196:197], v241 offset:16384
    ds_read_b64_tr_b16 v[198:199], v241 offset:20480
    ds_read_b64_tr_b16 v[200:201], v242 offset:16384
    v_mfma_f32_32x32x16_bf16 v[80:95], v[156:159], v[132:135], v[80:95]
    ds_read_b64_tr_b16 v[202:203], v242 offset:20480
    ds_read_b64_tr_b16 v[204:205], v243 offset:16384
    ds_read_b64_tr_b16 v[206:207], v243 offset:20480
    v_mfma_f32_32x32x16_bf16 v[96:111], v[160:163], v[132:135], v[96:111]
    s_add_u32 m0, s41, 65536
    s_add_u32 s40, s52, 3932160
    buffer_load_dwordx4 v2, s[20:23], s40 offen offset:0 lds
    v_mfma_f32_32x32x16_bf16 v[112:127], v[164:167], v[132:135], v[112:127]
    buffer_load_dwordx4 v3, s[20:23], s40 offen offset:1024 lds
    buffer_load_dwordx4 v4, s[20:23], s40 offen offset:2048 lds
    buffer_load_dwordx4 v5, s[20:23], s40 offen offset:3072 lds
    s_waitcnt vmcnt(4) lgkmcnt(0)
    s_barrier
    v_add_u32 v240, 131072, v9
    v_add_u32 v241, 131072, v10
    v_add_u32 v242, 131072, v11
    v_add_u32 v243, 131072, v12
    v_xor_b32 v244, 0, v13
    v_xor_b32 v245, 32, v13
    v_mfma_f32_32x32x16_bf16 v[64:79], v[176:179], v[168:171], v[64:79]
    ds_read_b128 v[128:131], v244 offset:57344
    ds_read_b64_tr_b16 v[136:137], v240 offset:0
    ds_read_b64_tr_b16 v[138:139], v240 offset:4096
    v_mfma_f32_32x32x16_bf16 v[80:95], v[180:183], v[168:171], v[80:95]
    ds_read_b64_tr_b16 v[140:141], v241 offset:0
    ds_read_b64_tr_b16 v[142:143], v241 offset:4096
    ds_read_b64_tr_b16 v[144:145], v242 offset:0
    v_mfma_f32_32x32x16_bf16 v[96:111], v[184:187], v[168:171], v[96:111]
    ds_read_b64_tr_b16 v[146:147], v242 offset:4096
    ds_read_b64_tr_b16 v[148:149], v243 offset:0
    ds_read_b64_tr_b16 v[150:151], v243 offset:4096
    v_mfma_f32_32x32x16_bf16 v[112:127], v[188:191], v[168:171], v[112:127]
    ds_read_b128 v[132:135], v245 offset:57344
    ds_read_b64_tr_b16 v[152:153], v240 offset:16384
    v_mfma_f32_32x32x16_bf16 v[64:79], v[192:195], v[172:175], v[64:79]
    ds_read_b64_tr_b16 v[154:155], v240 offset:20480
    ds_read_b64_tr_b16 v[156:157], v241 offset:16384
    ds_read_b64_tr_b16 v[158:159], v241 offset:20480
    v_mfma_f32_32x32x16_bf16 v[80:95], v[196:199], v[172:175], v[80:95]
    ds_read_b64_tr_b16 v[160:161], v242 offset:16384
    ds_read_b64_tr_b16 v[162:163], v242 offset:20480
    ds_read_b64_tr_b16 v[164:165], v243 offset:16384
    v_mfma_f32_32x32x16_bf16 v[96:111], v[200:203], v[172:175], v[96:111]
    ds_read_b64_tr_b16 v[166:167], v243 offset:20480
    s_add_u32 m0, s42, 98304
    s_add_u32 s40, s53, 0
    v_mfma_f32_32x32x16_bf16 v[112:127], v[204:207], v[172:175], v[112:127]
    buffer_load_dwordx4 v6, s[12:15], s40 offen offset:0 lds
    buffer_load_dwordx4 v7, s[12:15], s40 offen offset:1024 lds
    v_xor_b32 v2, 0, v1
    v_lshlrev_b32 v2, 4, v2
    v_xor_b32 v3, 4, v1
    v_lshlrev_b32 v3, 4, v3
    v_xor_b32 v4, 8, v1
    v_lshlrev_b32 v4, 4, v4
    v_xor_b32 v5, 12, v1
    v_lshlrev_b32 v5, 4, v5
    s_waitcnt vmcnt(2) lgkmcnt(0)
    s_barrier
    v_add_u32 v240, 65536, v9
    v_add_u32 v241, 65536, v10
    v_add_u32 v242, 65536, v11
    v_add_u32 v243, 65536, v12
    v_xor_b32 v244, 64, v13
    v_xor_b32 v245, 96, v13
    v_mfma_f32_32x32x16_bf16 v[64:79], v[136:139], v[128:131], v[64:79]
    ds_read_b128 v[168:171], v244 offset:57344
    ds_read_b64_tr_b16 v[176:177], v240 offset:0
    ds_read_b64_tr_b16 v[178:179], v240 offset:4096
    ds_read_b64_tr_b16 v[180:181], v241 offset:0
    v_mfma_f32_32x32x16_bf16 v[80:95], v[140:143], v[128:131], v[80:95]
    ds_read_b64_tr_b16 v[182:183], v241 offset:4096
    ds_read_b64_tr_b16 v[184:185], v242 offset:0
    ds_read_b64_tr_b16 v[186:187], v242 offset:4096
    v_mfma_f32_32x32x16_bf16 v[96:111], v[144:147], v[128:131], v[96:111]
    ds_read_b64_tr_b16 v[188:189], v243 offset:0
    ds_read_b64_tr_b16 v[190:191], v243 offset:4096
    ds_read_b128 v[172:175], v245 offset:57344
    v_mfma_f32_32x32x16_bf16 v[112:127], v[148:151], v[128:131], v[112:127]
    ds_read_b64_tr_b16 v[192:193], v240 offset:16384
    ds_read_b64_tr_b16 v[194:195], v240 offset:20480
    ds_read_b64_tr_b16 v[196:197], v241 offset:16384
    v_mfma_f32_32x32x16_bf16 v[64:79], v[152:155], v[132:135], v[64:79]
    ds_read_b64_tr_b16 v[198:199], v241 offset:20480
    ds_read_b64_tr_b16 v[200:201], v242 offset:16384
    ds_read_b64_tr_b16 v[202:203], v242 offset:20480
    ds_read_b64_tr_b16 v[204:205], v243 offset:16384
    v_mfma_f32_32x32x16_bf16 v[80:95], v[156:159], v[132:135], v[80:95]
    ds_read_b64_tr_b16 v[206:207], v243 offset:20480
    s_add_u32 m0, s42, 131072
    s_add_u32 s40, s53, 16384
    v_mfma_f32_32x32x16_bf16 v[96:111], v[160:163], v[132:135], v[96:111]
    buffer_load_dwordx4 v6, s[12:15], s40 offen offset:0 lds
    buffer_load_dwordx4 v7, s[12:15], s40 offen offset:1024 lds
    s_add_u32 m0, s42, 147456
    v_mfma_f32_32x32x16_bf16 v[112:127], v[164:167], v[132:135], v[112:127]
    s_add_u32 s43, s53, 0
    buffer_load_dwordx4 v8, s[72:75], s43 offen offset:0 lds
    buffer_load_dwordx4 v8, s[72:75], s43 offen offset:1024 lds
    s_waitcnt vmcnt(4) lgkmcnt(0)
    s_barrier
    s_cmp_lt_u32 s34, 4
    s_cbranch_scc1 L_back_pr
    s_setprio 1
L_back_pr:
    v_mfma_f32_32x32x16_bf16 v[64:79], v[176:179], v[168:171], v[64:79]
    v_mfma_f32_32x32x16_bf16 v[80:95], v[180:183], v[168:171], v[80:95]
    v_mfma_f32_32x32x16_bf16 v[96:111], v[184:187], v[168:171], v[96:111]
    v_mfma_f32_32x32x16_bf16 v[112:127], v[188:191], v[168:171], v[112:127]
    v_mfma_f32_32x32x16_bf16 v[64:79], v[192:195], v[172:175], v[64:79]
    v_mfma_f32_32x32x16_bf16 v[80:95], v[196:199], v[172:175], v[80:95]
    v_mfma_f32_32x32x16_bf16 v[96:111], v[200:203], v[172:175], v[96:111]
    v_mfma_f32_32x32x16_bf16 v[112:127], v[204:207], v[172:175], v[112:127]
    v_lshrrev_b32 v252, 5, v1
    v_lshlrev_b32 v252, 3, v252
    v_bfe_u32 v254, v1, 2, 2
    v_add_u32 v252, v252, v254
    v_lshlrev_b32 v252, 10, v252
    v_bfe_u32 v253, v1, 4, 1
    v_lshlrev_b32 v253, 5, v253
    v_and_b32 v254, 1, v1
    v_lshl_add_u32 v253, v254, 4, v253
    v_bfe_u32 v254, v1, 1, 1
    v_lshl_add_u32 v253, v254, 3, v253
    v_bfe_u32 v254, v1, 2, 2
    v_lshlrev_b32 v254, 6, v254
    s_lshl_b32 s40, s34, 7
    v_add_u32 v253, s40, v253
    v_add_u32 v255, 0, v253
    v_xor_b32 v255, v255, v254
    v_add_u32 v9, v255, v252
    v_add_u32 v255, 64, v253
    v_xor_b32 v255, v255, v254
    v_add_u32 v10, v255, v252
    s_lshl_b32 s40, s36, 12
    v_subrev_u32 v11, s40, v13
    v_mul_f32 v64, s50, v64
    v_mul_f32 v65, s50, v65
    v_mul_f32 v66, s50, v66
    v_mul_f32 v67, s50, v67
    v_mul_f32 v68, s50, v68
    v_mul_f32 v69, s50, v69
    v_mul_f32 v70, s50, v70
    v_mul_f32 v71, s50, v71
    v_mul_f32 v72, s50, v72
    v_mul_f32 v73, s50, v73
    v_mul_f32 v74, s50, v74
    v_mul_f32 v75, s50, v75
    v_mul_f32 v76, s50, v76
    v_mul_f32 v77, s50, v77
    v_mul_f32 v78, s50, v78
    v_mul_f32 v79, s50, v79
    v_mul_f32 v80, s50, v80
    v_mul_f32 v81, s50, v81
    v_mul_f32 v82, s50, v82
    v_mul_f32 v83, s50, v83
    v_mul_f32 v84, s50, v84
    v_mul_f32 v85, s50, v85
    v_mul_f32 v86, s50, v86
    v_mul_f32 v87, s50, v87
    v_mul_f32 v88, s50, v88
    v_mul_f32 v89, s50, v89
    v_mul_f32 v90, s50, v90
    v_mul_f32 v91, s50, v91
    v_mul_f32 v92, s50, v92
    v_mul_f32 v93, s50, v93
    v_mul_f32 v94, s50, v94
    v_mul_f32 v95, s50, v95
    v_mul_f32 v96, s50, v96
    v_mul_f32 v97, s50, v97
    v_mul_f32 v98, s50, v98
    v_mul_f32 v99, s50, v99
    v_mul_f32 v100, s50, v100
    v_mul_f32 v101, s50, v101
    v_mul_f32 v102, s50, v102
    v_mul_f32 v103, s50, v103
    v_mul_f32 v104, s50, v104
    v_mul_f32 v105, s50, v105
    v_mul_f32 v106, s50, v106
    v_mul_f32 v107, s50, v107
    v_mul_f32 v108, s50, v108
    v_mul_f32 v109, s50, v109
    v_mul_f32 v110, s50, v110
    v_mul_f32 v111, s50, v111
    v_mul_f32 v112, s50, v112
    v_mul_f32 v113, s50, v113
    v_mul_f32 v114, s50, v114
    v_mul_f32 v115, s50, v115
    v_mul_f32 v116, s50, v116
    v_mul_f32 v117, s50, v117
    v_mul_f32 v118, s50, v118
    v_mul_f32 v119, s50, v119
    v_mul_f32 v120, s50, v120
    v_mul_f32 v121, s50, v121
    v_mul_f32 v122, s50, v122
    v_mul_f32 v123, s50, v123
    v_mul_f32 v124, s50, v124
    v_mul_f32 v125, s50, v125
    v_mul_f32 v126, s50, v126
    v_mul_f32 v127, s50, v127
    v_cvt_pk_bf16_f32 v128, v64, v65
    v_cvt_pk_bf16_f32 v129, v66, v67
    v_cvt_pk_bf16_f32 v130, v68, v69
    v_cvt_pk_bf16_f32 v131, v70, v71
    v_cvt_pk_bf16_f32 v132, v72, v73
    v_cvt_pk_bf16_f32 v133, v74, v75
    v_cvt_pk_bf16_f32 v134, v76, v77
    v_cvt_pk_bf16_f32 v135, v78, v79
    v_cvt_pk_bf16_f32 v136, v80, v81
    v_cvt_pk_bf16_f32 v137, v82, v83
    v_cvt_pk_bf16_f32 v138, v84, v85
    v_cvt_pk_bf16_f32 v139, v86, v87
    v_cvt_pk_bf16_f32 v140, v88, v89
    v_cvt_pk_bf16_f32 v141, v90, v91
    v_cvt_pk_bf16_f32 v142, v92, v93
    v_cvt_pk_bf16_f32 v143, v94, v95
    v_cvt_pk_bf16_f32 v144, v96, v97
    v_cvt_pk_bf16_f32 v145, v98, v99
    v_cvt_pk_bf16_f32 v146, v100, v101
    v_cvt_pk_bf16_f32 v147, v102, v103
    v_cvt_pk_bf16_f32 v148, v104, v105
    v_cvt_pk_bf16_f32 v149, v106, v107
    v_cvt_pk_bf16_f32 v150, v108, v109
    v_cvt_pk_bf16_f32 v151, v110, v111
    v_cvt_pk_bf16_f32 v152, v112, v113
    v_cvt_pk_bf16_f32 v153, v114, v115
    v_cvt_pk_bf16_f32 v154, v116, v117
    v_cvt_pk_bf16_f32 v155, v118, v119
    v_cvt_pk_bf16_f32 v156, v120, v121
    v_cvt_pk_bf16_f32 v157, v122, v123
    v_cvt_pk_bf16_f32 v158, v124, v125
    v_cvt_pk_bf16_f32 v159, v126, v127
    v_add_u32 v240, 98304, v14
    v_add_u32 v241, 98304, v15
    v_add_u32 v242, 98304, v16
    v_add_u32 v243, 98304, v17
    v_add_u32 v244, 98304, v18
    v_add_u32 v245, 98304, v19
    v_add_u32 v246, 98304, v20
    v_add_u32 v247, 98304, v21
    ds_read_b128 v[32:35], v240 offset:0
    ds_read_b128 v[36:39], v241 offset:0
    ds_read_b128 v[40:43], v242 offset:0
    ds_read_b128 v[44:47], v243 offset:0
    ds_read_b128 v[48:51], v244 offset:0
    ds_read_b128 v[52:55], v245 offset:0
    s_waitcnt lgkmcnt(5)
    v_mfma_f32_32x32x16_bf16 v[160:175], v[32:35], v[128:131], 0
    ds_read_b128 v[56:59], v246 offset:0
    s_add_u32 m0, s42, 65536
    s_add_u32 s40, s53, 32768
    s_waitcnt lgkmcnt(5)
    v_mfma_f32_32x32x16_bf16 v[160:175], v[36:39], v[132:135], v[160:175]
    ds_read_b128 v[60:63], v247 offset:0
    buffer_load_dwordx4 v6, s[12:15], s40 offen offset:0 lds
    s_waitcnt lgkmcnt(5)
    v_mfma_f32_32x32x16_bf16 v[160:175], v[40:43], v[136:139], v[160:175]
    ds_read_b128 v[32:35], v240 offset:8192
    buffer_load_dwordx4 v7, s[12:15], s40 offen offset:1024 lds
    s_add_u32 m0, s42, 81920
    s_waitcnt lgkmcnt(5)
    v_mfma_f32_32x32x16_bf16 v[160:175], v[44:47], v[140:143], v[160:175]
    ds_read_b128 v[36:39], v241 offset:8192
    s_add_u32 s43, s53, 16384
    s_waitcnt lgkmcnt(5)
    v_mfma_f32_32x32x16_bf16 v[160:175], v[48:51], v[144:147], v[160:175]
    ds_read_b128 v[40:43], v242 offset:8192
    buffer_load_dwordx4 v8, s[72:75], s43 offen offset:0 lds
    buffer_load_dwordx4 v8, s[72:75], s43 offen offset:1024 lds
    s_waitcnt lgkmcnt(5)
    v_mfma_f32_32x32x16_bf16 v[160:175], v[52:55], v[148:151], v[160:175]
    ds_read_b128 v[44:47], v243 offset:8192
    s_waitcnt lgkmcnt(5)
    v_mfma_f32_32x32x16_bf16 v[160:175], v[56:59], v[152:155], v[160:175]
    ds_read_b128 v[48:51], v244 offset:8192
    s_waitcnt lgkmcnt(5)
    v_mfma_f32_32x32x16_bf16 v[160:175], v[60:63], v[156:159], v[160:175]
    ds_read_b128 v[52:55], v245 offset:8192
    s_waitcnt lgkmcnt(5)
    v_mfma_f32_32x32x16_bf16 v[176:191], v[32:35], v[128:131], 0
    ds_read_b128 v[56:59], v246 offset:8192
    s_waitcnt lgkmcnt(5)
    v_mfma_f32_32x32x16_bf16 v[176:191], v[36:39], v[132:135], v[176:191]
    ds_read_b128 v[60:63], v247 offset:8192
    s_waitcnt lgkmcnt(5)
    v_mfma_f32_32x32x16_bf16 v[176:191], v[40:43], v[136:139], v[176:191]
    s_waitcnt lgkmcnt(4)
    v_mfma_f32_32x32x16_bf16 v[176:191], v[44:47], v[140:143], v[176:191]
    s_waitcnt lgkmcnt(3)
    v_mfma_f32_32x32x16_bf16 v[176:191], v[48:51], v[144:147], v[176:191]
    s_waitcnt lgkmcnt(2)
    v_mfma_f32_32x32x16_bf16 v[176:191], v[52:55], v[148:151], v[176:191]
    s_waitcnt lgkmcnt(1)
    v_mfma_f32_32x32x16_bf16 v[176:191], v[56:59], v[152:155], v[176:191]
    s_waitcnt lgkmcnt(0)
    v_mfma_f32_32x32x16_bf16 v[176:191], v[60:63], v[156:159], v[176:191]
    v_max3_f32 v30, v160, v161, v162
    v_max3_f32 v30, v30, v163, v164
    v_max3_f32 v30, v30, v165, v166
    v_max3_f32 v30, v30, v167, v168
    v_max3_f32 v30, v30, v169, v170
    v_max3_f32 v30, v30, v171, v172
    v_max3_f32 v30, v30, v173, v174
    s_nop 4
    v_max3_f32 v30, v30, v175, v176
    v_max3_f32 v30, v30, v177, v178
    v_max3_f32 v30, v30, v179, v180
    v_max3_f32 v30, v30, v181, v182
    v_max3_f32 v30, v30, v183, v184
    v_max3_f32 v30, v30, v185, v186
    v_max3_f32 v30, v30, v187, v188
    v_max3_f32 v30, v30, v189, v190
    v_max_f32 v30, v30, v191
    s_waitcnt vmcnt(4) lgkmcnt(0)
    s_barrier
    v_add_u32 v240, 131072, v14
    v_add_u32 v241, 131072, v15
    v_add_u32 v242, 131072, v16
    v_add_u32 v243, 131072, v17
    v_add_u32 v244, 131072, v18
    v_add_u32 v245, 131072, v19
    v_add_u32 v246, 131072, v20
    v_add_u32 v247, 131072, v21
    v_add_u32 v248, 131072, v22
    v_add_u32 v249, 131072, v23
    v_add_u32 v250, 131072, v24
    v_add_u32 v251, 131072, v25
    ds_read_b128 v[32:35], v240 offset:0
    ds_read_b128 v[36:39], v241 offset:0
    ds_read_b128 v[40:43], v242 offset:0
    ds_read_b128 v[44:47], v243 offset:0
    ds_read_b128 v[48:51], v244 offset:0
    ds_read_b128 v[52:55], v245 offset:0
    v_mov_b32 v31, v30
    s_nop 1
    v_permlane32_swap_b32 v30, v31
    v_max_f32 v30, v30, v31
    v_sub_f32 v224, 0, v30
    v_sub_f32 v225, 0, v30
    v_sub_f32 v226, 0, v30
    v_sub_f32 v227, 0, v30
    v_sub_f32 v228, 0, v30
    v_sub_f32 v229, 0, v30
    v_sub_f32 v230, 0, v30
    v_sub_f32 v231, 0, v30
    v_sub_f32 v232, 0, v30
    v_sub_f32 v233, 0, v30
    v_sub_f32 v234, 0, v30
    v_sub_f32 v235, 0, v30
    v_sub_f32 v236, 0, v30
    v_sub_f32 v237, 0, v30
    v_sub_f32 v238, 0, v30
    v_sub_f32 v239, 0, v30
    v_mov_b32 v27, 0
    s_waitcnt lgkmcnt(5)
    v_mfma_f32_32x32x16_bf16 v[192:207], v[32:35], v[128:131], v[224:239]
    ds_read_b128 v[56:59], v246 offset:0
    s_add_u32 m0, s42, 98304
    s_add_u32 s40, s53, 49152
    buffer_load_dwordx4 v6, s[12:15], s40 offen offset:0 lds
    buffer_load_dwordx4 v7, s[12:15], s40 offen offset:1024 lds
    s_add_u32 m0, s42, 114688
    s_waitcnt lgkmcnt(5)
    v_mfma_f32_32x32x16_bf16 v[192:207], v[36:39], v[132:135], v[192:207]
    ds_read_b128 v[60:63], v247 offset:0
    s_add_u32 s43, s53, 32768
    buffer_load_dwordx4 v8, s[72:75], s43 offen offset:0 lds
    buffer_load_dwordx4 v8, s[72:75], s43 offen offset:1024 lds
    v_sub_f32 v160, v160, v30
    s_waitcnt lgkmcnt(5)
    v_mfma_f32_32x32x16_bf16 v[192:207], v[40:43], v[136:139], v[192:207]
    ds_read_b128 v[32:35], v240 offset:8192
    v_sub_f32 v161, v161, v30
    v_sub_f32 v162, v162, v30
    v_sub_f32 v163, v163, v30
    v_sub_f32 v164, v164, v30
    s_waitcnt lgkmcnt(5)
    v_mfma_f32_32x32x16_bf16 v[192:207], v[44:47], v[140:143], v[192:207]
    ds_read_b128 v[36:39], v241 offset:8192
    v_sub_f32 v165, v165, v30
    v_sub_f32 v166, v166, v30
    v_sub_f32 v167, v167, v30
    v_sub_f32 v168, v168, v30
    s_waitcnt lgkmcnt(5)
    v_mfma_f32_32x32x16_bf16 v[192:207], v[48:51], v[144:147], v[192:207]
    ds_read_b128 v[40:43], v242 offset:8192
    v_sub_f32 v169, v169, v30
    v_sub_f32 v170, v170, v30
    v_sub_f32 v171, v171, v30
    v_sub_f32 v172, v172, v30
    v_sub_f32 v173, v173, v30
    s_waitcnt lgkmcnt(5)
    v_mfma_f32_32x32x16_bf16 v[192:207], v[52:55], v[148:151], v[192:207]
    ds_read_b128 v[44:47], v243 offset:8192
    v_sub_f32 v174, v174, v30
    v_sub_f32 v175, v175, v30
    v_sub_f32 v176, v176, v30
    v_sub_f32 v177, v177, v30
    s_waitcnt lgkmcnt(5)
    v_mfma_f32_32x32x16_bf16 v[192:207], v[56:59], v[152:155], v[192:207]
    ds_read_b128 v[48:51], v244 offset:8192
    v_sub_f32 v178, v178, v30
    v_sub_f32 v179, v179, v30
    v_sub_f32 v180, v180, v30
    v_sub_f32 v181, v181, v30
    s_waitcnt lgkmcnt(5)
    v_mfma_f32_32x32x16_bf16 v[192:207], v[60:63], v[156:159], v[192:207]
    ds_read_b128 v[52:55], v245 offset:8192
    v_sub_f32 v182, v182, v30
    v_sub_f32 v183, v183, v30
    v_sub_f32 v184, v184, v30
    v_sub_f32 v185, v185, v30
    s_waitcnt lgkmcnt(5)
    v_mfma_f32_32x32x16_bf16 v[208:223], v[32:35], v[128:131], v[224:239]
    ds_read_b128 v[56:59], v246 offset:8192
    v_sub_f32 v186, v186, v30
    v_sub_f32 v187, v187, v30
    v_sub_f32 v188, v188, v30
    v_sub_f32 v189, v189, v30
    v_sub_f32 v190, v190, v30
    s_waitcnt lgkmcnt(5)
    v_mfma_f32_32x32x16_bf16 v[208:223], v[36:39], v[132:135], v[208:223]
    ds_read_b128 v[60:63], v247 offset:8192
    v_sub_f32 v191, v191, v30
    v_exp_f32 v160, v160
    v_exp_f32 v161, v161
    v_exp_f32 v162, v162
    s_waitcnt lgkmcnt(5)
    v_mfma_f32_32x32x16_bf16 v[208:223], v[40:43], v[136:139], v[208:223]
    ds_read_b64_tr_b16 v[32:33], v248 offset:16384
    ds_read_b64_tr_b16 v[34:35], v248 offset:17408
    v_exp_f32 v163, v163
    v_exp_f32 v164, v164
    v_exp_f32 v165, v165
    v_exp_f32 v166, v166
    s_waitcnt lgkmcnt(6)
    v_mfma_f32_32x32x16_bf16 v[208:223], v[44:47], v[140:143], v[208:223]
    ds_read_b64_tr_b16 v[36:37], v249 offset:16384
    ds_read_b64_tr_b16 v[38:39], v249 offset:17408
    v_exp_f32 v167, v167
    v_add_f32 v27, v27, v160
    v_add_f32 v27, v27, v161
    v_add_f32 v27, v27, v162
    s_waitcnt lgkmcnt(7)
    v_mfma_f32_32x32x16_bf16 v[208:223], v[48:51], v[144:147], v[208:223]
    ds_read_b64_tr_b16 v[40:41], v250 offset:16384
    ds_read_b64_tr_b16 v[42:43], v250 offset:17408
    v_add_f32 v27, v27, v163
    v_add_f32 v27, v27, v164
    v_add_f32 v27, v27, v165
    v_add_f32 v27, v27, v166
    v_add_f32 v27, v27, v167
    s_waitcnt lgkmcnt(8)
    v_mfma_f32_32x32x16_bf16 v[208:223], v[52:55], v[148:151], v[208:223]
    ds_read_b64_tr_b16 v[44:45], v251 offset:16384
    ds_read_b64_tr_b16 v[46:47], v251 offset:17408
    v_cvt_pk_bf16_f32 v160, v160, v161
    v_cvt_pk_bf16_f32 v161, v162, v163
    v_cvt_pk_bf16_f32 v162, v164, v165
    v_cvt_pk_bf16_f32 v163, v166, v167
    s_waitcnt lgkmcnt(9)
    v_mfma_f32_32x32x16_bf16 v[208:223], v[56:59], v[152:155], v[208:223]
    ds_read_b64_tr_b16 v[48:49], v248 offset:20480
    ds_read_b64_tr_b16 v[50:51], v248 offset:21504
    v_exp_f32 v168, v168
    v_exp_f32 v169, v169
    v_exp_f32 v170, v170
    v_exp_f32 v171, v171
    s_waitcnt lgkmcnt(10)
    v_mfma_f32_32x32x16_bf16 v[208:223], v[60:63], v[156:159], v[208:223]
    ds_read_b64_tr_b16 v[52:53], v249 offset:20480
    ds_read_b64_tr_b16 v[54:55], v249 offset:21504
    v_exp_f32 v172, v172
    v_exp_f32 v173, v173
    v_exp_f32 v174, v174
    v_exp_f32 v175, v175
    s_waitcnt lgkmcnt(10)
    v_mfma_f32_32x32x16_bf16 v[64:79], v[32:35], v[160:163], 0
    ds_read_b64_tr_b16 v[56:57], v250 offset:20480
    ds_read_b64_tr_b16 v[58:59], v250 offset:21504
    v_add_f32 v27, v27, v168
    v_add_f32 v27, v27, v169
    v_add_f32 v27, v27, v170
    v_add_f32 v27, v27, v171
    v_add_f32 v27, v27, v172
    s_waitcnt lgkmcnt(10)
    v_mfma_f32_32x32x16_bf16 v[80:95], v[36:39], v[160:163], 0
    ds_read_b64_tr_b16 v[60:61], v251 offset:20480
    ds_read_b64_tr_b16 v[62:63], v251 offset:21504
    v_add_f32 v27, v27, v173
    v_add_f32 v27, v27, v174
    v_add_f32 v27, v27, v175
    v_cvt_pk_bf16_f32 v168, v168, v169
    s_waitcnt lgkmcnt(10)
    v_mfma_f32_32x32x16_bf16 v[96:111], v[40:43], v[160:163], 0
    ds_read_b64_tr_b16 v[32:33], v248 offset:24576
    ds_read_b64_tr_b16 v[34:35], v248 offset:25600
    v_cvt_pk_bf16_f32 v169, v170, v171
    v_cvt_pk_bf16_f32 v170, v172, v173
    v_cvt_pk_bf16_f32 v171, v174, v175
    v_exp_f32 v176, v176
    s_waitcnt lgkmcnt(10)
    v_mfma_f32_32x32x16_bf16 v[112:127], v[44:47], v[160:163], 0
    ds_read_b64_tr_b16 v[36:37], v249 offset:24576
    ds_read_b64_tr_b16 v[38:39], v249 offset:25600
    v_exp_f32 v177, v177
    v_exp_f32 v178, v178
    v_exp_f32 v179, v179
    v_exp_f32 v180, v180
    s_waitcnt lgkmcnt(10)
    v_mfma_f32_32x32x16_bf16 v[64:79], v[48:51], v[168:171], v[64:79]
    ds_read_b64_tr_b16 v[40:41], v250 offset:24576
    ds_read_b64_tr_b16 v[42:43], v250 offset:25600
    v_exp_f32 v181, v181
    v_exp_f32 v182, v182
    v_exp_f32 v183, v183
    v_add_f32 v27, v27, v176
    v_add_f32 v27, v27, v177
    s_waitcnt lgkmcnt(10)
    v_mfma_f32_32x32x16_bf16 v[80:95], v[52:55], v[168:171], v[80:95]
    ds_read_b64_tr_b16 v[44:45], v251 offset:24576
    ds_read_b64_tr_b16 v[46:47], v251 offset:25600
    v_add_f32 v27, v27, v178
    v_add_f32 v27, v27, v179
    v_add_f32 v27, v27, v180
    v_add_f32 v27, v27, v181
    s_waitcnt lgkmcnt(10)
    v_mfma_f32_32x32x16_bf16 v[96:111], v[56:59], v[168:171], v[96:111]
    ds_read_b64_tr_b16 v[48:49], v248 offset:28672
    ds_read_b64_tr_b16 v[50:51], v248 offset:29696
    v_add_f32 v27, v27, v182
    v_add_f32 v27, v27, v183
    v_cvt_pk_bf16_f32 v176, v176, v177
    v_cvt_pk_bf16_f32 v177, v178, v179
    s_waitcnt lgkmcnt(10)
    v_mfma_f32_32x32x16_bf16 v[112:127], v[60:63], v[168:171], v[112:127]
    ds_read_b64_tr_b16 v[52:53], v249 offset:28672
    ds_read_b64_tr_b16 v[54:55], v249 offset:29696
    v_cvt_pk_bf16_f32 v178, v180, v181
    v_cvt_pk_bf16_f32 v179, v182, v183
    v_exp_f32 v184, v184
    v_exp_f32 v185, v185
    s_waitcnt lgkmcnt(10)
    v_mfma_f32_32x32x16_bf16 v[64:79], v[32:35], v[176:179], v[64:79]
    ds_read_b64_tr_b16 v[56:57], v250 offset:28672
    ds_read_b64_tr_b16 v[58:59], v250 offset:29696
    v_exp_f32 v186, v186
    v_exp_f32 v187, v187
    v_exp_f32 v188, v188
    v_exp_f32 v189, v189
    v_exp_f32 v190, v190
    s_waitcnt lgkmcnt(10)
    v_mfma_f32_32x32x16_bf16 v[80:95], v[36:39], v[176:179], v[80:95]
    ds_read_b64_tr_b16 v[60:61], v251 offset:28672
    ds_read_b64_tr_b16 v[62:63], v251 offset:29696
    v_exp_f32 v191, v191
    v_add_f32 v27, v27, v184
    v_add_f32 v27, v27, v185
    v_add_f32 v27, v27, v186
    s_waitcnt lgkmcnt(10)
    v_mfma_f32_32x32x16_bf16 v[96:111], v[40:43], v[176:179], v[96:111]
    v_add_f32 v27, v27, v187
    v_add_f32 v27, v27, v188
    v_add_f32 v27, v27, v189
    v_add_f32 v27, v27, v190
    s_waitcnt lgkmcnt(8)
    v_mfma_f32_32x32x16_bf16 v[112:127], v[44:47], v[176:179], v[112:127]
    v_add_f32 v27, v27, v191
    v_cvt_pk_bf16_f32 v184, v184, v185
    v_cvt_pk_bf16_f32 v185, v186, v187
    v_cvt_pk_bf16_f32 v186, v188, v189
    v_cvt_pk_bf16_f32 v187, v190, v191
    s_waitcnt lgkmcnt(6)
    s_nop 0
    v_mfma_f32_32x32x16_bf16 v[64:79], v[48:51], v[184:187], v[64:79]
    v_max3_f32 v30, v192, v193, v194
    v_max3_f32 v30, v30, v195, v196
    v_max3_f32 v30, v30, v197, v198
    v_max3_f32 v30, v30, v199, v200
    s_waitcnt lgkmcnt(4)
    v_mfma_f32_32x32x16_bf16 v[80:95], v[52:55], v[184:187], v[80:95]
    v_max3_f32 v30, v30, v201, v202
    v_max3_f32 v30, v30, v203, v204
    v_max3_f32 v30, v30, v205, v206
    v_max3_f32 v30, v30, v207, v208
    s_waitcnt lgkmcnt(2)
    v_mfma_f32_32x32x16_bf16 v[96:111], v[56:59], v[184:187], v[96:111]
    v_max3_f32 v30, v30, v209, v210
    v_max3_f32 v30, v30, v211, v212
    v_max3_f32 v30, v30, v213, v214
    v_max3_f32 v30, v30, v215, v216
    s_waitcnt lgkmcnt(0)
    v_mfma_f32_32x32x16_bf16 v[112:127], v[60:63], v[184:187], v[112:127]
    v_max3_f32 v30, v30, v217, v218
    v_max3_f32 v30, v30, v219, v220
    v_max3_f32 v30, v30, v221, v222
    v_max_f32 v30, v30, v223
    s_waitcnt vmcnt(4) lgkmcnt(0)
    s_barrier
    v_add_u32 v240, 65536, v14
    v_add_u32 v241, 65536, v15
    v_add_u32 v242, 65536, v16
    v_add_u32 v243, 65536, v17
    v_add_u32 v244, 65536, v18
    v_add_u32 v245, 65536, v19
    v_add_u32 v246, 65536, v20
    v_add_u32 v247, 65536, v21
    v_add_u32 v248, 65536, v22
    v_add_u32 v249, 65536, v23
    v_add_u32 v250, 65536, v24
    v_add_u32 v251, 65536, v25
    ds_read_b128 v[32:35], v240 offset:0
    ds_read_b128 v[36:39], v241 offset:0
    ds_read_b128 v[40:43], v242 offset:0
    ds_read_b128 v[44:47], v243 offset:0
    ds_read_b128 v[48:51], v244 offset:0
    ds_read_b128 v[52:55], v245 offset:0
    v_cmp_lt_f32 vcc, s51, v30
    s_cbranch_vccnz L_fix2
L_back2:
    s_waitcnt lgkmcnt(5)
    v_mfma_f32_32x32x16_bf16 v[160:175], v[32:35], v[128:131], v[224:239]
    ds_read_b128 v[56:59], v246 offset:0
    s_lshl_b32 s94, s33, 3
    s_add_u32 s94, s94, s34
    v_and_b32 v252, 15, v1
    v_lshlrev_b32 v253, 7, v252
    s_waitcnt lgkmcnt(5)
    v_mfma_f32_32x32x16_bf16 v[160:175], v[36:39], v[132:135], v[160:175]
    ds_read_b128 v[60:63], v247 offset:0
    s_lshl_b32 s95, s32, 19
    s_lshl_b32 s94, s94, 11
    s_add_u32 s94, s94, s95
    s_waitcnt lgkmcnt(5)
    v_mfma_f32_32x32x16_bf16 v[160:175], v[40:43], v[136:139], v[160:175]
    ds_read_b128 v[32:35], v240 offset:8192
    buffer_load_dword v255, v253, s[24:27], s94 offen
    s_add_u32 m0, s42, 131072
    s_add_u32 s40, s53, 65536
    buffer_load_dwordx4 v6, s[12:15], s40 offen offset:0 lds
    s_waitcnt lgkmcnt(5)
    v_mfma_f32_32x32x16_bf16 v[160:175], v[44:47], v[140:143], v[160:175]
    ds_read_b128 v[36:39], v241 offset:8192
    buffer_load_dwordx4 v7, s[12:15], s40 offen offset:1024 lds
    s_add_u32 m0, s42, 147456
    s_add_u32 s43, s53, 49152
    s_waitcnt lgkmcnt(5)
    v_mfma_f32_32x32x16_bf16 v[160:175], v[48:51], v[144:147], v[160:175]
    ds_read_b128 v[40:43], v242 offset:8192
    buffer_load_dwordx4 v8, s[72:75], s43 offen offset:0 lds
    buffer_load_dwordx4 v8, s[72:75], s43 offen offset:1024 lds
    v_exp_f32 v192, v192
    v_exp_f32 v193, v193
    s_waitcnt lgkmcnt(5)
    v_mfma_f32_32x32x16_bf16 v[160:175], v[52:55], v[148:151], v[160:175]
    ds_read_b128 v[44:47], v243 offset:8192
    v_exp_f32 v194, v194
    v_exp_f32 v195, v195
    v_exp_f32 v196, v196
    s_waitcnt lgkmcnt(5)
    v_mfma_f32_32x32x16_bf16 v[160:175], v[56:59], v[152:155], v[160:175]
    ds_read_b128 v[48:51], v244 offset:8192
    v_exp_f32 v197, v197
    v_exp_f32 v198, v198
    v_exp_f32 v199, v199
    v_add_f32 v27, v27, v192
    s_waitcnt lgkmcnt(5)
    v_mfma_f32_32x32x16_bf16 v[160:175], v[60:63], v[156:159], v[160:175]
    ds_read_b128 v[52:55], v245 offset:8192
    v_add_f32 v27, v27, v193
    v_add_f32 v27, v27, v194
    v_add_f32 v27, v27, v195
    s_waitcnt lgkmcnt(5)
    v_mfma_f32_32x32x16_bf16 v[176:191], v[32:35], v[128:131], v[224:239]
    ds_read_b128 v[56:59], v246 offset:8192
    v_add_f32 v27, v27, v196
    v_add_f32 v27, v27, v197
    v_add_f32 v27, v27, v198
    v_add_f32 v27, v27, v199
    s_waitcnt lgkmcnt(5)
    v_mfma_f32_32x32x16_bf16 v[176:191], v[36:39], v[132:135], v[176:191]
    ds_read_b128 v[60:63], v247 offset:8192
    v_cvt_pk_bf16_f32 v192, v192, v193
    v_cvt_pk_bf16_f32 v193, v194, v195
    v_cvt_pk_bf16_f32 v194, v196, v197
    s_waitcnt lgkmcnt(5)
    v_mfma_f32_32x32x16_bf16 v[176:191], v[40:43], v[136:139], v[176:191]
    ds_read_b64_tr_b16 v[32:33], v248 offset:16384
    ds_read_b64_tr_b16 v[34:35], v248 offset:17408
    v_cvt_pk_bf16_f32 v195, v198, v199
    v_exp_f32 v200, v200
    v_exp_f32 v201, v201
    v_exp_f32 v202, v202
    s_waitcnt lgkmcnt(6)
    v_mfma_f32_32x32x16_bf16 v[176:191], v[44:47], v[140:143], v[176:191]
    ds_read_b64_tr_b16 v[36:37], v249 offset:16384
    ds_read_b64_tr_b16 v[38:39], v249 offset:17408
    v_exp_f32 v203, v203
    v_exp_f32 v204, v204
    v_exp_f32 v205, v205
    s_waitcnt lgkmcnt(7)
    v_mfma_f32_32x32x16_bf16 v[176:191], v[48:51], v[144:147], v[176:191]
    ds_read_b64_tr_b16 v[40:41], v250 offset:16384
    ds_read_b64_tr_b16 v[42:43], v250 offset:17408
    v_exp_f32 v206, v206
    v_exp_f32 v207, v207
    v_add_f32 v27, v27, v200
    v_add_f32 v27, v27, v201
    s_waitcnt lgkmcnt(8)
    v_mfma_f32_32x32x16_bf16 v[176:191], v[52:55], v[148:151], v[176:191]
    ds_read_b64_tr_b16 v[44:45], v251 offset:16384
    ds_read_b64_tr_b16 v[46:47], v251 offset:17408
    v_add_f32 v27, v27, v202
    v_add_f32 v27, v27, v203
    v_add_f32 v27, v27, v204
    s_waitcnt lgkmcnt(9)
    v_mfma_f32_32x32x16_bf16 v[176:191], v[56:59], v[152:155], v[176:191]
    ds_read_b64_tr_b16 v[48:49], v248 offset:20480
    ds_read_b64_tr_b16 v[50:51], v248 offset:21504
    v_add_f32 v27, v27, v205
    v_add_f32 v27, v27, v206
    v_add_f32 v27, v27, v207
    v_cvt_pk_bf16_f32 v200, v200, v201
    s_waitcnt lgkmcnt(10)
    v_mfma_f32_32x32x16_bf16 v[176:191], v[60:63], v[156:159], v[176:191]
    ds_read_b64_tr_b16 v[52:53], v249 offset:20480
    ds_read_b64_tr_b16 v[54:55], v249 offset:21504
    v_cvt_pk_bf16_f32 v201, v202, v203
    v_cvt_pk_bf16_f32 v202, v204, v205
    v_cvt_pk_bf16_f32 v203, v206, v207
    s_waitcnt lgkmcnt(10)
    v_mfma_f32_32x32x16_bf16 v[64:79], v[32:35], v[192:195], v[64:79]
    ds_read_b64_tr_b16 v[56:57], v250 offset:20480
    ds_read_b64_tr_b16 v[58:59], v250 offset:21504
    v_exp_f32 v208, v208
    v_exp_f32 v209, v209
    v_exp_f32 v210, v210
    v_exp_f32 v211, v211
    s_waitcnt lgkmcnt(10)
    v_mfma_f32_32x32x16_bf16 v[80:95], v[36:39], v[192:195], v[80:95]
    ds_read_b64_tr_b16 v[60:61], v251 offset:20480
    ds_read_b64_tr_b16 v[62:63], v251 offset:21504
    v_exp_f32 v212, v212
    v_exp_f32 v213, v213
    v_exp_f32 v214, v214
    s_waitcnt lgkmcnt(10)
    v_mfma_f32_32x32x16_bf16 v[96:111], v[40:43], v[192:195], v[96:111]
    ds_read_b64_tr_b16 v[32:33], v248 offset:24576
    ds_read_b64_tr_b16 v[34:35], v248 offset:25600
    v_exp_f32 v215, v215
    v_add_f32 v27, v27, v208
    v_add_f32 v27, v27, v209
    v_add_f32 v27, v27, v210
    s_waitcnt lgkmcnt(10)
    v_mfma_f32_32x32x16_bf16 v[112:127], v[44:47], v[192:195], v[112:127]
    ds_read_b64_tr_b16 v[36:37], v249 offset:24576
    ds_read_b64_tr_b16 v[38:39], v249 offset:25600
    v_add_f32 v27, v27, v211
    v_add_f32 v27, v27, v212
    v_add_f32 v27, v27, v213
    s_waitcnt lgkmcnt(10)
    v_mfma_f32_32x32x16_bf16 v[64:79], v[48:51], v[200:203], v[64:79]
    ds_read_b64_tr_b16 v[40:41], v250 offset:24576
    ds_read_b64_tr_b16 v[42:43], v250 offset:25600
    v_add_f32 v27, v27, v214
    v_add_f32 v27, v27, v215
    v_cvt_pk_bf16_f32 v208, v208, v209
    v_cvt_pk_bf16_f32 v209, v210, v211
    s_waitcnt lgkmcnt(10)
    v_mfma_f32_32x32x16_bf16 v[80:95], v[52:55], v[200:203], v[80:95]
    ds_read_b64_tr_b16 v[44:45], v251 offset:24576
    ds_read_b64_tr_b16 v[46:47], v251 offset:25600
    v_cvt_pk_bf16_f32 v210, v212, v213
    v_cvt_pk_bf16_f32 v211, v214, v215
    v_exp_f32 v216, v216
    s_waitcnt lgkmcnt(10)
    v_mfma_f32_32x32x16_bf16 v[96:111], v[56:59], v[200:203], v[96:111]
    ds_read_b64_tr_b16 v[48:49], v248 offset:28672
    ds_read_b64_tr_b16 v[50:51], v248 offset:29696
    v_exp_f32 v217, v217
    v_exp_f32 v218, v218
    v_exp_f32 v219, v219
    v_exp_f32 v220, v220
    s_waitcnt lgkmcnt(10)
    v_mfma_f32_32x32x16_bf16 v[112:127], v[60:63], v[200:203], v[112:127]
    ds_read_b64_tr_b16 v[52:53], v249 offset:28672
    ds_read_b64_tr_b16 v[54:55], v249 offset:29696
    v_exp_f32 v221, v221
    v_exp_f32 v222, v222
    v_exp_f32 v223, v223
    s_waitcnt lgkmcnt(10)
    v_mfma_f32_32x32x16_bf16 v[64:79], v[32:35], v[208:211], v[64:79]
    ds_read_b64_tr_b16 v[56:57], v250 offset:28672
    ds_read_b64_tr_b16 v[58:59], v250 offset:29696
    v_add_f32 v27, v27, v216
    v_add_f32 v27, v27, v217
    v_add_f32 v27, v27, v218
    v_add_f32 v27, v27, v219
    s_waitcnt lgkmcnt(10)
    v_mfma_f32_32x32x16_bf16 v[80:95], v[36:39], v[208:211], v[80:95]
    ds_read_b64_tr_b16 v[60:61], v251 offset:28672
    ds_read_b64_tr_b16 v[62:63], v251 offset:29696
    v_add_f32 v27, v27, v220
    v_add_f32 v27, v27, v221
    v_add_f32 v27, v27, v222
    s_waitcnt lgkmcnt(10)
    v_mfma_f32_32x32x16_bf16 v[96:111], v[40:43], v[208:211], v[96:111]
    v_add_f32 v27, v27, v223
    v_cvt_pk_bf16_f32 v216, v216, v217
    v_cvt_pk_bf16_f32 v217, v218, v219
    v_cvt_pk_bf16_f32 v218, v220, v221
    s_waitcnt lgkmcnt(8)
    v_mfma_f32_32x32x16_bf16 v[112:127], v[44:47], v[208:211], v[112:127]
    v_cvt_pk_bf16_f32 v219, v222, v223
    v_max3_f32 v30, v160, v161, v162
    v_max3_f32 v30, v30, v163, v164
    s_waitcnt lgkmcnt(6)
    v_mfma_f32_32x32x16_bf16 v[64:79], v[48:51], v[216:219], v[64:79]
    v_max3_f32 v30, v30, v165, v166
    v_max3_f32 v30, v30, v167, v168
    v_max3_f32 v30, v30, v169, v170
    v_max3_f32 v30, v30, v171, v172
    s_waitcnt lgkmcnt(4)
    v_mfma_f32_32x32x16_bf16 v[80:95], v[52:55], v[216:219], v[80:95]
    v_max3_f32 v30, v30, v173, v174
    v_max3_f32 v30, v30, v175, v176
    v_max3_f32 v30, v30, v177, v178
    s_waitcnt lgkmcnt(2)
    v_mfma_f32_32x32x16_bf16 v[96:111], v[56:59], v[216:219], v[96:111]
    v_max3_f32 v30, v30, v179, v180
    v_max3_f32 v30, v30, v181, v182
    v_max3_f32 v30, v30, v183, v184
    v_max3_f32 v30, v30, v185, v186
    s_waitcnt lgkmcnt(0)
    v_mfma_f32_32x32x16_bf16 v[112:127], v[60:63], v[216:219], v[112:127]
    v_max3_f32 v30, v30, v187, v188
    v_max3_f32 v30, v30, v189, v190
    v_max_f32 v30, v30, v191
    s_waitcnt vmcnt(5) lgkmcnt(0)
    s_barrier
    v_add_u32 v240, 98304, v14
    v_add_u32 v241, 98304, v15
    v_add_u32 v242, 98304, v16
    v_add_u32 v243, 98304, v17
    v_add_u32 v244, 98304, v18
    v_add_u32 v245, 98304, v19
    v_add_u32 v246, 98304, v20
    v_add_u32 v247, 98304, v21
    v_add_u32 v248, 98304, v22
    v_add_u32 v249, 98304, v23
    v_add_u32 v250, 98304, v24
    v_add_u32 v251, 98304, v25
    ds_read_b128 v[32:35], v240 offset:0
    ds_read_b128 v[36:39], v241 offset:0
    ds_read_b128 v[40:43], v242 offset:0
    ds_read_b128 v[44:47], v243 offset:0
    ds_read_b128 v[48:51], v244 offset:0
    ds_read_b128 v[52:55], v245 offset:0
    v_cmp_lt_f32 vcc, s51, v30
    s_cbranch_vccnz L_fix3
L_back3:
    s_waitcnt lgkmcnt(5)
    v_mfma_f32_32x32x16_bf16 v[192:207], v[32:35], v[128:131], v[224:239]
    ds_read_b128 v[56:59], v246 offset:0
    s_add_u32 m0, s42, 65536
    s_add_u32 s40, s53, 81920
    buffer_load_dwordx4 v6, s[12:15], s40 offen offset:0 lds
    buffer_load_dwordx4 v7, s[12:15], s40 offen offset:1024 lds
    s_waitcnt lgkmcnt(5)
    v_mfma_f32_32x32x16_bf16 v[192:207], v[36:39], v[132:135], v[192:207]
    ds_read_b128 v[60:63], v247 offset:0
    s_add_u32 m0, s42, 81920
    s_add_u32 s43, s53, 65536
    buffer_load_dwordx4 v8, s[72:75], s43 offen offset:0 lds
    s_waitcnt lgkmcnt(5)
    v_mfma_f32_32x32x16_bf16 v[192:207], v[40:43], v[136:139], v[192:207]
    ds_read_b128 v[32:35], v240 offset:8192
    buffer_load_dwordx4 v8, s[72:75], s43 offen offset:1024 lds
    v_exp_f32 v160, v160
    v_exp_f32 v161, v161
    s_waitcnt lgkmcnt(5)
    v_mfma_f32_32x32x16_bf16 v[192:207], v[44:47], v[140:143], v[192:207]
    ds_read_b128 v[36:39], v241 offset:8192
    v_exp_f32 v162, v162
    v_exp_f32 v163, v163
    v_exp_f32 v164, v164
    s_waitcnt lgkmcnt(5)
    v_mfma_f32_32x32x16_bf16 v[192:207], v[48:51], v[144:147], v[192:207]
    ds_read_b128 v[40:43], v242 offset:8192
    v_exp_f32 v165, v165
    v_exp_f32 v166, v166
    v_exp_f32 v167, v167
    v_add_f32 v27, v27, v160
    s_waitcnt lgkmcnt(5)
    v_mfma_f32_32x32x16_bf16 v[192:207], v[52:55], v[148:151], v[192:207]
    ds_read_b128 v[44:47], v243 offset:8192
    v_add_f32 v27, v27, v161
    v_add_f32 v27, v27, v162
    v_add_f32 v27, v27, v163
    s_waitcnt lgkmcnt(5)
    v_mfma_f32_32x32x16_bf16 v[192:207], v[56:59], v[152:155], v[192:207]
    ds_read_b128 v[48:51], v244 offset:8192
    v_add_f32 v27, v27, v164
    v_add_f32 v27, v27, v165
    v_add_f32 v27, v27, v166
    s_waitcnt lgkmcnt(5)
    v_mfma_f32_32x32x16_bf16 v[192:207], v[60:63], v[156:159], v[192:207]
    ds_read_b128 v[52:55], v245 offset:8192
    v_add_f32 v27, v27, v167
    v_cvt_pk_bf16_f32 v160, v160, v161
    v_cvt_pk_bf16_f32 v161, v162, v163
    s_waitcnt lgkmcnt(5)
    v_mfma_f32_32x32x16_bf16 v[208:223], v[32:35], v[128:131], v[224:239]
    ds_read_b128 v[56:59], v246 offset:8192
    v_cvt_pk_bf16_f32 v162, v164, v165
    v_cvt_pk_bf16_f32 v163, v166, v167
    v_exp_f32 v168, v168
    v_exp_f32 v169, v169
    s_waitcnt lgkmcnt(5)
    v_mfma_f32_32x32x16_bf16 v[208:223], v[36:39], v[132:135], v[208:223]
    ds_read_b128 v[60:63], v247 offset:8192
    v_exp_f32 v170, v170
    v_exp_f32 v171, v171
    v_exp_f32 v172, v172
    s_waitcnt lgkmcnt(5)
    v_mfma_f32_32x32x16_bf16 v[208:223], v[40:43], v[136:139], v[208:223]
    ds_read_b64_tr_b16 v[32:33], v248 offset:16384
    ds_read_b64_tr_b16 v[34:35], v248 offset:17408
    v_exp_f32 v173, v173
    v_exp_f32 v174, v174
    v_exp_f32 v175, v175
    s_waitcnt lgkmcnt(6)
    v_mfma_f32_32x32x16_bf16 v[208:223], v[44:47], v[140:143], v[208:223]
    ds_read_b64_tr_b16 v[36:37], v249 offset:16384
    ds_read_b64_tr_b16 v[38:39], v249 offset:17408
    v_add_f32 v27, v27, v168
    v_add_f32 v27, v27, v169
    v_add_f32 v27, v27, v170
    s_waitcnt lgkmcnt(7)
    v_mfma_f32_32x32x16_bf16 v[208:223], v[48:51], v[144:147], v[208:223]
    ds_read_b64_tr_b16 v[40:41], v250 offset:16384
    ds_read_b64_tr_b16 v[42:43], v250 offset:17408
    v_add_f32 v27, v27, v171
    v_add_f32 v27, v27, v172
    v_add_f32 v27, v27, v173
    v_add_f32 v27, v27, v174
    s_waitcnt lgkmcnt(8)
    v_mfma_f32_32x32x16_bf16 v[208:223], v[52:55], v[148:151], v[208:223]
    ds_read_b64_tr_b16 v[44:45], v251 offset:16384
    ds_read_b64_tr_b16 v[46:47], v251 offset:17408
    v_add_f32 v27, v27, v175
    v_cvt_pk_bf16_f32 v168, v168, v169
    v_cvt_pk_bf16_f32 v169, v170, v171
    s_waitcnt lgkmcnt(9)
    v_mfma_f32_32x32x16_bf16 v[208:223], v[56:59], v[152:155], v[208:223]
    ds_read_b64_tr_b16 v[48:49], v248 offset:20480
    ds_read_b64_tr_b16 v[50:51], v248 offset:21504
    v_cvt_pk_bf16_f32 v170, v172, v173
    v_cvt_pk_bf16_f32 v171, v174, v175
    v_exp_f32 v176, v176
    s_waitcnt lgkmcnt(10)
    v_mfma_f32_32x32x16_bf16 v[208:223], v[60:63], v[156:159], v[208:223]
    ds_read_b64_tr_b16 v[52:53], v249 offset:20480
    ds_read_b64_tr_b16 v[54:55], v249 offset:21504
    v_exp_f32 v177, v177
    v_exp_f32 v178, v178
    v_exp_f32 v179, v179
    s_waitcnt lgkmcnt(10)
    v_mfma_f32_32x32x16_bf16 v[64:79], v[32:35], v[160:163], v[64:79]
    ds_read_b64_tr_b16 v[56:57], v250 offset:20480
    ds_read_b64_tr_b16 v[58:59], v250 offset:21504
    v_exp_f32 v180, v180
    v_exp_f32 v181, v181
    v_exp_f32 v182, v182
    v_exp_f32 v183, v183
    s_waitcnt lgkmcnt(10)
    v_mfma_f32_32x32x16_bf16 v[80:95], v[36:39], v[160:163], v[80:95]
    ds_read_b64_tr_b16 v[60:61], v251 offset:20480
    ds_read_b64_tr_b16 v[62:63], v251 offset:21504
    v_add_f32 v27, v27, v176
    v_add_f32 v27, v27, v177
    v_add_f32 v27, v27, v178
    s_waitcnt lgkmcnt(10)
    v_mfma_f32_32x32x16_bf16 v[96:111], v[40:43], v[160:163], v[96:111]
    ds_read_b64_tr_b16 v[32:33], v248 offset:24576
    ds_read_b64_tr_b16 v[34:35], v248 offset:25600
    v_add_f32 v27, v27, v179
    v_add_f32 v27, v27, v180
    v_add_f32 v27, v27, v181
    s_waitcnt lgkmcnt(10)
    v_mfma_f32_32x32x16_bf16 v[112:127], v[44:47], v[160:163], v[112:127]
    ds_read_b64_tr_b16 v[36:37], v249 offset:24576
    ds_read_b64_tr_b16 v[38:39], v249 offset:25600
    v_add_f32 v27, v27, v182
    v_add_f32 v27, v27, v183
    v_cvt_pk_bf16_f32 v176, v176, v177
    s_waitcnt lgkmcnt(10)
    v_mfma_f32_32x32x16_bf16 v[64:79], v[48:51], v[168:171], v[64:79]
    ds_read_b64_tr_b16 v[40:41], v250 offset:24576
    ds_read_b64_tr_b16 v[42:43], v250 offset:25600
    v_cvt_pk_bf16_f32 v177, v178, v179
    v_cvt_pk_bf16_f32 v178, v180, v181
    v_cvt_pk_bf16_f32 v179, v182, v183
    v_exp_f32 v184, v184
    s_waitcnt lgkmcnt(10)
    v_mfma_f32_32x32x16_bf16 v[80:95], v[52:55], v[168:171], v[80:95]
    ds_read_b64_tr_b16 v[44:45], v251 offset:24576
    ds_read_b64_tr_b16 v[46:47], v251 offset:25600
    v_exp_f32 v185, v185
    v_exp_f32 v186, v186
    v_exp_f32 v187, v187
    s_waitcnt lgkmcnt(10)
    v_mfma_f32_32x32x16_bf16 v[96:111], v[56:59], v[168:171], v[96:111]
    ds_read_b64_tr_b16 v[48:49], v248 offset:28672
    ds_read_b64_tr_b16 v[50:51], v248 offset:29696
    v_exp_f32 v188, v188
    v_exp_f32 v189, v189
    v_exp_f32 v190, v190
    s_waitcnt lgkmcnt(10)
    v_mfma_f32_32x32x16_bf16 v[112:127], v[60:63], v[168:171], v[112:127]
    ds_read_b64_tr_b16 v[52:53], v249 offset:28672
    ds_read_b64_tr_b16 v[54:55], v249 offset:29696
    v_exp_f32 v191, v191
    v_add_f32 v27, v27, v184
    v_add_f32 v27, v27, v185
    s_waitcnt lgkmcnt(10)
    v_mfma_f32_32x32x16_bf16 v[64:79], v[32:35], v[176:179], v[64:79]
    ds_read_b64_tr_b16 v[56:57], v250 offset:28672
    ds_read_b64_tr_b16 v[58:59], v250 offset:29696
    v_add_f32 v27, v27, v186
    v_add_f32 v27, v27, v187
    v_add_f32 v27, v27, v188
    v_add_f32 v27, v27, v189
    s_waitcnt lgkmcnt(10)
    v_mfma_f32_32x32x16_bf16 v[80:95], v[36:39], v[176:179], v[80:95]
    ds_read_b64_tr_b16 v[60:61], v251 offset:28672
    ds_read_b64_tr_b16 v[62:63], v251 offset:29696
    v_add_f32 v27, v27, v190
    v_add_f32 v27, v27, v191
    v_cvt_pk_bf16_f32 v184, v184, v185
    s_waitcnt lgkmcnt(10)
    v_mfma_f32_32x32x16_bf16 v[96:111], v[40:43], v[176:179], v[96:111]
    v_cvt_pk_bf16_f32 v185, v186, v187
    v_cvt_pk_bf16_f32 v186, v188, v189
    v_cvt_pk_bf16_f32 v187, v190, v191
    s_waitcnt lgkmcnt(8)
    v_mfma_f32_32x32x16_bf16 v[112:127], v[44:47], v[176:179], v[112:127]
    v_max3_f32 v30, v192, v193, v194
    v_max3_f32 v30, v30, v195, v196
    v_max3_f32 v30, v30, v197, v198
    s_waitcnt lgkmcnt(6)
    v_mfma_f32_32x32x16_bf16 v[64:79], v[48:51], v[184:187], v[64:79]
    v_max3_f32 v30, v30, v199, v200
    v_max3_f32 v30, v30, v201, v202
    v_max3_f32 v30, v30, v203, v204
    v_max3_f32 v30, v30, v205, v206
    s_waitcnt lgkmcnt(4)
    v_mfma_f32_32x32x16_bf16 v[80:95], v[52:55], v[184:187], v[80:95]
    v_max3_f32 v30, v30, v207, v208
    v_max3_f32 v30, v30, v209, v210
    v_max3_f32 v30, v30, v211, v212
    s_waitcnt lgkmcnt(2)
    v_mfma_f32_32x32x16_bf16 v[96:111], v[56:59], v[184:187], v[96:111]
    v_max3_f32 v30, v30, v213, v214
    v_max3_f32 v30, v30, v215, v216
    v_max3_f32 v30, v30, v217, v218
    s_waitcnt lgkmcnt(0)
    v_mfma_f32_32x32x16_bf16 v[112:127], v[60:63], v[184:187], v[112:127]
    v_max3_f32 v30, v30, v219, v220
    v_max3_f32 v30, v30, v221, v222
    v_max_f32 v30, v30, v223
    s_waitcnt vmcnt(4) lgkmcnt(0)
    s_barrier
    v_add_u32 v240, 131072, v14
    v_add_u32 v241, 131072, v15
    v_add_u32 v242, 131072, v16
    v_add_u32 v243, 131072, v17
    v_add_u32 v244, 131072, v18
    v_add_u32 v245, 131072, v19
    v_add_u32 v246, 131072, v20
    v_add_u32 v247, 131072, v21
    v_add_u32 v248, 131072, v22
    v_add_u32 v249, 131072, v23
    v_add_u32 v250, 131072, v24
    v_add_u32 v251, 131072, v25
    ds_read_b128 v[32:35], v240 offset:0
    ds_read_b128 v[36:39], v241 offset:0
    ds_read_b128 v[40:43], v242 offset:0
    ds_read_b128 v[44:47], v243 offset:0
    ds_read_b128 v[48:51], v244 offset:0
    ds_read_b128 v[52:55], v245 offset:0
    v_cmp_lt_f32 vcc, s51, v30
    s_cbranch_vccnz L_fix4
L_back4:
    s_waitcnt lgkmcnt(5)
    v_mfma_f32_32x32x16_bf16 v[160:175], v[32:35], v[128:131], v[224:239]
    ds_read_b128 v[56:59], v246 offset:0
    v_mov_b32 v254, 0
    buffer_load_dword v255, v254, s[96:99], 0 offen sc1
    s_add_u32 m0, s42, 98304
    s_add_u32 s40, s53, 98304
    s_waitcnt lgkmcnt(5)
    v_mfma_f32_32x32x16_bf16 v[160:175], v[36:39], v[132:135], v[160:175]
    ds_read_b128 v[60:63], v247 offset:0
    buffer_load_dwordx4 v6, s[12:15], s40 offen offset:0 lds
    buffer_load_dwordx4 v7, s[12:15], s40 offen offset:1024 lds
    s_add_u32 m0, s42, 114688
    s_waitcnt lgkmcnt(5)
    v_mfma_f32_32x32x16_bf16 v[160:175], v[40:43], v[136:139], v[160:175]
    ds_read_b128 v[32:35], v240 offset:8192
    s_add_u32 s43, s53, 81920
    buffer_load_dwordx4 v8, s[72:75], s43 offen offset:0 lds
    buffer_load_dwordx4 v8, s[72:75], s43 offen offset:1024 lds
    s_waitcnt lgkmcnt(5)
    v_mfma_f32_32x32x16_bf16 v[160:175], v[44:47], v[140:143], v[160:175]
    ds_read_b128 v[36:39], v241 offset:8192
    v_exp_f32 v192, v192
    v_exp_f32 v193, v193
    v_exp_f32 v194, v194
    v_exp_f32 v195, v195
    s_waitcnt lgkmcnt(5)
    v_mfma_f32_32x32x16_bf16 v[160:175], v[48:51], v[144:147], v[160:175]
    ds_read_b128 v[40:43], v242 offset:8192
    v_exp_f32 v196, v196
    v_exp_f32 v197, v197
    v_exp_f32 v198, v198
    s_waitcnt lgkmcnt(5)
    v_mfma_f32_32x32x16_bf16 v[160:175], v[52:55], v[148:151], v[160:175]
    ds_read_b128 v[44:47], v243 offset:8192
    v_exp_f32 v199, v199
    v_add_f32 v27, v27, v192
    v_add_f32 v27, v27, v193
    s_waitcnt lgkmcnt(5)
    v_mfma_f32_32x32x16_bf16 v[160:175], v[56:59], v[152:155], v[160:175]
    ds_read_b128 v[48:51], v244 offset:8192
    v_add_f32 v27, v27, v194
    v_add_f32 v27, v27, v195
    v_add_f32 v27, v27, v196
    v_add_f32 v27, v27, v197
    s_waitcnt lgkmcnt(5)
    v_mfma_f32_32x32x16_bf16 v[160:175], v[60:63], v[156:159], v[160:175]
    ds_read_b128 v[52:55], v245 offset:8192
    v_add_f32 v27, v27, v198
    v_add_f32 v27, v27, v199
    v_cvt_pk_bf16_f32 v192, v192, v193
    s_waitcnt lgkmcnt(5)
    v_mfma_f32_32x32x16_bf16 v[176:191], v[32:35], v[128:131], v[224:239]
    ds_read_b128 v[56:59], v246 offset:8192
    v_cvt_pk_bf16_f32 v193, v194, v195
    v_cvt_pk_bf16_f32 v194, v196, v197
    v_cvt_pk_bf16_f32 v195, v198, v199
    s_waitcnt lgkmcnt(5)
    v_mfma_f32_32x32x16_bf16 v[176:191], v[36:39], v[132:135], v[176:191]
    ds_read_b128 v[60:63], v247 offset:8192
    v_exp_f32 v200, v200
    v_exp_f32 v201, v201
    v_exp_f32 v202, v202
    v_exp_f32 v203, v203
    s_waitcnt lgkmcnt(5)
    v_mfma_f32_32x32x16_bf16 v[176:191], v[40:43], v[136:139], v[176:191]
    ds_read_b64_tr_b16 v[32:33], v248 offset:16384
    ds_read_b64_tr_b16 v[34:35], v248 offset:17408
    v_exp_f32 v204, v204
    v_exp_f32 v205, v205
    v_exp_f32 v206, v206
    s_waitcnt lgkmcnt(6)
    v_mfma_f32_32x32x16_bf16 v[176:191], v[44:47], v[140:143], v[176:191]
    ds_read_b64_tr_b16 v[36:37], v249 offset:16384
    ds_read_b64_tr_b16 v[38:39], v249 offset:17408
    v_exp_f32 v207, v207
    v_add_f32 v27, v27, v200
    v_add_f32 v27, v27, v201
    s_waitcnt lgkmcnt(7)
    v_mfma_f32_32x32x16_bf16 v[176:191], v[48:51], v[144:147], v[176:191]
    ds_read_b64_tr_b16 v[40:41], v250 offset:16384
    ds_read_b64_tr_b16 v[42:43], v250 offset:17408
    v_add_f32 v27, v27, v202
    v_add_f32 v27, v27, v203
    v_add_f32 v27, v27, v204
    v_add_f32 v27, v27, v205
    s_waitcnt lgkmcnt(8)
    v_mfma_f32_32x32x16_bf16 v[176:191], v[52:55], v[148:151], v[176:191]
    ds_read_b64_tr_b16 v[44:45], v251 offset:16384
    ds_read_b64_tr_b16 v[46:47], v251 offset:17408
    v_add_f32 v27, v27, v206
    v_add_f32 v27, v27, v207
    v_cvt_pk_bf16_f32 v200, v200, v201
    s_waitcnt lgkmcnt(9)
    v_mfma_f32_32x32x16_bf16 v[176:191], v[56:59], v[152:155], v[176:191]
    ds_read_b64_tr_b16 v[48:49], v248 offset:20480
    ds_read_b64_tr_b16 v[50:51], v248 offset:21504
    v_cvt_pk_bf16_f32 v201, v202, v203
    v_cvt_pk_bf16_f32 v202, v204, v205
    v_cvt_pk_bf16_f32 v203, v206, v207
    s_waitcnt lgkmcnt(10)
    v_mfma_f32_32x32x16_bf16 v[176:191], v[60:63], v[156:159], v[176:191]
    ds_read_b64_tr_b16 v[52:53], v249 offset:20480
    ds_read_b64_tr_b16 v[54:55], v249 offset:21504
    v_exp_f32 v208, v208
    v_exp_f32 v209, v209
    v_exp_f32 v210, v210
    s_waitcnt lgkmcnt(10)
    v_mfma_f32_32x32x16_bf16 v[64:79], v[32:35], v[192:195], v[64:79]
    ds_read_b64_tr_b16 v[56:57], v250 offset:20480
    ds_read_b64_tr_b16 v[58:59], v250 offset:21504
    v_exp_f32 v211, v211
    v_exp_f32 v212, v212
    v_exp_f32 v213, v213
    v_exp_f32 v214, v214
    s_waitcnt lgkmcnt(10)
    v_mfma_f32_32x32x16_bf16 v[80:95], v[36:39], v[192:195], v[80:95]
    ds_read_b64_tr_b16 v[60:61], v251 offset:20480
    ds_read_b64_tr_b16 v[62:63], v251 offset:21504
    v_exp_f32 v215, v215
    v_add_f32 v27, v27, v208
    v_add_f32 v27, v27, v209
    s_waitcnt lgkmcnt(10)
    v_mfma_f32_32x32x16_bf16 v[96:111], v[40:43], v[192:195], v[96:111]
    ds_read_b64_tr_b16 v[32:33], v248 offset:24576
    ds_read_b64_tr_b16 v[34:35], v248 offset:25600
    v_add_f32 v27, v27, v210
    v_add_f32 v27, v27, v211
    v_add_f32 v27, v27, v212
    s_waitcnt lgkmcnt(10)
    v_mfma_f32_32x32x16_bf16 v[112:127], v[44:47], v[192:195], v[112:127]
    ds_read_b64_tr_b16 v[36:37], v249 offset:24576
    ds_read_b64_tr_b16 v[38:39], v249 offset:25600
    v_add_f32 v27, v27, v213
    v_add_f32 v27, v27, v214
    v_add_f32 v27, v27, v215
    v_cvt_pk_bf16_f32 v208, v208, v209
    s_waitcnt lgkmcnt(10)
    v_mfma_f32_32x32x16_bf16 v[64:79], v[48:51], v[200:203], v[64:79]
    ds_read_b64_tr_b16 v[40:41], v250 offset:24576
    ds_read_b64_tr_b16 v[42:43], v250 offset:25600
    v_cvt_pk_bf16_f32 v209, v210, v211
    v_cvt_pk_bf16_f32 v210, v212, v213
    v_cvt_pk_bf16_f32 v211, v214, v215
    s_waitcnt lgkmcnt(10)
    v_mfma_f32_32x32x16_bf16 v[80:95], v[52:55], v[200:203], v[80:95]
    ds_read_b64_tr_b16 v[44:45], v251 offset:24576
    ds_read_b64_tr_b16 v[46:47], v251 offset:25600
    v_exp_f32 v216, v216
    v_exp_f32 v217, v217
    v_exp_f32 v218, v218
    s_waitcnt lgkmcnt(10)
    v_mfma_f32_32x32x16_bf16 v[96:111], v[56:59], v[200:203], v[96:111]
    ds_read_b64_tr_b16 v[48:49], v248 offset:28672
    ds_read_b64_tr_b16 v[50:51], v248 offset:29696
    v_exp_f32 v219, v219
    v_exp_f32 v220, v220
    v_exp_f32 v221, v221
    v_exp_f32 v222, v222
    s_waitcnt lgkmcnt(10)
    v_mfma_f32_32x32x16_bf16 v[112:127], v[60:63], v[200:203], v[112:127]
    ds_read_b64_tr_b16 v[52:53], v249 offset:28672
    ds_read_b64_tr_b16 v[54:55], v249 offset:29696
    v_exp_f32 v223, v223
    v_add_f32 v27, v27, v216
    v_add_f32 v27, v27, v217
    s_waitcnt lgkmcnt(10)
    v_mfma_f32_32x32x16_bf16 v[64:79], v[32:35], v[208:211], v[64:79]
    ds_read_b64_tr_b16 v[56:57], v250 offset:28672
    ds_read_b64_tr_b16 v[58:59], v250 offset:29696
    v_add_f32 v27, v27, v218
    v_add_f32 v27, v27, v219
    v_add_f32 v27, v27, v220
    s_waitcnt lgkmcnt(10)
    v_mfma_f32_32x32x16_bf16 v[80:95], v[36:39], v[208:211], v[80:95]
    ds_read_b64_tr_b16 v[60:61], v251 offset:28672
    ds_read_b64_tr_b16 v[62:63], v251 offset:29696
    v_add_f32 v27, v27, v221
    v_add_f32 v27, v27, v222
    v_add_f32 v27, v27, v223
    v_cvt_pk_bf16_f32 v216, v216, v217
    s_waitcnt lgkmcnt(10)
    v_mfma_f32_32x32x16_bf16 v[96:111], v[40:43], v[208:211], v[96:111]
    v_cvt_pk_bf16_f32 v217, v218, v219
    v_cvt_pk_bf16_f32 v218, v220, v221
    v_cvt_pk_bf16_f32 v219, v222, v223
    s_waitcnt lgkmcnt(8)
    v_mfma_f32_32x32x16_bf16 v[112:127], v[44:47], v[208:211], v[112:127]
    v_max3_f32 v30, v160, v161, v162
    v_max3_f32 v30, v30, v163, v164
    v_max3_f32 v30, v30, v165, v166
    s_waitcnt lgkmcnt(6)
    v_mfma_f32_32x32x16_bf16 v[64:79], v[48:51], v[216:219], v[64:79]
    v_max3_f32 v30, v30, v167, v168
    v_max3_f32 v30, v30, v169, v170
    v_max3_f32 v30, v30, v171, v172
    v_max3_f32 v30, v30, v173, v174
    s_waitcnt lgkmcnt(4)
    v_mfma_f32_32x32x16_bf16 v[80:95], v[52:55], v[216:219], v[80:95]
    v_max3_f32 v30, v30, v175, v176
    v_max3_f32 v30, v30, v177, v178
    v_max3_f32 v30, v30, v179, v180
    s_waitcnt lgkmcnt(2)
    v_mfma_f32_32x32x16_bf16 v[96:111], v[56:59], v[216:219], v[96:111]
    v_max3_f32 v30, v30, v181, v182
    v_max3_f32 v30, v30, v183, v184
    v_max3_f32 v30, v30, v185, v186
    s_waitcnt lgkmcnt(0)
    v_mfma_f32_32x32x16_bf16 v[112:127], v[60:63], v[216:219], v[112:127]
    v_max3_f32 v30, v30, v187, v188
    v_max3_f32 v30, v30, v189, v190
    v_max_f32 v30, v30, v191
    s_waitcnt vmcnt(5) lgkmcnt(0)
    s_barrier
    v_add_u32 v240, 65536, v14
    v_add_u32 v241, 65536, v15
    v_add_u32 v242, 65536, v16
    v_add_u32 v243, 65536, v17
    v_add_u32 v244, 65536, v18
    v_add_u32 v245, 65536, v19
    v_add_u32 v246, 65536, v20
    v_add_u32 v247, 65536, v21
    v_add_u32 v248, 65536, v22
    v_add_u32 v249, 65536, v23
    v_add_u32 v250, 65536, v24
    v_add_u32 v251, 65536, v25
    ds_read_b128 v[32:35], v240 offset:0
    ds_read_b128 v[36:39], v241 offset:0
    ds_read_b128 v[40:43], v242 offset:0
    ds_read_b128 v[44:47], v243 offset:0
    ds_read_b128 v[48:51], v244 offset:0
    ds_read_b128 v[52:55], v245 offset:0
    v_cmp_lt_f32 vcc, s51, v30
    s_cbranch_vccnz L_fix5
L_back5:
    s_waitcnt lgkmcnt(5)
    v_mfma_f32_32x32x16_bf16 v[192:207], v[32:35], v[128:131], v[224:239]
    ds_read_b128 v[56:59], v246 offset:0
    s_add_u32 m0, s42, 131072
    s_add_u32 s40, s53, 114688
    buffer_load_dwordx4 v6, s[12:15], s40 offen offset:0 lds
    buffer_load_dwordx4 v7, s[12:15], s40 offen offset:1024 lds
    s_waitcnt lgkmcnt(5)
    v_mfma_f32_32x32x16_bf16 v[192:207], v[36:39], v[132:135], v[192:207]
    ds_read_b128 v[60:63], v247 offset:0
    s_add_u32 m0, s42, 147456
    s_add_u32 s43, s53, 98304
    buffer_load_dwordx4 v8, s[72:75], s43 offen offset:0 lds
    s_waitcnt lgkmcnt(5)
    v_mfma_f32_32x32x16_bf16 v[192:207], v[40:43], v[136:139], v[192:207]
    ds_read_b128 v[32:35], v240 offset:8192
    buffer_load_dwordx4 v8, s[72:75], s43 offen offset:1024 lds
    v_exp_f32 v160, v160
    v_exp_f32 v161, v161
    s_waitcnt lgkmcnt(5)
    v_mfma_f32_32x32x16_bf16 v[192:207], v[44:47], v[140:143], v[192:207]
    ds_read_b128 v[36:39], v241 offset:8192
    v_exp_f32 v162, v162
    v_exp_f32 v163, v163
    v_exp_f32 v164, v164
    s_waitcnt lgkmcnt(5)
    v_mfma_f32_32x32x16_bf16 v[192:207], v[48:51], v[144:147], v[192:207]
    ds_read_b128 v[40:43], v242 offset:8192
    v_exp_f32 v165, v165
    v_exp_f32 v166, v166
    v_exp_f32 v167, v167
    v_add_f32 v27, v27, v160
    s_waitcnt lgkmcnt(5)
    v_mfma_f32_32x32x16_bf16 v[192:207], v[52:55], v[148:151], v[192:207]
    ds_read_b128 v[44:47], v243 offset:8192
    v_add_f32 v27, v27, v161
    v_add_f32 v27, v27, v162
    v_add_f32 v27, v27, v163
    s_waitcnt lgkmcnt(5)
    v_mfma_f32_32x32x16_bf16 v[192:207], v[56:59], v[152:155], v[192:207]
    ds_read_b128 v[48:51], v244 offset:8192
    v_add_f32 v27, v27, v164
    v_add_f32 v27, v27, v165
    v_add_f32 v27, v27, v166
    s_waitcnt lgkmcnt(5)
    v_mfma_f32_32x32x16_bf16 v[192:207], v[60:63], v[156:159], v[192:207]
    ds_read_b128 v[52:55], v245 offset:8192
    v_add_f32 v27, v27, v167
    v_cvt_pk_bf16_f32 v160, v160, v161
    v_cvt_pk_bf16_f32 v161, v162, v163
    s_waitcnt lgkmcnt(5)
    v_mfma_f32_32x32x16_bf16 v[208:223], v[32:35], v[128:131], v[224:239]
    ds_read_b128 v[56:59], v246 offset:8192
    v_cvt_pk_bf16_f32 v162, v164, v165
    v_cvt_pk_bf16_f32 v163, v166, v167
    v_exp_f32 v168, v168
    v_exp_f32 v169, v169
    s_waitcnt lgkmcnt(5)
    v_mfma_f32_32x32x16_bf16 v[208:223], v[36:39], v[132:135], v[208:223]
    ds_read_b128 v[60:63], v247 offset:8192
    v_exp_f32 v170, v170
    v_exp_f32 v171, v171
    v_exp_f32 v172, v172
    s_waitcnt lgkmcnt(5)
    v_mfma_f32_32x32x16_bf16 v[208:223], v[40:43], v[136:139], v[208:223]
    ds_read_b64_tr_b16 v[32:33], v248 offset:16384
    ds_read_b64_tr_b16 v[34:35], v248 offset:17408
    v_exp_f32 v173, v173
    v_exp_f32 v174, v174
    v_exp_f32 v175, v175
    s_waitcnt lgkmcnt(6)
    v_mfma_f32_32x32x16_bf16 v[208:223], v[44:47], v[140:143], v[208:223]
    ds_read_b64_tr_b16 v[36:37], v249 offset:16384
    ds_read_b64_tr_b16 v[38:39], v249 offset:17408
    v_add_f32 v27, v27, v168
    v_add_f32 v27, v27, v169
    v_add_f32 v27, v27, v170
    s_waitcnt lgkmcnt(7)
    v_mfma_f32_32x32x16_bf16 v[208:223], v[48:51], v[144:147], v[208:223]
    ds_read_b64_tr_b16 v[40:41], v250 offset:16384
    ds_read_b64_tr_b16 v[42:43], v250 offset:17408
    v_add_f32 v27, v27, v171
    v_add_f32 v27, v27, v172
    v_add_f32 v27, v27, v173
    v_add_f32 v27, v27, v174
    s_waitcnt lgkmcnt(8)
    v_mfma_f32_32x32x16_bf16 v[208:223], v[52:55], v[148:151], v[208:223]
    ds_read_b64_tr_b16 v[44:45], v251 offset:16384
    ds_read_b64_tr_b16 v[46:47], v251 offset:17408
    v_add_f32 v27, v27, v175
    v_cvt_pk_bf16_f32 v168, v168, v169
    v_cvt_pk_bf16_f32 v169, v170, v171
    s_waitcnt lgkmcnt(9)
    v_mfma_f32_32x32x16_bf16 v[208:223], v[56:59], v[152:155], v[208:223]
    ds_read_b64_tr_b16 v[48:49], v248 offset:20480
    ds_read_b64_tr_b16 v[50:51], v248 offset:21504
    v_cvt_pk_bf16_f32 v170, v172, v173
    v_cvt_pk_bf16_f32 v171, v174, v175
    v_exp_f32 v176, v176
    s_waitcnt lgkmcnt(10)
    v_mfma_f32_32x32x16_bf16 v[208:223], v[60:63], v[156:159], v[208:223]
    ds_read_b64_tr_b16 v[52:53], v249 offset:20480
    ds_read_b64_tr_b16 v[54:55], v249 offset:21504
    v_exp_f32 v177, v177
    v_exp_f32 v178, v178
    v_exp_f32 v179, v179
    s_waitcnt lgkmcnt(10)
    v_mfma_f32_32x32x16_bf16 v[64:79], v[32:35], v[160:163], v[64:79]
    ds_read_b64_tr_b16 v[56:57], v250 offset:20480
    ds_read_b64_tr_b16 v[58:59], v250 offset:21504
    v_exp_f32 v180, v180
    v_exp_f32 v181, v181
    v_exp_f32 v182, v182
    v_exp_f32 v183, v183
    s_waitcnt lgkmcnt(10)
    v_mfma_f32_32x32x16_bf16 v[80:95], v[36:39], v[160:163], v[80:95]
    ds_read_b64_tr_b16 v[60:61], v251 offset:20480
    ds_read_b64_tr_b16 v[62:63], v251 offset:21504
    v_add_f32 v27, v27, v176
    v_add_f32 v27, v27, v177
    v_add_f32 v27, v27, v178
    s_waitcnt lgkmcnt(10)
    v_mfma_f32_32x32x16_bf16 v[96:111], v[40:43], v[160:163], v[96:111]
    ds_read_b64_tr_b16 v[32:33], v248 offset:24576
    ds_read_b64_tr_b16 v[34:35], v248 offset:25600
    v_add_f32 v27, v27, v179
    v_add_f32 v27, v27, v180
    v_add_f32 v27, v27, v181
    s_waitcnt lgkmcnt(10)
    v_mfma_f32_32x32x16_bf16 v[112:127], v[44:47], v[160:163], v[112:127]
    ds_read_b64_tr_b16 v[36:37], v249 offset:24576
    ds_read_b64_tr_b16 v[38:39], v249 offset:25600
    v_add_f32 v27, v27, v182
    v_add_f32 v27, v27, v183
    v_cvt_pk_bf16_f32 v176, v176, v177
    s_waitcnt lgkmcnt(10)
    v_mfma_f32_32x32x16_bf16 v[64:79], v[48:51], v[168:171], v[64:79]
    ds_read_b64_tr_b16 v[40:41], v250 offset:24576
    ds_read_b64_tr_b16 v[42:43], v250 offset:25600
    v_cvt_pk_bf16_f32 v177, v178, v179
    v_cvt_pk_bf16_f32 v178, v180, v181
    v_cvt_pk_bf16_f32 v179, v182, v183
    v_exp_f32 v184, v184
    s_waitcnt lgkmcnt(10)
    v_mfma_f32_32x32x16_bf16 v[80:95], v[52:55], v[168:171], v[80:95]
    ds_read_b64_tr_b16 v[44:45], v251 offset:24576
    ds_read_b64_tr_b16 v[46:47], v251 offset:25600
    v_exp_f32 v185, v185
    v_exp_f32 v186, v186
    v_exp_f32 v187, v187
    s_waitcnt lgkmcnt(10)
    v_mfma_f32_32x32x16_bf16 v[96:111], v[56:59], v[168:171], v[96:111]
    ds_read_b64_tr_b16 v[48:49], v248 offset:28672
    ds_read_b64_tr_b16 v[50:51], v248 offset:29696
    v_exp_f32 v188, v188
    v_exp_f32 v189, v189
    v_exp_f32 v190, v190
    s_waitcnt lgkmcnt(10)
    v_mfma_f32_32x32x16_bf16 v[112:127], v[60:63], v[168:171], v[112:127]
    ds_read_b64_tr_b16 v[52:53], v249 offset:28672
    ds_read_b64_tr_b16 v[54:55], v249 offset:29696
    v_exp_f32 v191, v191
    v_add_f32 v27, v27, v184
    v_add_f32 v27, v27, v185
    s_waitcnt lgkmcnt(10)
    v_mfma_f32_32x32x16_bf16 v[64:79], v[32:35], v[176:179], v[64:79]
    ds_read_b64_tr_b16 v[56:57], v250 offset:28672
    ds_read_b64_tr_b16 v[58:59], v250 offset:29696
    v_add_f32 v27, v27, v186
    v_add_f32 v27, v27, v187
    v_add_f32 v27, v27, v188
    v_add_f32 v27, v27, v189
    s_waitcnt lgkmcnt(10)
    v_mfma_f32_32x32x16_bf16 v[80:95], v[36:39], v[176:179], v[80:95]
    ds_read_b64_tr_b16 v[60:61], v251 offset:28672
    ds_read_b64_tr_b16 v[62:63], v251 offset:29696
    v_add_f32 v27, v27, v190
    v_add_f32 v27, v27, v191
    v_cvt_pk_bf16_f32 v184, v184, v185
    s_waitcnt lgkmcnt(10)
    v_mfma_f32_32x32x16_bf16 v[96:111], v[40:43], v[176:179], v[96:111]
    v_cvt_pk_bf16_f32 v185, v186, v187
    v_cvt_pk_bf16_f32 v186, v188, v189
    v_cvt_pk_bf16_f32 v187, v190, v191
    s_waitcnt lgkmcnt(8)
    v_mfma_f32_32x32x16_bf16 v[112:127], v[44:47], v[176:179], v[112:127]
    v_max3_f32 v30, v192, v193, v194
    v_max3_f32 v30, v30, v195, v196
    v_max3_f32 v30, v30, v197, v198
    s_waitcnt lgkmcnt(6)
    v_mfma_f32_32x32x16_bf16 v[64:79], v[48:51], v[184:187], v[64:79]
    v_max3_f32 v30, v30, v199, v200
    v_max3_f32 v30, v30, v201, v202
    v_max3_f32 v30, v30, v203, v204
    v_max3_f32 v30, v30, v205, v206
    s_waitcnt lgkmcnt(4)
    v_mfma_f32_32x32x16_bf16 v[80:95], v[52:55], v[184:187], v[80:95]
    v_max3_f32 v30, v30, v207, v208
    v_max3_f32 v30, v30, v209, v210
    v_max3_f32 v30, v30, v211, v212
    s_waitcnt lgkmcnt(2)
    v_mfma_f32_32x32x16_bf16 v[96:111], v[56:59], v[184:187], v[96:111]
    v_max3_f32 v30, v30, v213, v214
    v_max3_f32 v30, v30, v215, v216
    v_max3_f32 v30, v30, v217, v218
    s_waitcnt lgkmcnt(0)
    v_mfma_f32_32x32x16_bf16 v[112:127], v[60:63], v[184:187], v[112:127]
    v_max3_f32 v30, v30, v219, v220
    v_max3_f32 v30, v30, v221, v222
    v_max_f32 v30, v30, v223
    s_waitcnt vmcnt(4) lgkmcnt(0)
    s_barrier
    v_add_u32 v240, 98304, v14
    v_add_u32 v241, 98304, v15
    v_add_u32 v242, 98304, v16
    v_add_u32 v243, 98304, v17
    v_add_u32 v244, 98304, v18
    v_add_u32 v245, 98304, v19
    v_add_u32 v246, 98304, v20
    v_add_u32 v247, 98304, v21
    v_add_u32 v248, 98304, v22
    v_add_u32 v249, 98304, v23
    v_add_u32 v250, 98304, v24
    v_add_u32 v251, 98304, v25
    ds_read_b128 v[32:35], v240 offset:0
    ds_read_b128 v[36:39], v241 offset:0
    ds_read_b128 v[40:43], v242 offset:0
    ds_read_b128 v[44:47], v243 offset:0
    ds_read_b128 v[48:51], v244 offset:0
    ds_read_b128 v[52:55], v245 offset:0
    v_readfirstlane_b32 s43, v255
    s_nop 0
    s_cmp_lt_u32 s43, 256
    s_cbranch_scc1 L_back_w
    s_lshl_b32 s40, s33, 3
    s_add_u32 s40, s40, s34
    v_lshlrev_b32 v253, 7, v1
    s_lshl_b32 s43, s40, 13
    buffer_load_dword v255, v253, s[8:11], s43 offen sc1
L_back_w:
    v_cmp_lt_f32 vcc, s51, v30
    s_cbranch_vccnz L_fix6
L_back6:
    s_waitcnt lgkmcnt(5)
    v_mfma_f32_32x32x16_bf16 v[160:175], v[32:35], v[128:131], v[224:239]
    ds_read_b128 v[56:59], v246 offset:0
    s_lshl_b32 s40, s33, 3
    s_add_u32 s40, s40, s34
    v_lshrrev_b32 v252, 2, v1
    v_and_b32 v252, 7, v252
    s_waitcnt lgkmcnt(5)
    v_mfma_f32_32x32x16_bf16 v[160:175], v[36:39], v[132:135], v[160:175]
    ds_read_b128 v[60:63], v247 offset:0
    s_mov_b32 s43, 3584
    v_mul_lo_u32 v252, v252, s43
    v_and_b32 v253, 3, v1
    v_lshlrev_b32 v253, 3, v253
    s_waitcnt lgkmcnt(5)
    v_mfma_f32_32x32x16_bf16 v[160:175], v[40:43], v[136:139], v[160:175]
    ds_read_b128 v[32:35], v240 offset:8192
    v_add_u32 v253, s32, v253
    s_lshr_b32 s55, s32, 1
    s_add_u32 s55, s55, 24
    s_waitcnt lgkmcnt(5)
    v_mfma_f32_32x32x16_bf16 v[160:175], v[44:47], v[140:143], v[160:175]
    ds_read_b128 v[36:39], v241 offset:8192
    v_min_u32 v253, s55, v253
    v_lshl_add_u32 v252, v253, 7, v252
    s_mul_i32 s43, s40, 28672
    buffer_load_dword v254, v252, s[16:19], s43 offen
    s_waitcnt lgkmcnt(5)
    v_mfma_f32_32x32x16_bf16 v[160:175], v[48:51], v[144:147], v[160:175]
    ds_read_b128 v[40:43], v242 offset:8192
    s_add_u32 m0, s42, 81920
    s_add_u32 s43, s53, 114688
    buffer_load_dwordx4 v8, s[72:75], s43 offen offset:0 lds
    s_waitcnt lgkmcnt(5)
    v_mfma_f32_32x32x16_bf16 v[160:175], v[52:55], v[148:151], v[160:175]
    ds_read_b128 v[44:47], v243 offset:8192
    buffer_load_dwordx4 v8, s[72:75], s43 offen offset:1024 lds
    v_exp_f32 v192, v192
    v_exp_f32 v193, v193
    v_exp_f32 v194, v194
    s_waitcnt lgkmcnt(5)
    v_mfma_f32_32x32x16_bf16 v[160:175], v[56:59], v[152:155], v[160:175]
    ds_read_b128 v[48:51], v244 offset:8192
    v_exp_f32 v195, v195
    v_exp_f32 v196, v196
    v_exp_f32 v197, v197
    v_exp_f32 v198, v198
    s_waitcnt lgkmcnt(5)
    v_mfma_f32_32x32x16_bf16 v[160:175], v[60:63], v[156:159], v[160:175]
    ds_read_b128 v[52:55], v245 offset:8192
    v_exp_f32 v199, v199
    v_add_f32 v27, v27, v192
    v_add_f32 v27, v27, v193
    s_waitcnt lgkmcnt(5)
    v_mfma_f32_32x32x16_bf16 v[176:191], v[32:35], v[128:131], v[224:239]
    ds_read_b128 v[56:59], v246 offset:8192
    v_add_f32 v27, v27, v194
    v_add_f32 v27, v27, v195
    v_add_f32 v27, v27, v196
    v_add_f32 v27, v27, v197
    s_waitcnt lgkmcnt(5)
    v_mfma_f32_32x32x16_bf16 v[176:191], v[36:39], v[132:135], v[176:191]
    ds_read_b128 v[60:63], v247 offset:8192
    v_add_f32 v27, v27, v198
    v_add_f32 v27, v27, v199
    v_cvt_pk_bf16_f32 v192, v192, v193
    s_waitcnt lgkmcnt(5)
    v_mfma_f32_32x32x16_bf16 v[176:191], v[40:43], v[136:139], v[176:191]
    ds_read_b64_tr_b16 v[32:33], v248 offset:16384
    ds_read_b64_tr_b16 v[34:35], v248 offset:17408
    v_cvt_pk_bf16_f32 v193, v194, v195
    v_cvt_pk_bf16_f32 v194, v196, v197
    v_cvt_pk_bf16_f32 v195, v198, v199
    v_exp_f32 v200, v200
    s_waitcnt lgkmcnt(6)
    v_mfma_f32_32x32x16_bf16 v[176:191], v[44:47], v[140:143], v[176:191]
    ds_read_b64_tr_b16 v[36:37], v249 offset:16384
    ds_read_b64_tr_b16 v[38:39], v249 offset:17408
    v_exp_f32 v201, v201
    v_exp_f32 v202, v202
    v_exp_f32 v203, v203
    v_exp_f32 v204, v204
    s_waitcnt lgkmcnt(7)
    v_mfma_f32_32x32x16_bf16 v[176:191], v[48:51], v[144:147], v[176:191]
    ds_read_b64_tr_b16 v[40:41], v250 offset:16384
    ds_read_b64_tr_b16 v[42:43], v250 offset:17408
    v_exp_f32 v205, v205
    v_exp_f32 v206, v206
    v_exp_f32 v207, v207
    s_waitcnt lgkmcnt(8)
    v_mfma_f32_32x32x16_bf16 v[176:191], v[52:55], v[148:151], v[176:191]
    ds_read_b64_tr_b16 v[44:45], v251 offset:16384
    ds_read_b64_tr_b16 v[46:47], v251 offset:17408
    v_add_f32 v27, v27, v200
    v_add_f32 v27, v27, v201
    v_add_f32 v27, v27, v202
    v_add_f32 v27, v27, v203
    s_waitcnt lgkmcnt(9)
    v_mfma_f32_32x32x16_bf16 v[176:191], v[56:59], v[152:155], v[176:191]
    ds_read_b64_tr_b16 v[48:49], v248 offset:20480
    ds_read_b64_tr_b16 v[50:51], v248 offset:21504
    v_add_f32 v27, v27, v204
    v_add_f32 v27, v27, v205
    v_add_f32 v27, v27, v206
    s_waitcnt lgkmcnt(10)
    v_mfma_f32_32x32x16_bf16 v[176:191], v[60:63], v[156:159], v[176:191]
    ds_read_b64_tr_b16 v[52:53], v249 offset:20480
    ds_read_b64_tr_b16 v[54:55], v249 offset:21504
    v_add_f32 v27, v27, v207
    v_cvt_pk_bf16_f32 v200, v200, v201
    v_cvt_pk_bf16_f32 v201, v202, v203
    v_cvt_pk_bf16_f32 v202, v204, v205
    s_waitcnt lgkmcnt(10)
    v_mfma_f32_32x32x16_bf16 v[64:79], v[32:35], v[192:195], v[64:79]
    ds_read_b64_tr_b16 v[56:57], v250 offset:20480
    ds_read_b64_tr_b16 v[58:59], v250 offset:21504
    v_cvt_pk_bf16_f32 v203, v206, v207
    v_exp_f32 v208, v208
    v_exp_f32 v209, v209
    v_exp_f32 v210, v210
    s_waitcnt lgkmcnt(10)
    v_mfma_f32_32x32x16_bf16 v[80:95], v[36:39], v[192:195], v[80:95]
    ds_read_b64_tr_b16 v[60:61], v251 offset:20480
    ds_read_b64_tr_b16 v[62:63], v251 offset:21504
    v_exp_f32 v211, v211
    v_exp_f32 v212, v212
    v_exp_f32 v213, v213
    s_waitcnt lgkmcnt(10)
    v_mfma_f32_32x32x16_bf16 v[96:111], v[40:43], v[192:195], v[96:111]
    ds_read_b64_tr_b16 v[32:33], v248 offset:24576
    ds_read_b64_tr_b16 v[34:35], v248 offset:25600
    v_exp_f32 v214, v214
    v_exp_f32 v215, v215
    v_add_f32 v27, v27, v208
    v_add_f32 v27, v27, v209
    s_waitcnt lgkmcnt(10)
    v_mfma_f32_32x32x16_bf16 v[112:127], v[44:47], v[192:195], v[112:127]
    ds_read_b64_tr_b16 v[36:37], v249 offset:24576
    ds_read_b64_tr_b16 v[38:39], v249 offset:25600
    v_add_f32 v27, v27, v210
    v_add_f32 v27, v27, v211
    v_add_f32 v27, v27, v212
    s_waitcnt lgkmcnt(10)
    v_mfma_f32_32x32x16_bf16 v[64:79], v[48:51], v[200:203], v[64:79]
    ds_read_b64_tr_b16 v[40:41], v250 offset:24576
    ds_read_b64_tr_b16 v[42:43], v250 offset:25600
    v_add_f32 v27, v27, v213
    v_add_f32 v27, v27, v214
    v_add_f32 v27, v27, v215
    v_cvt_pk_bf16_f32 v208, v208, v209
    s_waitcnt lgkmcnt(10)
    v_mfma_f32_32x32x16_bf16 v[80:95], v[52:55], v[200:203], v[80:95]
    ds_read_b64_tr_b16 v[44:45], v251 offset:24576
    ds_read_b64_tr_b16 v[46:47], v251 offset:25600
    v_cvt_pk_bf16_f32 v209, v210, v211
    v_cvt_pk_bf16_f32 v210, v212, v213
    v_cvt_pk_bf16_f32 v211, v214, v215
    v_exp_f32 v216, v216
    s_waitcnt lgkmcnt(10)
    v_mfma_f32_32x32x16_bf16 v[96:111], v[56:59], v[200:203], v[96:111]
    ds_read_b64_tr_b16 v[48:49], v248 offset:28672
    ds_read_b64_tr_b16 v[50:51], v248 offset:29696
    v_exp_f32 v217, v217
    v_exp_f32 v218, v218
    v_exp_f32 v219, v219
    s_waitcnt lgkmcnt(10)
    v_mfma_f32_32x32x16_bf16 v[112:127], v[60:63], v[200:203], v[112:127]
    ds_read_b64_tr_b16 v[52:53], v249 offset:28672
    ds_read_b64_tr_b16 v[54:55], v249 offset:29696
    v_exp_f32 v220, v220
    v_exp_f32 v221, v221
    v_exp_f32 v222, v222
    v_exp_f32 v223, v223
    s_waitcnt lgkmcnt(10)
    v_mfma_f32_32x32x16_bf16 v[64:79], v[32:35], v[208:211], v[64:79]
    ds_read_b64_tr_b16 v[56:57], v250 offset:28672
    ds_read_b64_tr_b16 v[58:59], v250 offset:29696
    v_add_f32 v27, v27, v216
    v_add_f32 v27, v27, v217
    v_add_f32 v27, v27, v218
    s_waitcnt lgkmcnt(10)
    v_mfma_f32_32x32x16_bf16 v[80:95], v[36:39], v[208:211], v[80:95]
    ds_read_b64_tr_b16 v[60:61], v251 offset:28672
    ds_read_b64_tr_b16 v[62:63], v251 offset:29696
    v_add_f32 v27, v27, v219
    v_add_f32 v27, v27, v220
    v_add_f32 v27, v27, v221
    v_add_f32 v27, v27, v222
    s_waitcnt lgkmcnt(10)
    v_mfma_f32_32x32x16_bf16 v[96:111], v[40:43], v[208:211], v[96:111]
    v_add_f32 v27, v27, v223
    v_cvt_pk_bf16_f32 v216, v216, v217
    v_cvt_pk_bf16_f32 v217, v218, v219
    v_cvt_pk_bf16_f32 v218, v220, v221
    s_waitcnt lgkmcnt(8)
    v_mfma_f32_32x32x16_bf16 v[112:127], v[44:47], v[208:211], v[112:127]
    v_cvt_pk_bf16_f32 v219, v222, v223
    v_max3_f32 v30, v160, v161, v162
    v_max3_f32 v30, v30, v163, v164
    s_waitcnt lgkmcnt(6)
    v_mfma_f32_32x32x16_bf16 v[64:79], v[48:51], v[216:219], v[64:79]
    v_max3_f32 v30, v30, v165, v166
    v_max3_f32 v30, v30, v167, v168
    v_max3_f32 v30, v30, v169, v170
    v_max3_f32 v30, v30, v171, v172
    s_waitcnt lgkmcnt(4)
    v_mfma_f32_32x32x16_bf16 v[80:95], v[52:55], v[216:219], v[80:95]
    v_max3_f32 v30, v30, v173, v174
    v_max3_f32 v30, v30, v175, v176
    v_max3_f32 v30, v30, v177, v178
    s_waitcnt lgkmcnt(2)
    v_mfma_f32_32x32x16_bf16 v[96:111], v[56:59], v[216:219], v[96:111]
    v_max3_f32 v30, v30, v179, v180
    v_max3_f32 v30, v30, v181, v182
    v_max3_f32 v30, v30, v183, v184
    v_max3_f32 v30, v30, v185, v186
    s_waitcnt lgkmcnt(0)
    v_mfma_f32_32x32x16_bf16 v[112:127], v[60:63], v[216:219], v[112:127]
    v_max3_f32 v30, v30, v187, v188
    v_max3_f32 v30, v30, v189, v190
    v_max_f32 v30, v30, v191
    s_waitcnt vmcnt(3) lgkmcnt(0)
    s_barrier
    v_add_u32 v240, 131072, v14
    v_add_u32 v241, 131072, v15
    v_add_u32 v242, 131072, v16
    v_add_u32 v243, 131072, v17
    v_add_u32 v244, 131072, v18
    v_add_u32 v245, 131072, v19
    v_add_u32 v246, 131072, v20
    v_add_u32 v247, 131072, v21
    v_add_u32 v248, 131072, v22
    v_add_u32 v249, 131072, v23
    v_add_u32 v250, 131072, v24
    v_add_u32 v251, 131072, v25
    ds_read_b128 v[32:35], v240 offset:0
    ds_read_b128 v[36:39], v241 offset:0
    ds_read_b128 v[40:43], v242 offset:0
    ds_read_b128 v[44:47], v243 offset:0
    ds_read_b128 v[48:51], v244 offset:0
    ds_read_b128 v[52:55], v245 offset:0
    v_cmp_lt_f32 vcc, s51, v30
    s_cbranch_vccnz L_fix7
L_back7:
    s_waitcnt lgkmcnt(5)
    v_mfma_f32_32x32x16_bf16 v[192:207], v[32:35], v[128:131], v[224:239]
    ds_read_b128 v[56:59], v246 offset:0
    s_add_u32 m0, s41, 98304
    s_add_u32 s40, s54, 0
    buffer_load_dwordx4 v2, s[24:27], s40 offen offset:0 lds
    buffer_load_dwordx4 v3, s[24:27], s40 offen offset:1024 lds
    s_waitcnt lgkmcnt(5)
    v_mfma_f32_32x32x16_bf16 v[192:207], v[36:39], v[132:135], v[192:207]
    ds_read_b128 v[60:63], v247 offset:0
    buffer_load_dwordx4 v4, s[24:27], s40 offen offset:2048 lds
    buffer_load_dwordx4 v5, s[24:27], s40 offen offset:3072 lds
    v_exp_f32 v160, v160
    s_waitcnt lgkmcnt(5)
    v_mfma_f32_32x32x16_bf16 v[192:207], v[40:43], v[136:139], v[192:207]
    ds_read_b128 v[32:35], v240 offset:8192
    v_exp_f32 v161, v161
    v_exp_f32 v162, v162
    v_exp_f32 v163, v163
    s_waitcnt lgkmcnt(5)
    v_mfma_f32_32x32x16_bf16 v[192:207], v[44:47], v[140:143], v[192:207]
    ds_read_b128 v[36:39], v241 offset:8192
    v_exp_f32 v164, v164
    v_exp_f32 v165, v165
    v_exp_f32 v166, v166
    s_waitcnt lgkmcnt(5)
    v_mfma_f32_32x32x16_bf16 v[192:207], v[48:51], v[144:147], v[192:207]
    ds_read_b128 v[40:43], v242 offset:8192
    v_exp_f32 v167, v167
    v_add_f32 v27, v27, v160
    v_add_f32 v27, v27, v161
    s_waitcnt lgkmcnt(5)
    v_mfma_f32_32x32x16_bf16 v[192:207], v[52:55], v[148:151], v[192:207]
    ds_read_b128 v[44:47], v243 offset:8192
    v_add_f32 v27, v27, v162
    v_add_f32 v27, v27, v163
    v_add_f32 v27, v27, v164
    v_add_f32 v27, v27, v165
    s_waitcnt lgkmcnt(5)
    v_mfma_f32_32x32x16_bf16 v[192:207], v[56:59], v[152:155], v[192:207]
    ds_read_b128 v[48:51], v244 offset:8192
    v_add_f32 v27, v27, v166
    v_add_f32 v27, v27, v167
    v_cvt_pk_bf16_f32 v160, v160, v161
    s_waitcnt lgkmcnt(5)
    v_mfma_f32_32x32x16_bf16 v[192:207], v[60:63], v[156:159], v[192:207]
    ds_read_b128 v[52:55], v245 offset:8192
    v_cvt_pk_bf16_f32 v161, v162, v163
    v_cvt_pk_bf16_f32 v162, v164, v165
    v_cvt_pk_bf16_f32 v163, v166, v167
    s_waitcnt lgkmcnt(5)
    v_mfma_f32_32x32x16_bf16 v[208:223], v[32:35], v[128:131], v[224:239]
    ds_read_b128 v[56:59], v246 offset:8192
    v_exp_f32 v168, v168
    v_exp_f32 v169, v169
    v_exp_f32 v170, v170
    s_waitcnt lgkmcnt(5)
    v_mfma_f32_32x32x16_bf16 v[208:223], v[36:39], v[132:135], v[208:223]
    ds_read_b128 v[60:63], v247 offset:8192
    v_exp_f32 v171, v171
    v_exp_f32 v172, v172
    v_exp_f32 v173, v173
    s_waitcnt lgkmcnt(5)
    v_mfma_f32_32x32x16_bf16 v[208:223], v[40:43], v[136:139], v[208:223]
    ds_read_b64_tr_b16 v[32:33], v248 offset:16384
    ds_read_b64_tr_b16 v[34:35], v248 offset:17408
    v_exp_f32 v174, v174
    v_exp_f32 v175, v175
    v_add_f32 v27, v27, v168
    v_add_f32 v27, v27, v169
    s_waitcnt lgkmcnt(6)
    v_mfma_f32_32x32x16_bf16 v[208:223], v[44:47], v[140:143], v[208:223]
    ds_read_b64_tr_b16 v[36:37], v249 offset:16384
    ds_read_b64_tr_b16 v[38:39], v249 offset:17408
    v_add_f32 v27, v27, v170
    v_add_f32 v27, v27, v171
    v_add_f32 v27, v27, v172
    s_waitcnt lgkmcnt(7)
    v_mfma_f32_32x32x16_bf16 v[208:223], v[48:51], v[144:147], v[208:223]
    ds_read_b64_tr_b16 v[40:41], v250 offset:16384
    ds_read_b64_tr_b16 v[42:43], v250 offset:17408
    v_add_f32 v27, v27, v173
    v_add_f32 v27, v27, v174
    v_add_f32 v27, v27, v175
    s_waitcnt lgkmcnt(8)
    v_mfma_f32_32x32x16_bf16 v[208:223], v[52:55], v[148:151], v[208:223]
    ds_read_b64_tr_b16 v[44:45], v251 offset:16384
    ds_read_b64_tr_b16 v[46:47], v251 offset:17408
    v_cvt_pk_bf16_f32 v168, v168, v169
    v_cvt_pk_bf16_f32 v169, v170, v171
    v_cvt_pk_bf16_f32 v170, v172, v173
    s_waitcnt lgkmcnt(9)
    v_mfma_f32_32x32x16_bf16 v[208:223], v[56:59], v[152:155], v[208:223]
    ds_read_b64_tr_b16 v[48:49], v248 offset:20480
    ds_read_b64_tr_b16 v[50:51], v248 offset:21504
    v_cvt_pk_bf16_f32 v171, v174, v175
    v_exp_f32 v176, v176
    v_exp_f32 v177, v177
    s_waitcnt lgkmcnt(10)
    v_mfma_f32_32x32x16_bf16 v[208:223], v[60:63], v[156:159], v[208:223]
    ds_read_b64_tr_b16 v[52:53], v249 offset:20480
    ds_read_b64_tr_b16 v[54:55], v249 offset:21504
    v_exp_f32 v178, v178
    v_exp_f32 v179, v179
    v_exp_f32 v180, v180
    s_waitcnt lgkmcnt(10)
    v_mfma_f32_32x32x16_bf16 v[64:79], v[32:35], v[160:163], v[64:79]
    ds_read_b64_tr_b16 v[56:57], v250 offset:20480
    ds_read_b64_tr_b16 v[58:59], v250 offset:21504
    v_exp_f32 v181, v181
    v_exp_f32 v182, v182
    v_exp_f32 v183, v183
    v_add_f32 v27, v27, v176
    s_waitcnt lgkmcnt(10)
    v_mfma_f32_32x32x16_bf16 v[80:95], v[36:39], v[160:163], v[80:95]
    ds_read_b64_tr_b16 v[60:61], v251 offset:20480
    ds_read_b64_tr_b16 v[62:63], v251 offset:21504
    v_add_f32 v27, v27, v177
    v_add_f32 v27, v27, v178
    v_add_f32 v27, v27, v179
    s_waitcnt lgkmcnt(10)
    v_mfma_f32_32x32x16_bf16 v[96:111], v[40:43], v[160:163], v[96:111]
    ds_read_b64_tr_b16 v[32:33], v248 offset:24576
    ds_read_b64_tr_b16 v[34:35], v248 offset:25600
    v_add_f32 v27, v27, v180
    v_add_f32 v27, v27, v181
    v_add_f32 v27, v27, v182
    s_waitcnt lgkmcnt(10)
    v_mfma_f32_32x32x16_bf16 v[112:127], v[44:47], v[160:163], v[112:127]
    ds_read_b64_tr_b16 v[36:37], v249 offset:24576
    ds_read_b64_tr_b16 v[38:39], v249 offset:25600
    v_add_f32 v27, v27, v183
    v_cvt_pk_bf16_f32 v176, v176, v177
    v_cvt_pk_bf16_f32 v177, v178, v179
    s_waitcnt lgkmcnt(10)
    v_mfma_f32_32x32x16_bf16 v[64:79], v[48:51], v[168:171], v[64:79]
    ds_read_b64_tr_b16 v[40:41], v250 offset:24576
    ds_read_b64_tr_b16 v[42:43], v250 offset:25600
    v_cvt_pk_bf16_f32 v178, v180, v181
    v_cvt_pk_bf16_f32 v179, v182, v183
    v_exp_f32 v184, v184
    s_waitcnt lgkmcnt(10)
    v_mfma_f32_32x32x16_bf16 v[80:95], v[52:55], v[168:171], v[80:95]
    ds_read_b64_tr_b16 v[44:45], v251 offset:24576
    ds_read_b64_tr_b16 v[46:47], v251 offset:25600
    v_exp_f32 v185, v185
    v_exp_f32 v186, v186
    v_exp_f32 v187, v187
    v_exp_f32 v188, v188
    s_waitcnt lgkmcnt(10)
    v_mfma_f32_32x32x16_bf16 v[96:111], v[56:59], v[168:171], v[96:111]
    ds_read_b64_tr_b16 v[48:49], v248 offset:28672
    ds_read_b64_tr_b16 v[50:51], v248 offset:29696
    v_exp_f32 v189, v189
    v_exp_f32 v190, v190
    v_exp_f32 v191, v191
    s_waitcnt lgkmcnt(10)
    v_mfma_f32_32x32x16_bf16 v[112:127], v[60:63], v[168:171], v[112:127]
    ds_read_b64_tr_b16 v[52:53], v249 offset:28672
    ds_read_b64_tr_b16 v[54:55], v249 offset:29696
    v_add_f32 v27, v27, v184
    v_add_f32 v27, v27, v185
    v_add_f32 v27, v27, v186
    s_waitcnt lgkmcnt(10)
    v_mfma_f32_32x32x16_bf16 v[64:79], v[32:35], v[176:179], v[64:79]
    ds_read_b64_tr_b16 v[56:57], v250 offset:28672
    ds_read_b64_tr_b16 v[58:59], v250 offset:29696
    v_add_f32 v27, v27, v187
    v_add_f32 v27, v27, v188
    v_add_f32 v27, v27, v189
    s_waitcnt lgkmcnt(10)
    v_mfma_f32_32x32x16_bf16 v[80:95], v[36:39], v[176:179], v[80:95]
    ds_read_b64_tr_b16 v[60:61], v251 offset:28672
    ds_read_b64_tr_b16 v[62:63], v251 offset:29696
    v_add_f32 v27, v27, v190
    v_add_f32 v27, v27, v191
    v_cvt_pk_bf16_f32 v184, v184, v185
    s_waitcnt lgkmcnt(10)
    v_mfma_f32_32x32x16_bf16 v[96:111], v[40:43], v[176:179], v[96:111]
    v_cvt_pk_bf16_f32 v185, v186, v187
    v_cvt_pk_bf16_f32 v186, v188, v189
    v_cvt_pk_bf16_f32 v187, v190, v191
    v_max3_f32 v30, v192, v193, v194
    s_waitcnt lgkmcnt(8)
    v_mfma_f32_32x32x16_bf16 v[112:127], v[44:47], v[176:179], v[112:127]
    v_max3_f32 v30, v30, v195, v196
    v_max3_f32 v30, v30, v197, v198
    v_max3_f32 v30, v30, v199, v200
    s_waitcnt lgkmcnt(6)
    v_mfma_f32_32x32x16_bf16 v[64:79], v[48:51], v[184:187], v[64:79]
    v_max3_f32 v30, v30, v201, v202
    v_max3_f32 v30, v30, v203, v204
    v_max3_f32 v30, v30, v205, v206
    s_waitcnt lgkmcnt(4)
    v_mfma_f32_32x32x16_bf16 v[80:95], v[52:55], v[184:187], v[80:95]
    v_max3_f32 v30, v30, v207, v208
    v_max3_f32 v30, v30, v209, v210
    v_max3_f32 v30, v30, v211, v212
    s_waitcnt lgkmcnt(2)
    v_mfma_f32_32x32x16_bf16 v[96:111], v[56:59], v[184:187], v[96:111]
    v_max3_f32 v30, v30, v213, v214
    v_max3_f32 v30, v30, v215, v216
    v_max3_f32 v30, v30, v217, v218
    s_waitcnt lgkmcnt(0)
    v_mfma_f32_32x32x16_bf16 v[112:127], v[60:63], v[184:187], v[112:127]
    v_max3_f32 v30, v30, v219, v220
    v_max3_f32 v30, v30, v221, v222
    v_max_f32 v30, v30, v223
    s_waitcnt vmcnt(4) lgkmcnt(0)
    s_barrier
    v_add_u32 v248, 65536, v22
    v_add_u32 v249, 65536, v23
    v_add_u32 v250, 65536, v24
    v_add_u32 v251, 65536, v25
    ds_read_b64_tr_b16 v[32:33], v248 offset:16384
    ds_read_b64_tr_b16 v[34:35], v248 offset:17408
    ds_read_b64_tr_b16 v[36:37], v249 offset:16384
    ds_read_b64_tr_b16 v[38:39], v249 offset:17408
    ds_read_b64_tr_b16 v[40:41], v250 offset:16384
    ds_read_b64_tr_b16 v[42:43], v250 offset:17408
    ds_read_b64_tr_b16 v[44:45], v251 offset:16384
    ds_read_b64_tr_b16 v[46:47], v251 offset:17408
    ds_read_b64_tr_b16 v[48:49], v248 offset:20480
    ds_read_b64_tr_b16 v[50:51], v248 offset:21504
    ds_read_b64_tr_b16 v[52:53], v249 offset:20480
    ds_read_b64_tr_b16 v[54:55], v249 offset:21504
    v_cmp_lt_f32 vcc, s51, v30
    s_cbranch_vccnz L_fix8
L_back8:
    s_add_u32 m0, s41, 131072
    s_add_u32 s40, s54, 32768
    buffer_load_dwordx4 v2, s[24:27], s40 offen offset:0 lds
    buffer_load_dwordx4 v3, s[24:27], s40 offen offset:1024 lds
    buffer_load_dwordx4 v4, s[24:27], s40 offen offset:2048 lds
    buffer_load_dwordx4 v5, s[24:27], s40 offen offset:3072 lds
    v_exp_f32 v192, v192
    v_exp_f32 v193, v193
    v_exp_f32 v194, v194
    v_exp_f32 v195, v195
    v_exp_f32 v196, v196
    v_exp_f32 v197, v197
    v_exp_f32 v198, v198
    v_exp_f32 v199, v199
    v_add_f32 v27, v27, v192
    v_add_f32 v27, v27, v193
    v_add_f32 v27, v27, v194
    v_add_f32 v27, v27, v195
    v_add_f32 v27, v27, v196
    v_add_f32 v27, v27, v197
    v_add_f32 v27, v27, v198
    v_add_f32 v27, v27, v199
    v_cvt_pk_bf16_f32 v192, v192, v193
    v_cvt_pk_bf16_f32 v193, v194, v195
    v_cvt_pk_bf16_f32 v194, v196, v197
    v_cvt_pk_bf16_f32 v195, v198, v199
    s_waitcnt lgkmcnt(10)
    s_nop 0
    v_mfma_f32_32x32x16_bf16 v[64:79], v[32:35], v[192:195], v[64:79]
    ds_read_b64_tr_b16 v[56:57], v250 offset:20480
    ds_read_b64_tr_b16 v[58:59], v250 offset:21504
    s_waitcnt lgkmcnt(10)
    v_mfma_f32_32x32x16_bf16 v[80:95], v[36:39], v[192:195], v[80:95]
    ds_read_b64_tr_b16 v[60:61], v251 offset:20480
    ds_read_b64_tr_b16 v[62:63], v251 offset:21504
    s_waitcnt lgkmcnt(10)
    v_mfma_f32_32x32x16_bf16 v[96:111], v[40:43], v[192:195], v[96:111]
    ds_read_b64_tr_b16 v[32:33], v248 offset:24576
    ds_read_b64_tr_b16 v[34:35], v248 offset:25600
    s_waitcnt lgkmcnt(10)
    v_mfma_f32_32x32x16_bf16 v[112:127], v[44:47], v[192:195], v[112:127]
    ds_read_b64_tr_b16 v[36:37], v249 offset:24576
    ds_read_b64_tr_b16 v[38:39], v249 offset:25600
    v_exp_f32 v200, v200
    v_exp_f32 v201, v201
    v_exp_f32 v202, v202
    v_exp_f32 v203, v203
    v_exp_f32 v204, v204
    v_exp_f32 v205, v205
    v_exp_f32 v206, v206
    v_exp_f32 v207, v207
    v_add_f32 v27, v27, v200
    v_add_f32 v27, v27, v201
    v_add_f32 v27, v27, v202
    v_add_f32 v27, v27, v203
    v_add_f32 v27, v27, v204
    v_add_f32 v27, v27, v205
    v_add_f32 v27, v27, v206
    v_add_f32 v27, v27, v207
    v_cvt_pk_bf16_f32 v200, v200, v201
    v_cvt_pk_bf16_f32 v201, v202, v203
    v_cvt_pk_bf16_f32 v202, v204, v205
    v_cvt_pk_bf16_f32 v203, v206, v207
    s_waitcnt lgkmcnt(10)
    s_nop 0
    v_mfma_f32_32x32x16_bf16 v[64:79], v[48:51], v[200:203], v[64:79]
    ds_read_b64_tr_b16 v[40:41], v250 offset:24576
    ds_read_b64_tr_b16 v[42:43], v250 offset:25600
    s_waitcnt lgkmcnt(10)
    v_mfma_f32_32x32x16_bf16 v[80:95], v[52:55], v[200:203], v[80:95]
    ds_read_b64_tr_b16 v[44:45], v251 offset:24576
    ds_read_b64_tr_b16 v[46:47], v251 offset:25600
    s_waitcnt lgkmcnt(10)
    v_mfma_f32_32x32x16_bf16 v[96:111], v[56:59], v[200:203], v[96:111]
    ds_read_b64_tr_b16 v[48:49], v248 offset:28672
    ds_read_b64_tr_b16 v[50:51], v248 offset:29696
    s_waitcnt lgkmcnt(10)
    v_mfma_f32_32x32x16_bf16 v[112:127], v[60:63], v[200:203], v[112:127]
    ds_read_b64_tr_b16 v[52:53], v249 offset:28672
    ds_read_b64_tr_b16 v[54:55], v249 offset:29696
    v_exp_f32 v208, v208
    v_exp_f32 v209, v209
    v_exp_f32 v210, v210
    v_exp_f32 v211, v211
    v_exp_f32 v212, v212
    v_exp_f32 v213, v213
    v_exp_f32 v214, v214
    v_exp_f32 v215, v215
    v_add_f32 v27, v27, v208
    v_add_f32 v27, v27, v209
    v_add_f32 v27, v27, v210
    v_add_f32 v27, v27, v211
    v_add_f32 v27, v27, v212
    v_add_f32 v27, v27, v213
    v_add_f32 v27, v27, v214
    v_add_f32 v27, v27, v215
    v_cvt_pk_bf16_f32 v208, v208, v209
    v_cvt_pk_bf16_f32 v209, v210, v211
    v_cvt_pk_bf16_f32 v210, v212, v213
    v_cvt_pk_bf16_f32 v211, v214, v215
    s_waitcnt lgkmcnt(10)
    s_nop 0
    v_mfma_f32_32x32x16_bf16 v[64:79], v[32:35], v[208:211], v[64:79]
    ds_read_b64_tr_b16 v[56:57], v250 offset:28672
    ds_read_b64_tr_b16 v[58:59], v250 offset:29696
    s_waitcnt lgkmcnt(10)
    v_mfma_f32_32x32x16_bf16 v[80:95], v[36:39], v[208:211], v[80:95]
    ds_read_b64_tr_b16 v[60:61], v251 offset:28672
    ds_read_b64_tr_b16 v[62:63], v251 offset:29696
    s_waitcnt lgkmcnt(10)
    v_mfma_f32_32x32x16_bf16 v[96:111], v[40:43], v[208:211], v[96:111]
    s_waitcnt lgkmcnt(8)
    v_mfma_f32_32x32x16_bf16 v[112:127], v[44:47], v[208:211], v[112:127]
    v_exp_f32 v216, v216
    v_exp_f32 v217, v217
    v_exp_f32 v218, v218
    v_exp_f32 v219, v219
    v_exp_f32 v220, v220
    v_exp_f32 v221, v221
    v_exp_f32 v222, v222
    v_exp_f32 v223, v223
    v_add_f32 v27, v27, v216
    v_add_f32 v27, v27, v217
    v_add_f32 v27, v27, v218
    v_add_f32 v27, v27, v219
    v_add_f32 v27, v27, v220
    v_add_f32 v27, v27, v221
    v_add_f32 v27, v27, v222
    v_add_f32 v27, v27, v223
    v_cvt_pk_bf16_f32 v216, v216, v217
    v_cvt_pk_bf16_f32 v217, v218, v219
    v_cvt_pk_bf16_f32 v218, v220, v221
    v_cvt_pk_bf16_f32 v219, v222, v223
    s_waitcnt lgkmcnt(6)
    s_nop 0
    v_mfma_f32_32x32x16_bf16 v[64:79], v[48:51], v[216:219], v[64:79]
    s_waitcnt lgkmcnt(4)
    v_mfma_f32_32x32x16_bf16 v[80:95], v[52:55], v[216:219], v[80:95]
    s_waitcnt lgkmcnt(2)
    v_mfma_f32_32x32x16_bf16 v[96:111], v[56:59], v[216:219], v[96:111]
    s_waitcnt lgkmcnt(0)
    v_mfma_f32_32x32x16_bf16 v[112:127], v[60:63], v[216:219], v[112:127]
    v_mov_b32 v31, v27
    s_nop 1
    v_permlane32_swap_b32 v27, v31
    v_add_f32 v27, v27, v31
    v_rcp_f32 v27, v27
    s_lshl_b32 s40, s35, 14
    v_add_u32 v252, s40, v13
    v_mul_f32 v64, v64, v27
    v_mul_f32 v65, v65, v27
    v_mul_f32 v66, v66, v27
    v_mul_f32 v67, v67, v27
    v_mul_f32 v68, v68, v27
    v_mul_f32 v69, v69, v27
    v_mul_f32 v70, v70, v27
    v_mul_f32 v71, v71, v27
    v_cvt_pk_bf16_f32 v128, v64, v65
    v_cvt_pk_bf16_f32 v129, v66, v67
    v_cvt_pk_bf16_f32 v130, v68, v69
    v_cvt_pk_bf16_f32 v131, v70, v71
    v_xor_b32 v240, 0, v252
    ds_write_b128 v240, v[128:131] offset:0
    v_mul_f32 v72, v72, v27
    v_mul_f32 v73, v73, v27
    v_mul_f32 v74, v74, v27
    v_mul_f32 v75, v75, v27
    v_mul_f32 v76, v76, v27
    v_mul_f32 v77, v77, v27
    v_mul_f32 v78, v78, v27
    v_mul_f32 v79, v79, v27
    v_cvt_pk_bf16_f32 v132, v72, v73
    v_cvt_pk_bf16_f32 v133, v74, v75
    v_cvt_pk_bf16_f32 v134, v76, v77
    v_cvt_pk_bf16_f32 v135, v78, v79
    v_xor_b32 v241, 32, v252
    ds_write_b128 v241, v[132:135] offset:0
    v_mul_f32 v80, v80, v27
    v_mul_f32 v81, v81, v27
    v_mul_f32 v82, v82, v27
    v_mul_f32 v83, v83, v27
    v_mul_f32 v84, v84, v27
    v_mul_f32 v85, v85, v27
    v_mul_f32 v86, v86, v27
    v_mul_f32 v87, v87, v27
    v_cvt_pk_bf16_f32 v136, v80, v81
    v_cvt_pk_bf16_f32 v137, v82, v83
    v_cvt_pk_bf16_f32 v138, v84, v85
    v_cvt_pk_bf16_f32 v139, v86, v87
    v_xor_b32 v242, 64, v252
    ds_write_b128 v242, v[136:139] offset:0
    v_mul_f32 v88, v88, v27
    v_mul_f32 v89, v89, v27
    v_mul_f32 v90, v90, v27
    v_mul_f32 v91, v91, v27
    v_mul_f32 v92, v92, v27
    v_mul_f32 v93, v93, v27
    v_mul_f32 v94, v94, v27
    v_mul_f32 v95, v95, v27
    v_cvt_pk_bf16_f32 v140, v88, v89
    v_cvt_pk_bf16_f32 v141, v90, v91
    v_cvt_pk_bf16_f32 v142, v92, v93
    v_cvt_pk_bf16_f32 v143, v94, v95
    v_xor_b32 v243, 96, v252
    ds_write_b128 v243, v[140:143] offset:0
    v_mul_f32 v96, v96, v27
    v_mul_f32 v97, v97, v27
    v_mul_f32 v98, v98, v27
    v_mul_f32 v99, v99, v27
    v_mul_f32 v100, v100, v27
    v_mul_f32 v101, v101, v27
    v_mul_f32 v102, v102, v27
    v_mul_f32 v103, v103, v27
    v_cvt_pk_bf16_f32 v144, v96, v97
    v_cvt_pk_bf16_f32 v145, v98, v99
    v_cvt_pk_bf16_f32 v146, v100, v101
    v_cvt_pk_bf16_f32 v147, v102, v103
    v_xor_b32 v244, 0, v252
    ds_write_b128 v244, v[144:147] offset:8192
    v_mul_f32 v104, v104, v27
    v_mul_f32 v105, v105, v27
    v_mul_f32 v106, v106, v27
    v_mul_f32 v107, v107, v27
    v_mul_f32 v108, v108, v27
    v_mul_f32 v109, v109, v27
    v_mul_f32 v110, v110, v27
    v_mul_f32 v111, v111, v27
    v_cvt_pk_bf16_f32 v148, v104, v105
    v_cvt_pk_bf16_f32 v149, v106, v107
    v_cvt_pk_bf16_f32 v150, v108, v109
    v_cvt_pk_bf16_f32 v151, v110, v111
    v_xor_b32 v245, 32, v252
    ds_write_b128 v245, v[148:151] offset:8192
    v_mul_f32 v112, v112, v27
    v_mul_f32 v113, v113, v27
    v_mul_f32 v114, v114, v27
    v_mul_f32 v115, v115, v27
    v_mul_f32 v116, v116, v27
    v_mul_f32 v117, v117, v27
    v_mul_f32 v118, v118, v27
    v_mul_f32 v119, v119, v27
    v_cvt_pk_bf16_f32 v152, v112, v113
    v_cvt_pk_bf16_f32 v153, v114, v115
    v_cvt_pk_bf16_f32 v154, v116, v117
    v_cvt_pk_bf16_f32 v155, v118, v119
    v_xor_b32 v246, 64, v252
    ds_write_b128 v246, v[152:155] offset:8192
    v_mul_f32 v120, v120, v27
    v_mul_f32 v121, v121, v27
    v_mul_f32 v122, v122, v27
    v_mul_f32 v123, v123, v27
    v_mul_f32 v124, v124, v27
    v_mul_f32 v125, v125, v27
    v_mul_f32 v126, v126, v27
    v_mul_f32 v127, v127, v27
    v_cvt_pk_bf16_f32 v156, v120, v121
    v_cvt_pk_bf16_f32 v157, v122, v123
    v_cvt_pk_bf16_f32 v158, v124, v125
    v_cvt_pk_bf16_f32 v159, v126, v127
    v_xor_b32 v247, 96, v252
    ds_write_b128 v247, v[156:159] offset:8192
    s_waitcnt vmcnt(4) lgkmcnt(0)
    s_barrier
    v_add_u32 v240, 98304, v9
    v_add_u32 v241, 98304, v10
    v_xor_b32 v244, 0, v11
    v_xor_b32 v245, 32, v11
    ds_read_b128 v[128:131], v244 offset:0
    ds_read_b128 v[132:135], v244 offset:4096
    ds_read_b64_tr_b16 v[136:137], v240 offset:0
    ds_read_b64_tr_b16 v[138:139], v240 offset:4096
    ds_read_b64_tr_b16 v[140:141], v241 offset:0
    ds_read_b64_tr_b16 v[142:143], v241 offset:4096
    ds_read_b128 v[144:147], v245 offset:0
    ds_read_b128 v[148:151], v245 offset:4096
    ds_read_b64_tr_b16 v[152:153], v240 offset:16384
    ds_read_b64_tr_b16 v[154:155], v240 offset:20480
    ds_read_b64_tr_b16 v[156:157], v241 offset:16384
    ds_read_b64_tr_b16 v[158:159], v241 offset:20480
    s_add_u32 m0, s41, 65536
    s_add_u32 s40, s54, 65536
    buffer_load_dwordx4 v2, s[24:27], s40 offen offset:0 lds
    buffer_load_dwordx4 v3, s[24:27], s40 offen offset:1024 lds
    buffer_load_dwordx4 v4, s[24:27], s40 offen offset:2048 lds
    buffer_load_dwordx4 v5, s[24:27], s40 offen offset:3072 lds
    s_waitcnt vmcnt(4) lgkmcnt(0)
    s_barrier
    v_add_u32 v240, 131072, v9
    v_add_u32 v241, 131072, v10
    v_xor_b32 v244, 64, v11
    v_xor_b32 v245, 96, v11
    v_mfma_f32_32x32x16_bf16 v[64:79], v[136:139], v[128:131], 0
    ds_read_b128 v[160:163], v244 offset:0
    ds_read_b128 v[164:167], v244 offset:4096
    ds_read_b64_tr_b16 v[168:169], v240 offset:0
    v_mfma_f32_32x32x16_bf16 v[80:95], v[136:139], v[132:135], 0
    ds_read_b64_tr_b16 v[170:171], v240 offset:4096
    ds_read_b64_tr_b16 v[172:173], v241 offset:0
    v_mfma_f32_32x32x16_bf16 v[96:111], v[140:143], v[128:131], 0
    ds_read_b64_tr_b16 v[174:175], v241 offset:4096
    ds_read_b128 v[176:179], v245 offset:0
    v_mfma_f32_32x32x16_bf16 v[112:127], v[140:143], v[132:135], 0
    ds_read_b128 v[180:183], v245 offset:4096
    ds_read_b64_tr_b16 v[184:185], v240 offset:16384
    v_mfma_f32_32x32x16_bf16 v[64:79], v[152:155], v[144:147], v[64:79]
    ds_read_b64_tr_b16 v[186:187], v240 offset:20480
    ds_read_b64_tr_b16 v[188:189], v241 offset:16384
    ds_read_b64_tr_b16 v[190:191], v241 offset:20480
    v_mfma_f32_32x32x16_bf16 v[80:95], v[152:155], v[148:151], v[80:95]
    s_add_u32 m0, s41, 98304
    s_add_u32 s40, s54, 98304
    v_mfma_f32_32x32x16_bf16 v[96:111], v[156:159], v[144:147], v[96:111]
    buffer_load_dwordx4 v2, s[24:27], s40 offen offset:0 lds
    buffer_load_dwordx4 v3, s[24:27], s40 offen offset:1024 lds
    v_mfma_f32_32x32x16_bf16 v[112:127], v[156:159], v[148:151], v[112:127]
    buffer_load_dwordx4 v4, s[24:27], s40 offen offset:2048 lds
    buffer_load_dwordx4 v5, s[24:27], s40 offen offset:3072 lds
    s_waitcnt vmcnt(4) lgkmcnt(0)
    s_barrier
    v_add_u32 v240, 65536, v9
    v_add_u32 v241, 65536, v10
    v_xor_b32 v244, 0, v11
    v_xor_b32 v245, 32, v11
    v_mfma_f32_32x32x16_bf16 v[64:79], v[168:171], v[160:163], v[64:79]
    ds_read_b128 v[128:131], v244 offset:8192
    ds_read_b128 v[132:135], v244 offset:12288
    ds_read_b64_tr_b16 v[136:137], v240 offset:0
    v_mfma_f32_32x32x16_bf16 v[80:95], v[168:171], v[164:167], v[80:95]
    ds_read_b64_tr_b16 v[138:139], v240 offset:4096
    ds_read_b64_tr_b16 v[140:141], v241 offset:0
    v_mfma_f32_32x32x16_bf16 v[96:111], v[172:175], v[160:163], v[96:111]
    ds_read_b64_tr_b16 v[142:143], v241 offset:4096
    ds_read_b128 v[144:147], v245 offset:8192
    v_mfma_f32_32x32x16_bf16 v[112:127], v[172:175], v[164:167], v[112:127]
    ds_read_b128 v[148:151], v245 offset:12288
    ds_read_b64_tr_b16 v[152:153], v240 offset:16384
    v_mfma_f32_32x32x16_bf16 v[64:79], v[184:187], v[176:179], v[64:79]
    ds_read_b64_tr_b16 v[154:155], v240 offset:20480
    ds_read_b64_tr_b16 v[156:157], v241 offset:16384
    ds_read_b64_tr_b16 v[158:159], v241 offset:20480
    v_mfma_f32_32x32x16_bf16 v[80:95], v[184:187], v[180:183], v[80:95]
    s_add_u32 m0, s41, 131072
    s_add_u32 s40, s54, 131072
    v_mfma_f32_32x32x16_bf16 v[96:111], v[188:191], v[176:179], v[96:111]
    buffer_load_dwordx4 v2, s[24:27], s40 offen offset:0 lds
    buffer_load_dwordx4 v3, s[24:27], s40 offen offset:1024 lds
    v_mfma_f32_32x32x16_bf16 v[112:127], v[188:191], v[180:183], v[112:127]
    buffer_load_dwordx4 v4, s[24:27], s40 offen offset:2048 lds
    buffer_load_dwordx4 v5, s[24:27], s40 offen offset:3072 lds
    s_waitcnt vmcnt(4) lgkmcnt(0)
    s_barrier
    v_add_u32 v240, 98304, v9
    v_add_u32 v241, 98304, v10
    v_xor_b32 v244, 64, v11
    v_xor_b32 v245, 96, v11
    v_mfma_f32_32x32x16_bf16 v[64:79], v[136:139], v[128:131], v[64:79]
    ds_read_b128 v[160:163], v244 offset:8192
    ds_read_b128 v[164:167], v244 offset:12288
    ds_read_b64_tr_b16 v[168:169], v240 offset:0
    v_mfma_f32_32x32x16_bf16 v[80:95], v[136:139], v[132:135], v[80:95]
    ds_read_b64_tr_b16 v[170:171], v240 offset:4096
    ds_read_b64_tr_b16 v[172:173], v241 offset:0
    v_mfma_f32_32x32x16_bf16 v[96:111], v[140:143], v[128:131], v[96:111]
    ds_read_b64_tr_b16 v[174:175], v241 offset:4096
    ds_read_b128 v[176:179], v245 offset:8192
    v_mfma_f32_32x32x16_bf16 v[112:127], v[140:143], v[132:135], v[112:127]
    ds_read_b128 v[180:183], v245 offset:12288
    ds_read_b64_tr_b16 v[184:185], v240 offset:16384
    v_mfma_f32_32x32x16_bf16 v[64:79], v[152:155], v[144:147], v[64:79]
    ds_read_b64_tr_b16 v[186:187], v240 offset:20480
    ds_read_b64_tr_b16 v[188:189], v241 offset:16384
    ds_read_b64_tr_b16 v[190:191], v241 offset:20480
    v_mfma_f32_32x32x16_bf16 v[80:95], v[152:155], v[148:151], v[80:95]
    s_add_u32 m0, s41, 65536
    s_add_u32 s40, s54, 163840
    v_mfma_f32_32x32x16_bf16 v[96:111], v[156:159], v[144:147], v[96:111]
    buffer_load_dwordx4 v2, s[24:27], s40 offen offset:0 lds
    buffer_load_dwordx4 v3, s[24:27], s40 offen offset:1024 lds
    v_mfma_f32_32x32x16_bf16 v[112:127], v[156:159], v[148:151], v[112:127]
    buffer_load_dwordx4 v4, s[24:27], s40 offen offset:2048 lds
    buffer_load_dwordx4 v5, s[24:27], s40 offen offset:3072 lds
    s_waitcnt vmcnt(4) lgkmcnt(0)
    s_barrier
    v_add_u32 v240, 131072, v9
    v_add_u32 v241, 131072, v10
    v_xor_b32 v244, 0, v11
    v_xor_b32 v245, 32, v11
    v_mfma_f32_32x32x16_bf16 v[64:79], v[168:171], v[160:163], v[64:79]
    ds_read_b128 v[128:131], v244 offset:16384
    ds_read_b128 v[132:135], v244 offset:20480
    ds_read_b64_tr_b16 v[136:137], v240 offset:0
    v_mfma_f32_32x32x16_bf16 v[80:95], v[168:171], v[164:167], v[80:95]
    ds_read_b64_tr_b16 v[138:139], v240 offset:4096
    ds_read_b64_tr_b16 v[140:141], v241 offset:0
    v_mfma_f32_32x32x16_bf16 v[96:111], v[172:175], v[160:163], v[96:111]
    ds_read_b64_tr_b16 v[142:143], v241 offset:4096
    ds_read_b128 v[144:147], v245 offset:16384
    v_mfma_f32_32x32x16_bf16 v[112:127], v[172:175], v[164:167], v[112:127]
    ds_read_b128 v[148:151], v245 offset:20480
    ds_read_b64_tr_b16 v[152:153], v240 offset:16384
    v_mfma_f32_32x32x16_bf16 v[64:79], v[184:187], v[176:179], v[64:79]
    ds_read_b64_tr_b16 v[154:155], v240 offset:20480
    ds_read_b64_tr_b16 v[156:157], v241 offset:16384
    ds_read_b64_tr_b16 v[158:159], v241 offset:20480
    v_mfma_f32_32x32x16_bf16 v[80:95], v[184:187], v[180:183], v[80:95]
    s_add_u32 m0, s41, 98304
    s_add_u32 s40, s54, 196608
    v_mfma_f32_32x32x16_bf16 v[96:111], v[188:191], v[176:179], v[96:111]
    buffer_load_dwordx4 v2, s[24:27], s40 offen offset:0 lds
    buffer_load_dwordx4 v3, s[24:27], s40 offen offset:1024 lds
    v_mfma_f32_32x32x16_bf16 v[112:127], v[188:191], v[180:183], v[112:127]
    buffer_load_dwordx4 v4, s[24:27], s40 offen offset:2048 lds
    buffer_load_dwordx4 v5, s[24:27], s40 offen offset:3072 lds
    s_waitcnt vmcnt(4) lgkmcnt(0)
    s_barrier
    v_add_u32 v240, 65536, v9
    v_add_u32 v241, 65536, v10
    v_xor_b32 v244, 64, v11
    v_xor_b32 v245, 96, v11
    v_mfma_f32_32x32x16_bf16 v[64:79], v[136:139], v[128:131], v[64:79]
    ds_read_b128 v[160:163], v244 offset:16384
    ds_read_b128 v[164:167], v244 offset:20480
    ds_read_b64_tr_b16 v[168:169], v240 offset:0
    v_mfma_f32_32x32x16_bf16 v[80:95], v[136:139], v[132:135], v[80:95]
    ds_read_b64_tr_b16 v[170:171], v240 offset:4096
    ds_read_b64_tr_b16 v[172:173], v241 offset:0
    v_mfma_f32_32x32x16_bf16 v[96:111], v[140:143], v[128:131], v[96:111]
    ds_read_b64_tr_b16 v[174:175], v241 offset:4096
    ds_read_b128 v[176:179], v245 offset:16384
    v_mfma_f32_32x32x16_bf16 v[112:127], v[140:143], v[132:135], v[112:127]
    ds_read_b128 v[180:183], v245 offset:20480
    ds_read_b64_tr_b16 v[184:185], v240 offset:16384
    v_mfma_f32_32x32x16_bf16 v[64:79], v[152:155], v[144:147], v[64:79]
    ds_read_b64_tr_b16 v[186:187], v240 offset:20480
    ds_read_b64_tr_b16 v[188:189], v241 offset:16384
    ds_read_b64_tr_b16 v[190:191], v241 offset:20480
    v_mfma_f32_32x32x16_bf16 v[80:95], v[152:155], v[148:151], v[80:95]
    s_add_u32 m0, s41, 131072
    s_add_u32 s40, s54, 229376
    v_mfma_f32_32x32x16_bf16 v[96:111], v[156:159], v[144:147], v[96:111]
    buffer_load_dwordx4 v2, s[24:27], s40 offen offset:0 lds
    buffer_load_dwordx4 v3, s[24:27], s40 offen offset:1024 lds
    v_mfma_f32_32x32x16_bf16 v[112:127], v[156:159], v[148:151], v[112:127]
    buffer_load_dwordx4 v4, s[24:27], s40 offen offset:2048 lds
    buffer_load_dwordx4 v5, s[24:27], s40 offen offset:3072 lds
    s_waitcnt vmcnt(4) lgkmcnt(0)
    s_barrier
    v_add_u32 v240, 98304, v9
    v_add_u32 v241, 98304, v10
    v_xor_b32 v244, 0, v11
    v_xor_b32 v245, 32, v11
    v_mfma_f32_32x32x16_bf16 v[64:79], v[168:171], v[160:163], v[64:79]
    ds_read_b128 v[128:131], v244 offset:24576
    ds_read_b128 v[132:135], v244 offset:28672
    ds_read_b64_tr_b16 v[136:137], v240 offset:0
    v_mfma_f32_32x32x16_bf16 v[80:95], v[168:171], v[164:167], v[80:95]
    ds_read_b64_tr_b16 v[138:139], v240 offset:4096
    ds_read_b64_tr_b16 v[140:141], v241 offset:0
    v_mfma_f32_32x32x16_bf16 v[96:111], v[172:175], v[160:163], v[96:111]
    ds_read_b64_tr_b16 v[142:143], v241 offset:4096
    ds_read_b128 v[144:147], v245 offset:24576
    v_mfma_f32_32x32x16_bf16 v[112:127], v[172:175], v[164:167], v[112:127]
    ds_read_b128 v[148:151], v245 offset:28672
    ds_read_b64_tr_b16 v[152:153], v240 offset:16384
    v_mfma_f32_32x32x16_bf16 v[64:79], v[184:187], v[176:179], v[64:79]
    ds_read_b64_tr_b16 v[154:155], v240 offset:20480
    ds_read_b64_tr_b16 v[156:157], v241 offset:16384
    ds_read_b64_tr_b16 v[158:159], v241 offset:20480
    v_mfma_f32_32x32x16_bf16 v[80:95], v[184:187], v[180:183], v[80:95]
    s_add_u32 m0, s41, 65536
    s_add_u32 s40, s54, 262144
    v_mfma_f32_32x32x16_bf16 v[96:111], v[188:191], v[176:179], v[96:111]
    buffer_load_dwordx4 v2, s[24:27], s40 offen offset:0 lds
    buffer_load_dwordx4 v3, s[24:27], s40 offen offset:1024 lds
    v_mfma_f32_32x32x16_bf16 v[112:127], v[188:191], v[180:183], v[112:127]
    buffer_load_dwordx4 v4, s[24:27], s40 offen offset:2048 lds
    buffer_load_dwordx4 v5, s[24:27], s40 offen offset:3072 lds
    s_waitcnt vmcnt(4) lgkmcnt(0)
    s_barrier
    v_add_u32 v240, 131072, v9
    v_add_u32 v241, 131072, v10
    v_xor_b32 v244, 64, v11
    v_xor_b32 v245, 96, v11
    v_mfma_f32_32x32x16_bf16 v[64:79], v[136:139], v[128:131], v[64:79]
    ds_read_b128 v[160:163], v244 offset:24576
    ds_read_b128 v[164:167], v244 offset:28672
    ds_read_b64_tr_b16 v[168:169], v240 offset:0
    v_mfma_f32_32x32x16_bf16 v[80:95], v[136:139], v[132:135], v[80:95]
    ds_read_b64_tr_b16 v[170:171], v240 offset:4096
    ds_read_b64_tr_b16 v[172:173], v241 offset:0
    v_mfma_f32_32x32x16_bf16 v[96:111], v[140:143], v[128:131], v[96:111]
    ds_read_b64_tr_b16 v[174:175], v241 offset:4096
    ds_read_b128 v[176:179], v245 offset:24576
    v_mfma_f32_32x32x16_bf16 v[112:127], v[140:143], v[132:135], v[112:127]
    ds_read_b128 v[180:183], v245 offset:28672
    ds_read_b64_tr_b16 v[184:185], v240 offset:16384
    v_mfma_f32_32x32x16_bf16 v[64:79], v[152:155], v[144:147], v[64:79]
    ds_read_b64_tr_b16 v[186:187], v240 offset:20480
    ds_read_b64_tr_b16 v[188:189], v241 offset:16384
    ds_read_b64_tr_b16 v[190:191], v241 offset:20480
    v_mfma_f32_32x32x16_bf16 v[80:95], v[152:155], v[148:151], v[80:95]
    s_add_u32 m0, s41, 98304
    s_add_u32 s40, s54, 294912
    v_mfma_f32_32x32x16_bf16 v[96:111], v[156:159], v[144:147], v[96:111]
    buffer_load_dwordx4 v2, s[24:27], s40 offen offset:0 lds
    buffer_load_dwordx4 v3, s[24:27], s40 offen offset:1024 lds
    v_mfma_f32_32x32x16_bf16 v[112:127], v[156:159], v[148:151], v[112:127]
    buffer_load_dwordx4 v4, s[24:27], s40 offen offset:2048 lds
    buffer_load_dwordx4 v5, s[24:27], s40 offen offset:3072 lds
    s_waitcnt vmcnt(4) lgkmcnt(0)
    s_barrier
    v_add_u32 v240, 65536, v9
    v_add_u32 v241, 65536, v10
    v_xor_b32 v244, 0, v11
    v_xor_b32 v245, 32, v11
    v_mfma_f32_32x32x16_bf16 v[64:79], v[168:171], v[160:163], v[64:79]
    ds_read_b128 v[128:131], v244 offset:32768
    ds_read_b128 v[132:135], v244 offset:36864
    ds_read_b64_tr_b16 v[136:137], v240 offset:0
    v_mfma_f32_32x32x16_bf16 v[80:95], v[168:171], v[164:167], v[80:95]
    ds_read_b64_tr_b16 v[138:139], v240 offset:4096
    ds_read_b64_tr_b16 v[140:141], v241 offset:0
    v_mfma_f32_32x32x16_bf16 v[96:111], v[172:175], v[160:163], v[96:111]
    ds_read_b64_tr_b16 v[142:143], v241 offset:4096
    ds_read_b128 v[144:147], v245 offset:32768
    v_mfma_f32_32x32x16_bf16 v[112:127], v[172:175], v[164:167], v[112:127]
    ds_read_b128 v[148:151], v245 offset:36864
    ds_read_b64_tr_b16 v[152:153], v240 offset:16384
    v_mfma_f32_32x32x16_bf16 v[64:79], v[184:187], v[176:179], v[64:79]
    ds_read_b64_tr_b16 v[154:155], v240 offset:20480
    ds_read_b64_tr_b16 v[156:157], v241 offset:16384
    ds_read_b64_tr_b16 v[158:159], v241 offset:20480
    v_mfma_f32_32x32x16_bf16 v[80:95], v[184:187], v[180:183], v[80:95]
    s_add_u32 m0, s41, 131072
    s_add_u32 s40, s54, 327680
    v_mfma_f32_32x32x16_bf16 v[96:111], v[188:191], v[176:179], v[96:111]
    buffer_load_dwordx4 v2, s[24:27], s40 offen offset:0 lds
    buffer_load_dwordx4 v3, s[24:27], s40 offen offset:1024 lds
    v_mfma_f32_32x32x16_bf16 v[112:127], v[188:191], v[180:183], v[112:127]
    buffer_load_dwordx4 v4, s[24:27], s40 offen offset:2048 lds
    buffer_load_dwordx4 v5, s[24:27], s40 offen offset:3072 lds
    s_waitcnt vmcnt(4) lgkmcnt(0)
    s_barrier
    v_add_u32 v240, 98304, v9
    v_add_u32 v241, 98304, v10
    v_xor_b32 v244, 64, v11
    v_xor_b32 v245, 96, v11
    v_mfma_f32_32x32x16_bf16 v[64:79], v[136:139], v[128:131], v[64:79]
    ds_read_b128 v[160:163], v244 offset:32768
    ds_read_b128 v[164:167], v244 offset:36864
    ds_read_b64_tr_b16 v[168:169], v240 offset:0
    v_mfma_f32_32x32x16_bf16 v[80:95], v[136:139], v[132:135], v[80:95]
    ds_read_b64_tr_b16 v[170:171], v240 offset:4096
    ds_read_b64_tr_b16 v[172:173], v241 offset:0
    v_mfma_f32_32x32x16_bf16 v[96:111], v[140:143], v[128:131], v[96:111]
    ds_read_b64_tr_b16 v[174:175], v241 offset:4096
    ds_read_b128 v[176:179], v245 offset:32768
    v_mfma_f32_32x32x16_bf16 v[112:127], v[140:143], v[132:135], v[112:127]
    ds_read_b128 v[180:183], v245 offset:36864
    ds_read_b64_tr_b16 v[184:185], v240 offset:16384
    v_mfma_f32_32x32x16_bf16 v[64:79], v[152:155], v[144:147], v[64:79]
    ds_read_b64_tr_b16 v[186:187], v240 offset:20480
    ds_read_b64_tr_b16 v[188:189], v241 offset:16384
    ds_read_b64_tr_b16 v[190:191], v241 offset:20480
    v_mfma_f32_32x32x16_bf16 v[80:95], v[152:155], v[148:151], v[80:95]
    s_add_u32 m0, s41, 65536
    s_add_u32 s40, s54, 360448
    v_mfma_f32_32x32x16_bf16 v[96:111], v[156:159], v[144:147], v[96:111]
    buffer_load_dwordx4 v2, s[24:27], s40 offen offset:0 lds
    buffer_load_dwordx4 v3, s[24:27], s40 offen offset:1024 lds
    v_mfma_f32_32x32x16_bf16 v[112:127], v[156:159], v[148:151], v[112:127]
    buffer_load_dwordx4 v4, s[24:27], s40 offen offset:2048 lds
    buffer_load_dwordx4 v5, s[24:27], s40 offen offset:3072 lds
    s_waitcnt vmcnt(4) lgkmcnt(0)
    s_barrier
    v_add_u32 v240, 131072, v9
    v_add_u32 v241, 131072, v10
    v_xor_b32 v244, 0, v11
    v_xor_b32 v245, 32, v11
    v_mfma_f32_32x32x16_bf16 v[64:79], v[168:171], v[160:163], v[64:79]
    ds_read_b128 v[128:131], v244 offset:40960
    ds_read_b128 v[132:135], v244 offset:45056
    ds_read_b64_tr_b16 v[136:137], v240 offset:0
    v_mfma_f32_32x32x16_bf16 v[80:95], v[168:171], v[164:167], v[80:95]
    ds_read_b64_tr_b16 v[138:139], v240 offset:4096
    ds_read_b64_tr_b16 v[140:141], v241 offset:0
    v_mfma_f32_32x32x16_bf16 v[96:111], v[172:175], v[160:163], v[96:111]
    ds_read_b64_tr_b16 v[142:143], v241 offset:4096
    ds_read_b128 v[144:147], v245 offset:40960
    v_mfma_f32_32x32x16_bf16 v[112:127], v[172:175], v[164:167], v[112:127]
    ds_read_b128 v[148:151], v245 offset:45056
    ds_read_b64_tr_b16 v[152:153], v240 offset:16384
    v_mfma_f32_32x32x16_bf16 v[64:79], v[184:187], v[176:179], v[64:79]
    ds_read_b64_tr_b16 v[154:155], v240 offset:20480
    ds_read_b64_tr_b16 v[156:157], v241 offset:16384
    ds_read_b64_tr_b16 v[158:159], v241 offset:20480
    v_mfma_f32_32x32x16_bf16 v[80:95], v[184:187], v[180:183], v[80:95]
    s_add_u32 m0, s41, 98304
    s_add_u32 s40, s54, 393216
    v_mfma_f32_32x32x16_bf16 v[96:111], v[188:191], v[176:179], v[96:111]
    buffer_load_dwordx4 v2, s[24:27], s40 offen offset:0 lds
    buffer_load_dwordx4 v3, s[24:27], s40 offen offset:1024 lds
    v_mfma_f32_32x32x16_bf16 v[112:127], v[188:191], v[180:183], v[112:127]
    buffer_load_dwordx4 v4, s[24:27], s40 offen offset:2048 lds
    buffer_load_dwordx4 v5, s[24:27], s40 offen offset:3072 lds
    s_waitcnt vmcnt(4) lgkmcnt(0)
    s_barrier
    v_add_u32 v240, 65536, v9
    v_add_u32 v241, 65536, v10
    v_xor_b32 v244, 64, v11
    v_xor_b32 v245, 96, v11
    v_mfma_f32_32x32x16_bf16 v[64:79], v[136:139], v[128:131], v[64:79]
    ds_read_b128 v[160:163], v244 offset:40960
    ds_read_b128 v[164:167], v244 offset:45056
    ds_read_b64_tr_b16 v[168:169], v240 offset:0
    v_mfma_f32_32x32x16_bf16 v[80:95], v[136:139], v[132:135], v[80:95]
    ds_read_b64_tr_b16 v[170:171], v240 offset:4096
    ds_read_b64_tr_b16 v[172:173], v241 offset:0
    v_mfma_f32_32x32x16_bf16 v[96:111], v[140:143], v[128:131], v[96:111]
    ds_read_b64_tr_b16 v[174:175], v241 offset:4096
    ds_read_b128 v[176:179], v245 offset:40960
    v_mfma_f32_32x32x16_bf16 v[112:127], v[140:143], v[132:135], v[112:127]
    ds_read_b128 v[180:183], v245 offset:45056
    ds_read_b64_tr_b16 v[184:185], v240 offset:16384
    v_mfma_f32_32x32x16_bf16 v[64:79], v[152:155], v[144:147], v[64:79]
    ds_read_b64_tr_b16 v[186:187], v240 offset:20480
    ds_read_b64_tr_b16 v[188:189], v241 offset:16384
    ds_read_b64_tr_b16 v[190:191], v241 offset:20480
    v_mfma_f32_32x32x16_bf16 v[80:95], v[152:155], v[148:151], v[80:95]
    s_add_u32 m0, s41, 131072
    s_add_u32 s40, s54, 425984
    v_mfma_f32_32x32x16_bf16 v[96:111], v[156:159], v[144:147], v[96:111]
    buffer_load_dwordx4 v2, s[24:27], s40 offen offset:0 lds
    buffer_load_dwordx4 v3, s[24:27], s40 offen offset:1024 lds
    v_mfma_f32_32x32x16_bf16 v[112:127], v[156:159], v[148:151], v[112:127]
    buffer_load_dwordx4 v4, s[24:27], s40 offen offset:2048 lds
    buffer_load_dwordx4 v5, s[24:27], s40 offen offset:3072 lds
    s_waitcnt vmcnt(4) lgkmcnt(0)
    s_barrier
    v_add_u32 v240, 98304, v9
    v_add_u32 v241, 98304, v10
    v_xor_b32 v244, 0, v11
    v_xor_b32 v245, 32, v11
    v_mfma_f32_32x32x16_bf16 v[64:79], v[168:171], v[160:163], v[64:79]
    ds_read_b128 v[128:131], v244 offset:49152
    ds_read_b128 v[132:135], v244 offset:53248
    ds_read_b64_tr_b16 v[136:137], v240 offset:0
    v_mfma_f32_32x32x16_bf16 v[80:95], v[168:171], v[164:167], v[80:95]
    ds_read_b64_tr_b16 v[138:139], v240 offset:4096
    ds_read_b64_tr_b16 v[140:141], v241 offset:0
    v_mfma_f32_32x32x16_bf16 v[96:111], v[172:175], v[160:163], v[96:111]
    ds_read_b64_tr_b16 v[142:143], v241 offset:4096
    ds_read_b128 v[144:147], v245 offset:49152
    v_mfma_f32_32x32x16_bf16 v[112:127], v[172:175], v[164:167], v[112:127]
    ds_read_b128 v[148:151], v245 offset:53248
    ds_read_b64_tr_b16 v[152:153], v240 offset:16384
    v_mfma_f32_32x32x16_bf16 v[64:79], v[184:187], v[176:179], v[64:79]
    ds_read_b64_tr_b16 v[154:155], v240 offset:20480
    ds_read_b64_tr_b16 v[156:157], v241 offset:16384
    ds_read_b64_tr_b16 v[158:159], v241 offset:20480
    v_mfma_f32_32x32x16_bf16 v[80:95], v[184:187], v[180:183], v[80:95]
    s_add_u32 m0, s41, 65536
    s_add_u32 s40, s54, 458752
    v_mfma_f32_32x32x16_bf16 v[96:111], v[188:191], v[176:179], v[96:111]
    buffer_load_dwordx4 v2, s[24:27], s40 offen offset:0 lds
    buffer_load_dwordx4 v3, s[24:27], s40 offen offset:1024 lds
    v_mfma_f32_32x32x16_bf16 v[112:127], v[188:191], v[180:183], v[112:127]
    buffer_load_dwordx4 v4, s[24:27], s40 offen offset:2048 lds
    buffer_load_dwordx4 v5, s[24:27], s40 offen offset:3072 lds
    s_waitcnt vmcnt(4) lgkmcnt(0)
    s_barrier
    v_add_u32 v240, 131072, v9
    v_add_u32 v241, 131072, v10
    v_xor_b32 v244, 64, v11
    v_xor_b32 v245, 96, v11
    v_mfma_f32_32x32x16_bf16 v[64:79], v[136:139], v[128:131], v[64:79]
    ds_read_b128 v[160:163], v244 offset:49152
    ds_read_b128 v[164:167], v244 offset:53248
    ds_read_b64_tr_b16 v[168:169], v240 offset:0
    v_mfma_f32_32x32x16_bf16 v[80:95], v[136:139], v[132:135], v[80:95]
    ds_read_b64_tr_b16 v[170:171], v240 offset:4096
    ds_read_b64_tr_b16 v[172:173], v241 offset:0
    v_mfma_f32_32x32x16_bf16 v[96:111], v[140:143], v[128:131], v[96:111]
    ds_read_b64_tr_b16 v[174:175], v241 offset:4096
    ds_read_b128 v[176:179], v245 offset:49152
    v_mfma_f32_32x32x16_bf16 v[112:127], v[140:143], v[132:135], v[112:127]
    ds_read_b128 v[180:183], v245 offset:53248
    ds_read_b64_tr_b16 v[184:185], v240 offset:16384
    v_mfma_f32_32x32x16_bf16 v[64:79], v[152:155], v[144:147], v[64:79]
    ds_read_b64_tr_b16 v[186:187], v240 offset:20480
    ds_read_b64_tr_b16 v[188:189], v241 offset:16384
    ds_read_b64_tr_b16 v[190:191], v241 offset:20480
    v_mfma_f32_32x32x16_bf16 v[80:95], v[152:155], v[148:151], v[80:95]
    s_add_u32 m0, s41, 98304
    s_add_u32 s40, s54, 491520
    v_mfma_f32_32x32x16_bf16 v[96:111], v[156:159], v[144:147], v[96:111]
    buffer_load_dwordx4 v2, s[24:27], s40 offen offset:0 lds
    buffer_load_dwordx4 v3, s[24:27], s40 offen offset:1024 lds
    v_mfma_f32_32x32x16_bf16 v[112:127], v[156:159], v[148:151], v[112:127]
    buffer_load_dwordx4 v4, s[24:27], s40 offen offset:2048 lds
    buffer_load_dwordx4 v5, s[24:27], s40 offen offset:3072 lds
    s_waitcnt vmcnt(4) lgkmcnt(0)
    s_barrier
    v_add_u32 v240, 65536, v9
    v_add_u32 v241, 65536, v10
    v_xor_b32 v244, 0, v11
    v_xor_b32 v245, 32, v11
    v_mfma_f32_32x32x16_bf16 v[64:79], v[168:171], v[160:163], v[64:79]
    ds_read_b128 v[128:131], v244 offset:57344
    ds_read_b128 v[132:135], v244 offset:61440
    v_mfma_f32_32x32x16_bf16 v[80:95], v[168:171], v[164:167], v[80:95]
    ds_read_b64_tr_b16 v[136:137], v240 offset:0
    v_mfma_f32_32x32x16_bf16 v[96:111], v[172:175], v[160:163], v[96:111]
    ds_read_b64_tr_b16 v[138:139], v240 offset:4096
    ds_read_b64_tr_b16 v[140:141], v241 offset:0
    v_mfma_f32_32x32x16_bf16 v[112:127], v[172:175], v[164:167], v[112:127]
    ds_read_b64_tr_b16 v[142:143], v241 offset:4096
    v_mfma_f32_32x32x16_bf16 v[64:79], v[184:187], v[176:179], v[64:79]
    ds_read_b128 v[144:147], v245 offset:57344
    ds_read_b128 v[148:151], v245 offset:61440
    v_mfma_f32_32x32x16_bf16 v[80:95], v[184:187], v[180:183], v[80:95]
    ds_read_b64_tr_b16 v[152:153], v240 offset:16384
    v_mfma_f32_32x32x16_bf16 v[96:111], v[188:191], v[176:179], v[96:111]
    ds_read_b64_tr_b16 v[154:155], v240 offset:20480
    ds_read_b64_tr_b16 v[156:157], v241 offset:16384
    v_mfma_f32_32x32x16_bf16 v[112:127], v[188:191], v[180:183], v[112:127]
    ds_read_b64_tr_b16 v[158:159], v241 offset:20480
    s_waitcnt vmcnt(0) lgkmcnt(0)
    s_barrier
    v_add_u32 v240, 98304, v9
    v_add_u32 v241, 98304, v10
    v_xor_b32 v244, 64, v11
    v_xor_b32 v245, 96, v11
    v_mfma_f32_32x32x16_bf16 v[64:79], v[136:139], v[128:131], v[64:79]
    ds_read_b128 v[160:163], v244 offset:57344
    ds_read_b128 v[164:167], v244 offset:61440
    v_mfma_f32_32x32x16_bf16 v[80:95], v[136:139], v[132:135], v[80:95]
    ds_read_b64_tr_b16 v[168:169], v240 offset:0
    v_mfma_f32_32x32x16_bf16 v[96:111], v[140:143], v[128:131], v[96:111]
    ds_read_b64_tr_b16 v[170:171], v240 offset:4096
    ds_read_b64_tr_b16 v[172:173], v241 offset:0
    v_mfma_f32_32x32x16_bf16 v[112:127], v[140:143], v[132:135], v[112:127]
    ds_read_b64_tr_b16 v[174:175], v241 offset:4096
    v_mfma_f32_32x32x16_bf16 v[64:79], v[152:155], v[144:147], v[64:79]
    ds_read_b128 v[176:179], v245 offset:57344
    ds_read_b128 v[180:183], v245 offset:61440
    v_mfma_f32_32x32x16_bf16 v[80:95], v[152:155], v[148:151], v[80:95]
    ds_read_b64_tr_b16 v[184:185], v240 offset:16384
    v_mfma_f32_32x32x16_bf16 v[96:111], v[156:159], v[144:147], v[96:111]
    ds_read_b64_tr_b16 v[186:187], v240 offset:20480
    ds_read_b64_tr_b16 v[188:189], v241 offset:16384
    v_mfma_f32_32x32x16_bf16 v[112:127], v[156:159], v[148:151], v[112:127]
    ds_read_b64_tr_b16 v[190:191], v241 offset:20480
    s_waitcnt lgkmcnt(8)
    v_mfma_f32_32x32x16_bf16 v[64:79], v[168:171], v[160:163], v[64:79]
    v_mfma_f32_32x32x16_bf16 v[80:95], v[168:171], v[164:167], v[80:95]
    s_waitcnt lgkmcnt(6)
    v_mfma_f32_32x32x16_bf16 v[96:111], v[172:175], v[160:163], v[96:111]
    v_mfma_f32_32x32x16_bf16 v[112:127], v[172:175], v[164:167], v[112:127]
    s_waitcnt lgkmcnt(2)
    v_mfma_f32_32x32x16_bf16 v[64:79], v[184:187], v[176:179], v[64:79]
    v_mfma_f32_32x32x16_bf16 v[80:95], v[184:187], v[180:183], v[80:95]
    s_waitcnt lgkmcnt(0)
    v_mfma_f32_32x32x16_bf16 v[96:111], v[188:191], v[176:179], v[96:111]
    v_mfma_f32_32x32x16_bf16 v[112:127], v[188:191], v[180:183], v[112:127]
    s_lshl_b32 s40, s32, 21
    s_lshl_b32 s43, s33, 16
    s_add_u32 s40, s40, s43
    s_add_u32 s40, s40, s41
    s_add_u32 s43, s40, 32768
    s_nop 2
    v_cvt_pk_bf16_f32 v128, v64, v65
    v_cvt_pk_bf16_f32 v129, v66, v67
    v_cvt_pk_bf16_f32 v130, v68, v69
    v_cvt_pk_bf16_f32 v131, v70, v71
    buffer_store_dwordx4 v[128:131], v26, s[28:31], s40 offen offset:0 sc1
    v_cvt_pk_bf16_f32 v132, v72, v73
    v_cvt_pk_bf16_f32 v133, v74, v75
    v_cvt_pk_bf16_f32 v134, v76, v77
    v_cvt_pk_bf16_f32 v135, v78, v79
    buffer_store_dwordx4 v[132:135], v26, s[28:31], s40 offen offset:1024 sc1
    v_cvt_pk_bf16_f32 v136, v80, v81
    v_cvt_pk_bf16_f32 v137, v82, v83
    v_cvt_pk_bf16_f32 v138, v84, v85
    v_cvt_pk_bf16_f32 v139, v86, v87
    buffer_store_dwordx4 v[136:139], v26, s[28:31], s43 offen offset:0 sc1
    v_cvt_pk_bf16_f32 v140, v88, v89
    v_cvt_pk_bf16_f32 v141, v90, v91
    v_cvt_pk_bf16_f32 v142, v92, v93
    v_cvt_pk_bf16_f32 v143, v94, v95
    buffer_store_dwordx4 v[140:143], v26, s[28:31], s43 offen offset:1024 sc1
    v_cvt_pk_bf16_f32 v144, v96, v97
    v_cvt_pk_bf16_f32 v145, v98, v99
    v_cvt_pk_bf16_f32 v146, v100, v101
    v_cvt_pk_bf16_f32 v147, v102, v103
    buffer_store_dwordx4 v[144:147], v26, s[28:31], s40 offen offset:2048 sc1
    v_cvt_pk_bf16_f32 v148, v104, v105
    v_cvt_pk_bf16_f32 v149, v106, v107
    v_cvt_pk_bf16_f32 v150, v108, v109
    v_cvt_pk_bf16_f32 v151, v110, v111
    buffer_store_dwordx4 v[148:151], v26, s[28:31], s40 offen offset:3072 sc1
    v_cvt_pk_bf16_f32 v152, v112, v113
    v_cvt_pk_bf16_f32 v153, v114, v115
    v_cvt_pk_bf16_f32 v154, v116, v117
    v_cvt_pk_bf16_f32 v155, v118, v119
    buffer_store_dwordx4 v[152:155], v26, s[28:31], s43 offen offset:2048 sc1
    v_cvt_pk_bf16_f32 v156, v120, v121
    v_cvt_pk_bf16_f32 v157, v122, v123
    v_cvt_pk_bf16_f32 v158, v124, v125
    v_cvt_pk_bf16_f32 v159, v126, v127
    buffer_store_dwordx4 v[156:159], v26, s[28:31], s43 offen offset:3072 sc1
    s_endpgm
L_fix2:
    s_nop 15
    v_mov_b32 v31, v30
    s_nop 1
    v_permlane32_swap_b32 v30, v31
    v_max3_f32 v30, v30, v31, 0
    v_sub_f32 v28, 0, v30
    v_exp_f32 v28, v28
    v_sub_f32 v192, v192, v30
    v_sub_f32 v193, v193, v30
    v_sub_f32 v194, v194, v30
    v_sub_f32 v195, v195, v30
    v_sub_f32 v196, v196, v30
    v_sub_f32 v197, v197, v30
    v_sub_f32 v198, v198, v30
    v_sub_f32 v199, v199, v30
    v_sub_f32 v200, v200, v30
    v_sub_f32 v201, v201, v30
    v_sub_f32 v202, v202, v30
    v_sub_f32 v203, v203, v30
    v_sub_f32 v204, v204, v30
    v_sub_f32 v205, v205, v30
    v_sub_f32 v206, v206, v30
    v_sub_f32 v207, v207, v30
    v_sub_f32 v208, v208, v30
    v_sub_f32 v209, v209, v30
    v_sub_f32 v210, v210, v30
    v_sub_f32 v211, v211, v30
    v_sub_f32 v212, v212, v30
    v_sub_f32 v213, v213, v30
    v_sub_f32 v214, v214, v30
    v_sub_f32 v215, v215, v30
    v_sub_f32 v216, v216, v30
    v_sub_f32 v217, v217, v30
    v_sub_f32 v218, v218, v30
    v_sub_f32 v219, v219, v30
    v_sub_f32 v220, v220, v30
    v_sub_f32 v221, v221, v30
    v_sub_f32 v222, v222, v30
    v_sub_f32 v223, v223, v30
    v_sub_f32 v224, v224, v30
    v_sub_f32 v225, v225, v30
    v_sub_f32 v226, v226, v30
    v_sub_f32 v227, v227, v30
    v_sub_f32 v228, v228, v30
    v_sub_f32 v229, v229, v30
    v_sub_f32 v230, v230, v30
    v_sub_f32 v231, v231, v30
    v_sub_f32 v232, v232, v30
    v_sub_f32 v233, v233, v30
    v_sub_f32 v234, v234, v30
    v_sub_f32 v235, v235, v30
    v_sub_f32 v236, v236, v30
    v_sub_f32 v237, v237, v30
    v_sub_f32 v238, v238, v30
    v_sub_f32 v239, v239, v30
    v_mul_f32 v27, v27, v28
    v_mul_f32 v64, v64, v28
    v_mul_f32 v65, v65, v28
    v_mul_f32 v66, v66, v28
    v_mul_f32 v67, v67, v28
    v_mul_f32 v68, v68, v28
    v_mul_f32 v69, v69, v28
    v_mul_f32 v70, v70, v28
    v_mul_f32 v71, v71, v28
    v_mul_f32 v72, v72, v28
    v_mul_f32 v73, v73, v28
    v_mul_f32 v74, v74, v28
    v_mul_f32 v75, v75, v28
    v_mul_f32 v76, v76, v28
    v_mul_f32 v77, v77, v28
    v_mul_f32 v78, v78, v28
    v_mul_f32 v79, v79, v28
    v_mul_f32 v80, v80, v28
    v_mul_f32 v81, v81, v28
    v_mul_f32 v82, v82, v28
    v_mul_f32 v83, v83, v28
    v_mul_f32 v84, v84, v28
    v_mul_f32 v85, v85, v28
    v_mul_f32 v86, v86, v28
    v_mul_f32 v87, v87, v28
    v_mul_f32 v88, v88, v28
    v_mul_f32 v89, v89, v28
    v_mul_f32 v90, v90, v28
    v_mul_f32 v91, v91, v28
    v_mul_f32 v92, v92, v28
    v_mul_f32 v93, v93, v28
    v_mul_f32 v94, v94, v28
    v_mul_f32 v95, v95, v28
    v_mul_f32 v96, v96, v28
    v_mul_f32 v97, v97, v28
    v_mul_f32 v98, v98, v28
    v_mul_f32 v99, v99, v28
    v_mul_f32 v100, v100, v28
    v_mul_f32 v101, v101, v28
    v_mul_f32 v102, v102, v28
    v_mul_f32 v103, v103, v28
    v_mul_f32 v104, v104, v28
    v_mul_f32 v105, v105, v28
    v_mul_f32 v106, v106, v28
    v_mul_f32 v107, v107, v28
    v_mul_f32 v108, v108, v28
    v_mul_f32 v109, v109, v28
    v_mul_f32 v110, v110, v28
    v_mul_f32 v111, v111, v28
    v_mul_f32 v112, v112, v28
    v_mul_f32 v113, v113, v28
    v_mul_f32 v114, v114, v28
    v_mul_f32 v115, v115, v28
    v_mul_f32 v116, v116, v28
    v_mul_f32 v117, v117, v28
    v_mul_f32 v118, v118, v28
    v_mul_f32 v119, v119, v28
    v_mul_f32 v120, v120, v28
    v_mul_f32 v121, v121, v28
    v_mul_f32 v122, v122, v28
    v_mul_f32 v123, v123, v28
    v_mul_f32 v124, v124, v28
    v_mul_f32 v125, v125, v28
    v_mul_f32 v126, v126, v28
    v_mul_f32 v127, v127, v28
    s_nop 3
    s_branch L_back2
L_fix3:
    s_nop 15
    v_mov_b32 v31, v30
    s_nop 1
    v_permlane32_swap_b32 v30, v31
    v_max3_f32 v30, v30, v31, 0
    v_sub_f32 v28, 0, v30
    v_exp_f32 v28, v28
    v_sub_f32 v160, v160, v30
    v_sub_f32 v161, v161, v30
    v_sub_f32 v162, v162, v30
    v_sub_f32 v163, v163, v30
    v_sub_f32 v164, v164, v30
    v_sub_f32 v165, v165, v30
    v_sub_f32 v166, v166, v30
    v_sub_f32 v167, v167, v30
    v_sub_f32 v168, v168, v30
    v_sub_f32 v169, v169, v30
    v_sub_f32 v170, v170, v30
    v_sub_f32 v171, v171, v30
    v_sub_f32 v172, v172, v30
    v_sub_f32 v173, v173, v30
    v_sub_f32 v174, v174, v30
    v_sub_f32 v175, v175, v30
    v_sub_f32 v176, v176, v30
    v_sub_f32 v177, v177, v30
    v_sub_f32 v178, v178, v30
    v_sub_f32 v179, v179, v30
    v_sub_f32 v180, v180, v30
    v_sub_f32 v181, v181, v30
    v_sub_f32 v182, v182, v30
    v_sub_f32 v183, v183, v30
    v_sub_f32 v184, v184, v30
    v_sub_f32 v185, v185, v30
    v_sub_f32 v186, v186, v30
    v_sub_f32 v187, v187, v30
    v_sub_f32 v188, v188, v30
    v_sub_f32 v189, v189, v30
    v_sub_f32 v190, v190, v30
    v_sub_f32 v191, v191, v30
    v_sub_f32 v224, v224, v30
    v_sub_f32 v225, v225, v30
    v_sub_f32 v226, v226, v30
    v_sub_f32 v227, v227, v30
    v_sub_f32 v228, v228, v30
    v_sub_f32 v229, v229, v30
    v_sub_f32 v230, v230, v30
    v_sub_f32 v231, v231, v30
    v_sub_f32 v232, v232, v30
    v_sub_f32 v233, v233, v30
    v_sub_f32 v234, v234, v30
    v_sub_f32 v235, v235, v30
    v_sub_f32 v236, v236, v30
    v_sub_f32 v237, v237, v30
    v_sub_f32 v238, v238, v30
    v_sub_f32 v239, v239, v30
    v_mul_f32 v27, v27, v28
    v_mul_f32 v64, v64, v28
    v_mul_f32 v65, v65, v28
    v_mul_f32 v66, v66, v28
    v_mul_f32 v67, v67, v28
    v_mul_f32 v68, v68, v28
    v_mul_f32 v69, v69, v28
    v_mul_f32 v70, v70, v28
    v_mul_f32 v71, v71, v28
    v_mul_f32 v72, v72, v28
    v_mul_f32 v73, v73, v28
    v_mul_f32 v74, v74, v28
    v_mul_f32 v75, v75, v28
    v_mul_f32 v76, v76, v28
    v_mul_f32 v77, v77, v28
    v_mul_f32 v78, v78, v28
    v_mul_f32 v79, v79, v28
    v_mul_f32 v80, v80, v28
    v_mul_f32 v81, v81, v28
    v_mul_f32 v82, v82, v28
    v_mul_f32 v83, v83, v28
    v_mul_f32 v84, v84, v28
    v_mul_f32 v85, v85, v28
    v_mul_f32 v86, v86, v28
    v_mul_f32 v87, v87, v28
    v_mul_f32 v88, v88, v28
    v_mul_f32 v89, v89, v28
    v_mul_f32 v90, v90, v28
    v_mul_f32 v91, v91, v28
    v_mul_f32 v92, v92, v28
    v_mul_f32 v93, v93, v28
    v_mul_f32 v94, v94, v28
    v_mul_f32 v95, v95, v28
    v_mul_f32 v96, v96, v28
    v_mul_f32 v97, v97, v28
    v_mul_f32 v98, v98, v28
    v_mul_f32 v99, v99, v28
    v_mul_f32 v100, v100, v28
    v_mul_f32 v101, v101, v28
    v_mul_f32 v102, v102, v28
    v_mul_f32 v103, v103, v28
    v_mul_f32 v104, v104, v28
    v_mul_f32 v105, v105, v28
    v_mul_f32 v106, v106, v28
    v_mul_f32 v107, v107, v28
    v_mul_f32 v108, v108, v28
    v_mul_f32 v109, v109, v28
    v_mul_f32 v110, v110, v28
    v_mul_f32 v111, v111, v28
    v_mul_f32 v112, v112, v28
    v_mul_f32 v113, v113, v28
    v_mul_f32 v114, v114, v28
    v_mul_f32 v115, v115, v28
    v_mul_f32 v116, v116, v28
    v_mul_f32 v117, v117, v28
    v_mul_f32 v118, v118, v28
    v_mul_f32 v119, v119, v28
    v_mul_f32 v120, v120, v28
    v_mul_f32 v121, v121, v28
    v_mul_f32 v122, v122, v28
    v_mul_f32 v123, v123, v28
    v_mul_f32 v124, v124, v28
    v_mul_f32 v125, v125, v28
    v_mul_f32 v126, v126, v28
    v_mul_f32 v127, v127, v28
    s_nop 3
    s_branch L_back3
L_fix4:
    s_nop 15
    v_mov_b32 v31, v30
    s_nop 1
    v_permlane32_swap_b32 v30, v31
    v_max3_f32 v30, v30, v31, 0
    v_sub_f32 v28, 0, v30
    v_exp_f32 v28, v28
    v_sub_f32 v192, v192, v30
    v_sub_f32 v193, v193, v30
    v_sub_f32 v194, v194, v30
    v_sub_f32 v195, v195, v30
    v_sub_f32 v196, v196, v30
    v_sub_f32 v197, v197, v30
    v_sub_f32 v198, v198, v30
    v_sub_f32 v199, v199, v30
    v_sub_f32 v200, v200, v30
    v_sub_f32 v201, v201, v30
    v_sub_f32 v202, v202, v30
    v_sub_f32 v203, v203, v30
    v_sub_f32 v204, v204, v30
    v_sub_f32 v205, v205, v30
    v_sub_f32 v206, v206, v30
    v_sub_f32 v207, v207, v30
    v_sub_f32 v208, v208, v30
    v_sub_f32 v209, v209, v30
    v_sub_f32 v210, v210, v30
    v_sub_f32 v211, v211, v30
    v_sub_f32 v212, v212, v30
    v_sub_f32 v213, v213, v30
    v_sub_f32 v214, v214, v30
    v_sub_f32 v215, v215, v30
    v_sub_f32 v216, v216, v30
    v_sub_f32 v217, v217, v30
    v_sub_f32 v218, v218, v30
    v_sub_f32 v219, v219, v30
    v_sub_f32 v220, v220, v30
    v_sub_f32 v221, v221, v30
    v_sub_f32 v222, v222, v30
    v_sub_f32 v223, v223, v30
    v_sub_f32 v224, v224, v30
    v_sub_f32 v225, v225, v30
    v_sub_f32 v226, v226, v30
    v_sub_f32 v227, v227, v30
    v_sub_f32 v228, v228, v30
    v_sub_f32 v229, v229, v30
    v_sub_f32 v230, v230, v30
    v_sub_f32 v231, v231, v30
    v_sub_f32 v232, v232, v30
    v_sub_f32 v233, v233, v30
    v_sub_f32 v234, v234, v30
    v_sub_f32 v235, v235, v30
    v_sub_f32 v236, v236, v30
    v_sub_f32 v237, v237, v30
    v_sub_f32 v238, v238, v30
    v_sub_f32 v239, v239, v30
    v_mul_f32 v27, v27, v28
    v_mul_f32 v64, v64, v28
    v_mul_f32 v65, v65, v28
    v_mul_f32 v66, v66, v28
    v_mul_f32 v67, v67, v28
    v_mul_f32 v68, v68, v28
    v_mul_f32 v69, v69, v28
    v_mul_f32 v70, v70, v28
    v_mul_f32 v71, v71, v28
    v_mul_f32 v72, v72, v28
    v_mul_f32 v73, v73, v28
    v_mul_f32 v74, v74, v28
    v_mul_f32 v75, v75, v28
    v_mul_f32 v76, v76, v28
    v_mul_f32 v77, v77, v28
    v_mul_f32 v78, v78, v28
    v_mul_f32 v79, v79, v28
    v_mul_f32 v80, v80, v28
    v_mul_f32 v81, v81, v28
    v_mul_f32 v82, v82, v28
    v_mul_f32 v83, v83, v28
    v_mul_f32 v84, v84, v28
    v_mul_f32 v85, v85, v28
    v_mul_f32 v86, v86, v28
    v_mul_f32 v87, v87, v28
    v_mul_f32 v88, v88, v28
    v_mul_f32 v89, v89, v28
    v_mul_f32 v90, v90, v28
    v_mul_f32 v91, v91, v28
    v_mul_f32 v92, v92, v28
    v_mul_f32 v93, v93, v28
    v_mul_f32 v94, v94, v28
    v_mul_f32 v95, v95, v28
    v_mul_f32 v96, v96, v28
    v_mul_f32 v97, v97, v28
    v_mul_f32 v98, v98, v28
    v_mul_f32 v99, v99, v28
    v_mul_f32 v100, v100, v28
    v_mul_f32 v101, v101, v28
    v_mul_f32 v102, v102, v28
    v_mul_f32 v103, v103, v28
    v_mul_f32 v104, v104, v28
    v_mul_f32 v105, v105, v28
    v_mul_f32 v106, v106, v28
    v_mul_f32 v107, v107, v28
    v_mul_f32 v108, v108, v28
    v_mul_f32 v109, v109, v28
    v_mul_f32 v110, v110, v28
    v_mul_f32 v111, v111, v28
    v_mul_f32 v112, v112, v28
    v_mul_f32 v113, v113, v28
    v_mul_f32 v114, v114, v28
    v_mul_f32 v115, v115, v28
    v_mul_f32 v116, v116, v28
    v_mul_f32 v117, v117, v28
    v_mul_f32 v118, v118, v28
    v_mul_f32 v119, v119, v28
    v_mul_f32 v120, v120, v28
    v_mul_f32 v121, v121, v28
    v_mul_f32 v122, v122, v28
    v_mul_f32 v123, v123, v28
    v_mul_f32 v124, v124, v28
    v_mul_f32 v125, v125, v28
    v_mul_f32 v126, v126, v28
    v_mul_f32 v127, v127, v28
    s_nop 3
    s_branch L_back4
L_fix5:
    s_nop 15
    v_mov_b32 v31, v30
    s_nop 1
    v_permlane32_swap_b32 v30, v31
    v_max3_f32 v30, v30, v31, 0
    v_sub_f32 v28, 0, v30
    v_exp_f32 v28, v28
    v_sub_f32 v160, v160, v30
    v_sub_f32 v161, v161, v30
    v_sub_f32 v162, v162, v30
    v_sub_f32 v163, v163, v30
    v_sub_f32 v164, v164, v30
    v_sub_f32 v165, v165, v30
    v_sub_f32 v166, v166, v30
    v_sub_f32 v167, v167, v30
    v_sub_f32 v168, v168, v30
    v_sub_f32 v169, v169, v30
    v_sub_f32 v170, v170, v30
    v_sub_f32 v171, v171, v30
    v_sub_f32 v172, v172, v30
    v_sub_f32 v173, v173, v30
    v_sub_f32 v174, v174, v30
    v_sub_f32 v175, v175, v30
    v_sub_f32 v176, v176, v30
    v_sub_f32 v177, v177, v30
    v_sub_f32 v178, v178, v30
    v_sub_f32 v179, v179, v30
    v_sub_f32 v180, v180, v30
    v_sub_f32 v181, v181, v30
    v_sub_f32 v182, v182, v30
    v_sub_f32 v183, v183, v30
    v_sub_f32 v184, v184, v30
    v_sub_f32 v185, v185, v30
    v_sub_f32 v186, v186, v30
    v_sub_f32 v187, v187, v30
    v_sub_f32 v188, v188, v30
    v_sub_f32 v189, v189, v30
    v_sub_f32 v190, v190, v30
    v_sub_f32 v191, v191, v30
    v_sub_f32 v224, v224, v30
    v_sub_f32 v225, v225, v30
    v_sub_f32 v226, v226, v30
    v_sub_f32 v227, v227, v30
    v_sub_f32 v228, v228, v30
    v_sub_f32 v229, v229, v30
    v_sub_f32 v230, v230, v30
    v_sub_f32 v231, v231, v30
    v_sub_f32 v232, v232, v30
    v_sub_f32 v233, v233, v30
    v_sub_f32 v234, v234, v30
    v_sub_f32 v235, v235, v30
    v_sub_f32 v236, v236, v30
    v_sub_f32 v237, v237, v30
    v_sub_f32 v238, v238, v30
    v_sub_f32 v239, v239, v30
    v_mul_f32 v27, v27, v28
    v_mul_f32 v64, v64, v28
    v_mul_f32 v65, v65, v28
    v_mul_f32 v66, v66, v28
    v_mul_f32 v67, v67, v28
    v_mul_f32 v68, v68, v28
    v_mul_f32 v69, v69, v28
    v_mul_f32 v70, v70, v28
    v_mul_f32 v71, v71, v28
    v_mul_f32 v72, v72, v28
    v_mul_f32 v73, v73, v28
    v_mul_f32 v74, v74, v28
    v_mul_f32 v75, v75, v28
    v_mul_f32 v76, v76, v28
    v_mul_f32 v77, v77, v28
    v_mul_f32 v78, v78, v28
    v_mul_f32 v79, v79, v28
    v_mul_f32 v80, v80, v28
    v_mul_f32 v81, v81, v28
    v_mul_f32 v82, v82, v28
    v_mul_f32 v83, v83, v28
    v_mul_f32 v84, v84, v28
    v_mul_f32 v85, v85, v28
    v_mul_f32 v86, v86, v28
    v_mul_f32 v87, v87, v28
    v_mul_f32 v88, v88, v28
    v_mul_f32 v89, v89, v28
    v_mul_f32 v90, v90, v28
    v_mul_f32 v91, v91, v28
    v_mul_f32 v92, v92, v28
    v_mul_f32 v93, v93, v28
    v_mul_f32 v94, v94, v28
    v_mul_f32 v95, v95, v28
    v_mul_f32 v96, v96, v28
    v_mul_f32 v97, v97, v28
    v_mul_f32 v98, v98, v28
    v_mul_f32 v99, v99, v28
    v_mul_f32 v100, v100, v28
    v_mul_f32 v101, v101, v28
    v_mul_f32 v102, v102, v28
    v_mul_f32 v103, v103, v28
    v_mul_f32 v104, v104, v28
    v_mul_f32 v105, v105, v28
    v_mul_f32 v106, v106, v28
    v_mul_f32 v107, v107, v28
    v_mul_f32 v108, v108, v28
    v_mul_f32 v109, v109, v28
    v_mul_f32 v110, v110, v28
    v_mul_f32 v111, v111, v28
    v_mul_f32 v112, v112, v28
    v_mul_f32 v113, v113, v28
    v_mul_f32 v114, v114, v28
    v_mul_f32 v115, v115, v28
    v_mul_f32 v116, v116, v28
    v_mul_f32 v117, v117, v28
    v_mul_f32 v118, v118, v28
    v_mul_f32 v119, v119, v28
    v_mul_f32 v120, v120, v28
    v_mul_f32 v121, v121, v28
    v_mul_f32 v122, v122, v28
    v_mul_f32 v123, v123, v28
    v_mul_f32 v124, v124, v28
    v_mul_f32 v125, v125, v28
    v_mul_f32 v126, v126, v28
    v_mul_f32 v127, v127, v28
    s_nop 3
    s_branch L_back5
L_fix6:
    s_nop 15
    v_mov_b32 v31, v30
    s_nop 1
    v_permlane32_swap_b32 v30, v31
    v_max3_f32 v30, v30, v31, 0
    v_sub_f32 v28, 0, v30
    v_exp_f32 v28, v28
    v_sub_f32 v192, v192, v30
    v_sub_f32 v193, v193, v30
    v_sub_f32 v194, v194, v30
    v_sub_f32 v195, v195, v30
    v_sub_f32 v196, v196, v30
    v_sub_f32 v197, v197, v30
    v_sub_f32 v198, v198, v30
    v_sub_f32 v199, v199, v30
    v_sub_f32 v200, v200, v30
    v_sub_f32 v201, v201, v30
    v_sub_f32 v202, v202, v30
    v_sub_f32 v203, v203, v30
    v_sub_f32 v204, v204, v30
    v_sub_f32 v205, v205, v30
    v_sub_f32 v206, v206, v30
    v_sub_f32 v207, v207, v30
    v_sub_f32 v208, v208, v30
    v_sub_f32 v209, v209, v30
    v_sub_f32 v210, v210, v30
    v_sub_f32 v211, v211, v30
    v_sub_f32 v212, v212, v30
    v_sub_f32 v213, v213, v30
    v_sub_f32 v214, v214, v30
    v_sub_f32 v215, v215, v30
    v_sub_f32 v216, v216, v30
    v_sub_f32 v217, v217, v30
    v_sub_f32 v218, v218, v30
    v_sub_f32 v219, v219, v30
    v_sub_f32 v220, v220, v30
    v_sub_f32 v221, v221, v30
    v_sub_f32 v222, v222, v30
    v_sub_f32 v223, v223, v30
    v_sub_f32 v224, v224, v30
    v_sub_f32 v225, v225, v30
    v_sub_f32 v226, v226, v30
    v_sub_f32 v227, v227, v30
    v_sub_f32 v228, v228, v30
    v_sub_f32 v229, v229, v30
    v_sub_f32 v230, v230, v30
    v_sub_f32 v231, v231, v30
    v_sub_f32 v232, v232, v30
    v_sub_f32 v233, v233, v30
    v_sub_f32 v234, v234, v30
    v_sub_f32 v235, v235, v30
    v_sub_f32 v236, v236, v30
    v_sub_f32 v237, v237, v30
    v_sub_f32 v238, v238, v30
    v_sub_f32 v239, v239, v30
    v_mul_f32 v27, v27, v28
    v_mul_f32 v64, v64, v28
    v_mul_f32 v65, v65, v28
    v_mul_f32 v66, v66, v28
    v_mul_f32 v67, v67, v28
    v_mul_f32 v68, v68, v28
    v_mul_f32 v69, v69, v28
    v_mul_f32 v70, v70, v28
    v_mul_f32 v71, v71, v28
    v_mul_f32 v72, v72, v28
    v_mul_f32 v73, v73, v28
    v_mul_f32 v74, v74, v28
    v_mul_f32 v75, v75, v28
    v_mul_f32 v76, v76, v28
    v_mul_f32 v77, v77, v28
    v_mul_f32 v78, v78, v28
    v_mul_f32 v79, v79, v28
    v_mul_f32 v80, v80, v28
    v_mul_f32 v81, v81, v28
    v_mul_f32 v82, v82, v28
    v_mul_f32 v83, v83, v28
    v_mul_f32 v84, v84, v28
    v_mul_f32 v85, v85, v28
    v_mul_f32 v86, v86, v28
    v_mul_f32 v87, v87, v28
    v_mul_f32 v88, v88, v28
    v_mul_f32 v89, v89, v28
    v_mul_f32 v90, v90, v28
    v_mul_f32 v91, v91, v28
    v_mul_f32 v92, v92, v28
    v_mul_f32 v93, v93, v28
    v_mul_f32 v94, v94, v28
    v_mul_f32 v95, v95, v28
    v_mul_f32 v96, v96, v28
    v_mul_f32 v97, v97, v28
    v_mul_f32 v98, v98, v28
    v_mul_f32 v99, v99, v28
    v_mul_f32 v100, v100, v28
    v_mul_f32 v101, v101, v28
    v_mul_f32 v102, v102, v28
    v_mul_f32 v103, v103, v28
    v_mul_f32 v104, v104, v28
    v_mul_f32 v105, v105, v28
    v_mul_f32 v106, v106, v28
    v_mul_f32 v107, v107, v28
    v_mul_f32 v108, v108, v28
    v_mul_f32 v109, v109, v28
    v_mul_f32 v110, v110, v28
    v_mul_f32 v111, v111, v28
    v_mul_f32 v112, v112, v28
    v_mul_f32 v113, v113, v28
    v_mul_f32 v114, v114, v28
    v_mul_f32 v115, v115, v28
    v_mul_f32 v116, v116, v28
    v_mul_f32 v117, v117, v28
    v_mul_f32 v118, v118, v28
    v_mul_f32 v119, v119, v28
    v_mul_f32 v120, v120, v28
    v_mul_f32 v121, v121, v28
    v_mul_f32 v122, v122, v28
    v_mul_f32 v123, v123, v28
    v_mul_f32 v124, v124, v28
    v_mul_f32 v125, v125, v28
    v_mul_f32 v126, v126, v28
    v_mul_f32 v127, v127, v28
    s_nop 3
    s_branch L_back6
L_fix7:
    s_nop 15
    v_mov_b32 v31, v30
    s_nop 1
    v_permlane32_swap_b32 v30, v31
    v_max3_f32 v30, v30, v31, 0
    v_sub_f32 v28, 0, v30
    v_exp_f32 v28, v28
    v_sub_f32 v160, v160, v30
    v_sub_f32 v161, v161, v30
    v_sub_f32 v162, v162, v30
    v_sub_f32 v163, v163, v30
    v_sub_f32 v164, v164, v30
    v_sub_f32 v165, v165, v30
    v_sub_f32 v166, v166, v30
    v_sub_f32 v167, v167, v30
    v_sub_f32 v168, v168, v30
    v_sub_f32 v169, v169, v30
    v_sub_f32 v170, v170, v30
    v_sub_f32 v171, v171, v30
    v_sub_f32 v172, v172, v30
    v_sub_f32 v173, v173, v30
    v_sub_f32 v174, v174, v30
    v_sub_f32 v175, v175, v30
    v_sub_f32 v176, v176, v30
    v_sub_f32 v177, v177, v30
    v_sub_f32 v178, v178, v30
    v_sub_f32 v179, v179, v30
    v_sub_f32 v180, v180, v30
    v_sub_f32 v181, v181, v30
    v_sub_f32 v182, v182, v30
    v_sub_f32 v183, v183, v30
    v_sub_f32 v184, v184, v30
    v_sub_f32 v185, v185, v30
    v_sub_f32 v186, v186, v30
    v_sub_f32 v187, v187, v30
    v_sub_f32 v188, v188, v30
    v_sub_f32 v189, v189, v30
    v_sub_f32 v190, v190, v30
    v_sub_f32 v191, v191, v30
    v_sub_f32 v224, v224, v30
    v_sub_f32 v225, v225, v30
    v_sub_f32 v226, v226, v30
    v_sub_f32 v227, v227, v30
    v_sub_f32 v228, v228, v30
    v_sub_f32 v229, v229, v30
    v_sub_f32 v230, v230, v30
    v_sub_f32 v231, v231, v30
    v_sub_f32 v232, v232, v30
    v_sub_f32 v233, v233, v30
    v_sub_f32 v234, v234, v30
    v_sub_f32 v235, v235, v30
    v_sub_f32 v236, v236, v30
    v_sub_f32 v237, v237, v30
    v_sub_f32 v238, v238, v30
    v_sub_f32 v239, v239, v30
    v_mul_f32 v27, v27, v28
    v_mul_f32 v64, v64, v28
    v_mul_f32 v65, v65, v28
    v_mul_f32 v66, v66, v28
    v_mul_f32 v67, v67, v28
    v_mul_f32 v68, v68, v28
    v_mul_f32 v69, v69, v28
    v_mul_f32 v70, v70, v28
    v_mul_f32 v71, v71, v28
    v_mul_f32 v72, v72, v28
    v_mul_f32 v73, v73, v28
    v_mul_f32 v74, v74, v28
    v_mul_f32 v75, v75, v28
    v_mul_f32 v76, v76, v28
    v_mul_f32 v77, v77, v28
    v_mul_f32 v78, v78, v28
    v_mul_f32 v79, v79, v28
    v_mul_f32 v80, v80, v28
    v_mul_f32 v81, v81, v28
    v_mul_f32 v82, v82, v28
    v_mul_f32 v83, v83, v28
    v_mul_f32 v84, v84, v28
    v_mul_f32 v85, v85, v28
    v_mul_f32 v86, v86, v28
    v_mul_f32 v87, v87, v28
    v_mul_f32 v88, v88, v28
    v_mul_f32 v89, v89, v28
    v_mul_f32 v90, v90, v28
    v_mul_f32 v91, v91, v28
    v_mul_f32 v92, v92, v28
    v_mul_f32 v93, v93, v28
    v_mul_f32 v94, v94, v28
    v_mul_f32 v95, v95, v28
    v_mul_f32 v96, v96, v28
    v_mul_f32 v97, v97, v28
    v_mul_f32 v98, v98, v28
    v_mul_f32 v99, v99, v28
    v_mul_f32 v100, v100, v28
    v_mul_f32 v101, v101, v28
    v_mul_f32 v102, v102, v28
    v_mul_f32 v103, v103, v28
    v_mul_f32 v104, v104, v28
    v_mul_f32 v105, v105, v28
    v_mul_f32 v106, v106, v28
    v_mul_f32 v107, v107, v28
    v_mul_f32 v108, v108, v28
    v_mul_f32 v109, v109, v28
    v_mul_f32 v110, v110, v28
    v_mul_f32 v111, v111, v28
    v_mul_f32 v112, v112, v28
    v_mul_f32 v113, v113, v28
    v_mul_f32 v114, v114, v28
    v_mul_f32 v115, v115, v28
    v_mul_f32 v116, v116, v28
    v_mul_f32 v117, v117, v28
    v_mul_f32 v118, v118, v28
    v_mul_f32 v119, v119, v28
    v_mul_f32 v120, v120, v28
    v_mul_f32 v121, v121, v28
    v_mul_f32 v122, v122, v28
    v_mul_f32 v123, v123, v28
    v_mul_f32 v124, v124, v28
    v_mul_f32 v125, v125, v28
    v_mul_f32 v126, v126, v28
    v_mul_f32 v127, v127, v28
    s_nop 3
    s_branch L_back7
L_fix8:
    s_nop 15
    v_mov_b32 v31, v30
    s_nop 1
    v_permlane32_swap_b32 v30, v31
    v_max3_f32 v30, v30, v31, 0
    v_sub_f32 v28, 0, v30
    v_exp_f32 v28, v28
    v_sub_f32 v192, v192, v30
    v_sub_f32 v193, v193, v30
    v_sub_f32 v194, v194, v30
    v_sub_f32 v195, v195, v30
    v_sub_f32 v196, v196, v30
    v_sub_f32 v197, v197, v30
    v_sub_f32 v198, v198, v30
    v_sub_f32 v199, v199, v30
    v_sub_f32 v200, v200, v30
    v_sub_f32 v201, v201, v30
    v_sub_f32 v202, v202, v30
    v_sub_f32 v203, v203, v30
    v_sub_f32 v204, v204, v30
    v_sub_f32 v205, v205, v30
    v_sub_f32 v206, v206, v30
    v_sub_f32 v207, v207, v30
    v_sub_f32 v208, v208, v30
    v_sub_f32 v209, v209, v30
    v_sub_f32 v210, v210, v30
    v_sub_f32 v211, v211, v30
    v_sub_f32 v212, v212, v30
    v_sub_f32 v213, v213, v30
    v_sub_f32 v214, v214, v30
    v_sub_f32 v215, v215, v30
    v_sub_f32 v216, v216, v30
    v_sub_f32 v217, v217, v30
    v_sub_f32 v218, v218, v30
    v_sub_f32 v219, v219, v30
    v_sub_f32 v220, v220, v30
    v_sub_f32 v221, v221, v30
    v_sub_f32 v222, v222, v30
    v_sub_f32 v223, v223, v30
    v_sub_f32 v224, v224, v30
    v_sub_f32 v225, v225, v30
    v_sub_f32 v226, v226, v30
    v_sub_f32 v227, v227, v30
    v_sub_f32 v228, v228, v30
    v_sub_f32 v229, v229, v30
    v_sub_f32 v230, v230, v30
    v_sub_f32 v231, v231, v30
    v_sub_f32 v232, v232, v30
    v_sub_f32 v233, v233, v30
    v_sub_f32 v234, v234, v30
    v_sub_f32 v235, v235, v30
    v_sub_f32 v236, v236, v30
    v_sub_f32 v237, v237, v30
    v_sub_f32 v238, v238, v30
    v_sub_f32 v239, v239, v30
    v_mul_f32 v27, v27, v28
    v_mul_f32 v64, v64, v28
    v_mul_f32 v65, v65, v28
    v_mul_f32 v66, v66, v28
    v_mul_f32 v67, v67, v28
    v_mul_f32 v68, v68, v28
    v_mul_f32 v69, v69, v28
    v_mul_f32 v70, v70, v28
    v_mul_f32 v71, v71, v28
    v_mul_f32 v72, v72, v28
    v_mul_f32 v73, v73, v28
    v_mul_f32 v74, v74, v28
    v_mul_f32 v75, v75, v28
    v_mul_f32 v76, v76, v28
    v_mul_f32 v77, v77, v28
    v_mul_f32 v78, v78, v28
    v_mul_f32 v79, v79, v28
    v_mul_f32 v80, v80, v28
    v_mul_f32 v81, v81, v28
    v_mul_f32 v82, v82, v28
    v_mul_f32 v83, v83, v28
    v_mul_f32 v84, v84, v28
    v_mul_f32 v85, v85, v28
    v_mul_f32 v86, v86, v28
    v_mul_f32 v87, v87, v28
    v_mul_f32 v88, v88, v28
    v_mul_f32 v89, v89, v28
    v_mul_f32 v90, v90, v28
    v_mul_f32 v91, v91, v28
    v_mul_f32 v92, v92, v28
    v_mul_f32 v93, v93, v28
    v_mul_f32 v94, v94, v28
    v_mul_f32 v95, v95, v28
    v_mul_f32 v96, v96, v28
    v_mul_f32 v97, v97, v28
    v_mul_f32 v98, v98, v28
    v_mul_f32 v99, v99, v28
    v_mul_f32 v100, v100, v28
    v_mul_f32 v101, v101, v28
    v_mul_f32 v102, v102, v28
    v_mul_f32 v103, v103, v28
    v_mul_f32 v104, v104, v28
    v_mul_f32 v105, v105, v28
    v_mul_f32 v106, v106, v28
    v_mul_f32 v107, v107, v28
    v_mul_f32 v108, v108, v28
    v_mul_f32 v109, v109, v28
    v_mul_f32 v110, v110, v28
    v_mul_f32 v111, v111, v28
    v_mul_f32 v112, v112, v28
    v_mul_f32 v113, v113, v28
    v_mul_f32 v114, v114, v28
    v_mul_f32 v115, v115, v28
    v_mul_f32 v116, v116, v28
    v_mul_f32 v117, v117, v28
    v_mul_f32 v118, v118, v28
    v_mul_f32 v119, v119, v28
    v_mul_f32 v120, v120, v28
    v_mul_f32 v121, v121, v28
    v_mul_f32 v122, v122, v28
    v_mul_f32 v123, v123, v28
    v_mul_f32 v124, v124, v28
    v_mul_f32 v125, v125, v28
    v_mul_f32 v126, v126, v28
    v_mul_f32 v127, v127, v28
    s_nop 3
    s_branch L_back8
L_gemm1:
    s_sub_u32 s3, s2, 256
    s_cmp_ge_u32 s3, 224
    s_cbranch_scc1 L_main_done
    s_and_b32 s40, s3, 7
    s_lshr_b32 s41, s3, 3
    s_and_b32 s32, s41, 7
    s_and_b32 s33, s41, 24
    s_add_u32 s33, s33, s40
    s_lshr_b32 s42, s40, 1
    s_add_u32 s42, s42, 24
    s_and_b32 s43, s40, 1
    s_lshl_b32 s43, s43, 2
    s_add_u32 s43, s43, s32
    s_cmp_ge_u32 s41, 24
    s_cselect_b32 s33, s42, s33
    s_cselect_b32 s32, s43, s32
    s_load_dwordx4 s[4:7], s[0:1], 48
    s_load_dwordx2 s[50:51], s[0:1], 64
    s_load_dwordx4 s[92:95], s[0:1], 88
    v_and_b32 v1, 63, v0
    v_lshrrev_b32 v252, 6, v0
    s_nop 0
    v_readfirstlane_b32 s34, v252
    s_waitcnt lgkmcnt(0)
    s_mov_b32 s48, s94
    s_mov_b32 s49, s95
    s_mov_b32 s96, s92
    s_and_b32 s97, s93, 0xffff
    s_mov_b32 s98, 256
    s_mov_b32 s99, 0x20000
    s_mov_b32 s8, s4
    s_and_b32 s9, s5, 0xffff
    s_mov_b32 s10, 7340032
    s_mov_b32 s11, 0x20000
    s_add_u32 s12, s48, 2097152
    s_addc_u32 s13, s49, 0
    s_and_b32 s13, s13, 0xffff
    s_mov_b32 s14, 2097152
    s_mov_b32 s15, 0x20000
    s_mov_b32 s16, s6
    s_and_b32 s17, s7, 0xffff
    s_mov_b32 s18, 3584
    s_mov_b32 s19, 0x20000
    s_add_u32 s20, s48, 4194304
    s_addc_u32 s21, s49, 0
    s_and_b32 s21, s21, 0xffff
    s_mov_b32 s22, 1835008
    s_mov_b32 s23, 0x20000
    s_mov_b32 s24, s50
    s_and_b32 s25, s51, 0xffff
    s_mov_b32 s26, 7340032
    s_mov_b32 s27, 0x20000
    s_mul_i32 s44, s34, 57344
    s_lshl_b32 s40, s33, 7
    s_add_u32 s44, s44, s40
    s_lshl_b32 s45, s34, 14
    s_lshl_b32 s40, s32, 7
    s_add_u32 s45, s45, s40
    s_lshr_b32 s37, s34, 2
    s_bfe_u32 s35, s34, 0x10001
    s_and_b32 s36, s34, 1
    v_lshrrev_b32 v252, 3, v1
    v_and_b32 v253, 7, v1
    v_bfe_u32 v254, v1, 4, 1
    v_lshlrev_b32 v254, 2, v254
    v_xor_b32 v253, v253, v254
    s_mov_b32 s38, 1024
    v_mul_lo_u32 v252, v252, s38
    v_lshl_add_u32 v2, v253, 4, v252
    v_add_u32 v3, 7168, v2
    v_lshrrev_b32 v252, 3, v1
    v_and_b32 v253, 7, v1
    v_bfe_u32 v254, v1, 4, 1
    v_lshlrev_b32 v254, 2, v254
    v_xor_b32 v253, v253, v254
    s_mov_b32 s38, 3584
    v_mul_lo_u32 v252, v252, s38
    v_lshl_add_u32 v4, v253, 4, v252
    v_add_u32 v5, 27648, v4
    s_lshl_b32 s39, s34, 11
    v_mov_b32 v24, 0
    buffer_load_dword v25, v24, s[96:99], 0 offen sc1
    s_add_u32 m0, s39, 0
    s_add_u32 s40, s44, 0
    buffer_load_dwordx4 v4, s[8:11], s40 offen lds
    buffer_load_dwordx4 v5, s[8:11], s40 offen offset:1024 lds
    s_add_u32 m0, s39, 32768
    s_add_u32 s40, s44, 458752
    buffer_load_dwordx4 v4, s[8:11], s40 offen lds
    buffer_load_dwordx4 v5, s[8:11], s40 offen offset:1024 lds
    s_add_u32 m0, s39, 65536
    s_add_u32 s40, s44, 917504
    buffer_load_dwordx4 v4, s[8:11], s40 offen lds
    buffer_load_dwordx4 v5, s[8:11], s40 offen offset:1024 lds
    s_add_u32 m0, s39, 98304
    s_add_u32 s40, s44, 1376256
    buffer_load_dwordx4 v4, s[8:11], s40 offen lds
    buffer_load_dwordx4 v5, s[8:11], s40 offen offset:1024 lds
    s_waitcnt vmcnt(8)
L_g1_poll:
    v_readfirstlane_b32 s40, v25
    s_nop 0
    s_cmp_ge_u32 s40, 256
    s_cbranch_scc1 L_g1_go
    s_sleep 8
    buffer_load_dword v25, v24, s[96:99], 0 offen sc1
    s_waitcnt vmcnt(0)
    s_branch L_g1_poll
L_g1_go:
    s_add_u32 m0, s39, 16384
    s_add_u32 s41, s45, 0
    buffer_load_dwordx4 v2, s[12:15], s41 offen sc1 lds
    buffer_load_dwordx4 v3, s[12:15], s41 offen offset:1024 sc1 lds
    s_add_u32 m0, s39, 49152
    s_add_u32 s41, s45, 131072
    buffer_load_dwordx4 v2, s[12:15], s41 offen sc1 lds
    buffer_load_dwordx4 v3, s[12:15], s41 offen offset:1024 sc1 lds
    s_add_u32 m0, s39, 81920
    s_add_u32 s41, s45, 262144
    buffer_load_dwordx4 v2, s[12:15], s41 offen sc1 lds
    buffer_load_dwordx4 v3, s[12:15], s41 offen offset:1024 sc1 lds
    s_add_u32 m0, s39, 114688
    s_add_u32 s41, s45, 393216
    buffer_load_dwordx4 v2, s[12:15], s41 offen sc1 lds
    buffer_load_dwordx4 v3, s[12:15], s41 offen offset:1024 sc1 lds
    s_lshl_b32 s40, s33, 7
    s_lshl_b32 s41, s35, 6
    s_add_u32 s40, s40, s41
    s_lshl_b32 s41, s37, 5
    s_add_u32 s46, s40, s41
    v_lshrrev_b32 v252, 5, v1
    v_lshlrev_b32 v20, 4, v252
    buffer_load_dwordx4 v[16:19], v20, s[16:19], s46 offen
    v_lshrrev_b32 v252, 5, v1
    v_lshlrev_b32 v252, 3, v252
    v_bfe_u32 v254, v1, 2, 2
    v_add_u32 v252, v252, v254
    v_lshlrev_b32 v252, 7, v252
    v_bfe_u32 v253, v1, 4, 1
    v_lshlrev_b32 v253, 5, v253
    v_and_b32 v254, 3, v1
    v_lshl_add_u32 v253, v254, 3, v253
    s_lshl_b32 s38, s36, 6
    v_add_u32 v253, s38, v253
    v_bfe_u32 v254, v1, 3, 1
    v_lshlrev_b32 v254, 6, v254
    v_xor_b32 v253, v253, v254
    v_add_u32 v6, v252, v253
    s_lshl_b32 s38, s37, 13
    v_add_u32 v6, s38, v6
    v_lshrrev_b32 v252, 5, v1
    v_lshlrev_b32 v252, 3, v252
    v_bfe_u32 v254, v1, 2, 2
    v_add_u32 v252, v252, v254
    v_lshlrev_b32 v252, 7, v252
    v_bfe_u32 v253, v1, 4, 1
    v_lshlrev_b32 v253, 5, v253
    v_and_b32 v254, 1, v1
    v_lshl_add_u32 v253, v254, 4, v253
    v_bfe_u32 v254, v1, 1, 1
    v_lshl_add_u32 v253, v254, 3, v253
    s_lshl_b32 s42, s35, 6
    v_add_u32 v253, s42, v253
    v_bfe_u32 v254, v1, 3, 1
    v_lshlrev_b32 v254, 6, v254
    v_xor_b32 v253, v253, v254
    v_add_u32 v7, v252, v253
    v_add_u32 v7, s38, v7
    s_waitcnt vmcnt(7) lgkmcnt(0)
    s_barrier
    v_add_u32 v240, 0, v6
    v_add_u32 v241, 0, v7
    ds_read_b64_tr_b16 v[128:129], v241 offset:0
    ds_read_b64_tr_b16 v[130:131], v241 offset:512
    ds_read_b64_tr_b16 v[132:133], v240 offset:16384
    ds_read_b64_tr_b16 v[134:135], v240 offset:16896
    ds_read_b64_tr_b16 v[136:137], v241 offset:2048
    ds_read_b64_tr_b16 v[138:139], v241 offset:2560
    ds_read_b64_tr_b16 v[140:141], v240 offset:18432
    ds_read_b64_tr_b16 v[142:143], v240 offset:18944
    ds_read_b64_tr_b16 v[144:145], v241 offset:4096
    ds_read_b64_tr_b16 v[146:147], v241 offset:4608
    ds_read_b64_tr_b16 v[148:149], v240 offset:20480
    ds_read_b64_tr_b16 v[150:151], v240 offset:20992
    ds_read_b64_tr_b16 v[152:153], v241 offset:6144
    ds_read_b64_tr_b16 v[154:155], v241 offset:6656
    ds_read_b64_tr_b16 v[156:157], v240 offset:22528
    ds_read_b64_tr_b16 v[158:159], v240 offset:23040
    s_add_u32 m0, s39, 131072
    s_add_u32 s40, s44, 1835008
    buffer_load_dwordx4 v4, s[8:11], s40 offen lds
    buffer_load_dwordx4 v5, s[8:11], s40 offen offset:1024 lds
    s_add_u32 m0, s39, 147456
    s_add_u32 s41, s45, 524288
    buffer_load_dwordx4 v2, s[12:15], s41 offen sc1 lds
    buffer_load_dwordx4 v3, s[12:15], s41 offen offset:1024 sc1 lds
    s_waitcnt vmcnt(9) lgkmcnt(0)
    s_barrier
    v_add_u32 v240, 32768, v6
    v_add_u32 v241, 32768, v7
    v_mfma_f32_32x32x16_bf16 v[64:79], v[128:131], v[132:135], 0
    ds_read_b64_tr_b16 v[160:161], v241 offset:0
    ds_read_b64_tr_b16 v[162:163], v241 offset:512
    ds_read_b64_tr_b16 v[164:165], v240 offset:16384
    ds_read_b64_tr_b16 v[166:167], v240 offset:16896
    ds_read_b64_tr_b16 v[168:169], v241 offset:2048
    ds_read_b64_tr_b16 v[170:171], v241 offset:2560
    v_mfma_f32_32x32x16_bf16 v[64:79], v[136:139], v[140:143], v[64:79]
    ds_read_b64_tr_b16 v[172:173], v240 offset:18432
    ds_read_b64_tr_b16 v[174:175], v240 offset:18944
    ds_read_b64_tr_b16 v[176:177], v241 offset:4096
    ds_read_b64_tr_b16 v[178:179], v241 offset:4608
    ds_read_b64_tr_b16 v[180:181], v240 offset:20480
    ds_read_b64_tr_b16 v[182:183], v240 offset:20992
    v_mfma_f32_32x32x16_bf16 v[64:79], v[144:147], v[148:151], v[64:79]
    ds_read_b64_tr_b16 v[184:185], v241 offset:6144
    ds_read_b64_tr_b16 v[186:187], v241 offset:6656
    ds_read_b64_tr_b16 v[188:189], v240 offset:22528
    ds_read_b64_tr_b16 v[190:191], v240 offset:23040
    s_add_u32 m0, s39, 0
    s_add_u32 s40, s44, 2293760
    v_mfma_f32_32x32x16_bf16 v[64:79], v[152:155], v[156:159], v[64:79]
    buffer_load_dwordx4 v4, s[8:11], s40 offen lds
    buffer_load_dwordx4 v5, s[8:11], s40 offen offset:1024 lds
    s_add_u32 m0, s39, 16384
    s_add_u32 s41, s45, 655360
    buffer_load_dwordx4 v2, s[12:15], s41 offen sc1 lds
    buffer_load_dwordx4 v3, s[12:15], s41 offen offset:1024 sc1 lds
    s_waitcnt vmcnt(11) lgkmcnt(0)
    s_barrier
    v_add_u32 v240, 65536, v6
    v_add_u32 v241, 65536, v7
    v_mfma_f32_32x32x16_bf16 v[64:79], v[160:163], v[164:167], v[64:79]
    ds_read_b64_tr_b16 v[128:129], v241 offset:0
    ds_read_b64_tr_b16 v[130:131], v241 offset:512
    ds_read_b64_tr_b16 v[132:133], v240 offset:16384
    ds_read_b64_tr_b16 v[134:135], v240 offset:16896
    ds_read_b64_tr_b16 v[136:137], v241 offset:2048
    ds_read_b64_tr_b16 v[138:139], v241 offset:2560
    v_mfma_f32_32x32x16_bf16 v[64:79], v[168:171], v[172:175], v[64:79]
    ds_read_b64_tr_b16 v[140:141], v240 offset:18432
    ds_read_b64_tr_b16 v[142:143], v240 offset:18944
    ds_read_b64_tr_b16 v[144:145], v241 offset:4096
    ds_read_b64_tr_b16 v[146:147], v241 offset:4608
    ds_read_b64_tr_b16 v[148:149], v240 offset:20480
    ds_read_b64_tr_b16 v[150:151], v240 offset:20992
    v_mfma_f32_32x32x16_bf16 v[64:79], v[176:179], v[180:183], v[64:79]
    ds_read_b64_tr_b16 v[152:153], v241 offset:6144
    ds_read_b64_tr_b16 v[154:155], v241 offset:6656
    ds_read_b64_tr_b16 v[156:157], v240 offset:22528
    ds_read_b64_tr_b16 v[158:159], v240 offset:23040
    s_add_u32 m0, s39, 32768
    s_add_u32 s40, s44, 2752512
    v_mfma_f32_32x32x16_bf16 v[64:79], v[184:187], v[188:191], v[64:79]
    buffer_load_dwordx4 v4, s[8:11], s40 offen lds
    buffer_load_dwordx4 v5, s[8:11], s40 offen offset:1024 lds
    s_add_u32 m0, s39, 49152
    s_add_u32 s41, s45, 786432
    buffer_load_dwordx4 v2, s[12:15], s41 offen sc1 lds
    buffer_load_dwordx4 v3, s[12:15], s41 offen offset:1024 sc1 lds
    s_waitcnt vmcnt(13) lgkmcnt(0)
    s_barrier
    v_add_u32 v240, 98304, v6
    v_add_u32 v241, 98304, v7
    v_mfma_f32_32x32x16_bf16 v[64:79], v[128:131], v[132:135], v[64:79]
    ds_read_b64_tr_b16 v[160:161], v241 offset:0
    ds_read_b64_tr_b16 v[162:163], v241 offset:512
    ds_read_b64_tr_b16 v[164:165], v240 offset:16384
    ds_read_b64_tr_b16 v[166:167], v240 offset:16896
    ds_read_b64_tr_b16 v[168:169], v241 offset:2048
    ds_read_b64_tr_b16 v[170:171], v241 offset:2560
    v_mfma_f32_32x32x16_bf16 v[64:79], v[136:139], v[140:143], v[64:79]
    ds_read_b64_tr_b16 v[172:173], v240 offset:18432
    ds_read_b64_tr_b16 v[174:175], v240 offset:18944
    ds_read_b64_tr_b16 v[176:177], v241 offset:4096
    ds_read_b64_tr_b16 v[178:179], v241 offset:4608
    ds_read_b64_tr_b16 v[180:181], v240 offset:20480
    ds_read_b64_tr_b16 v[182:183], v240 offset:20992
    v_mfma_f32_32x32x16_bf16 v[64:79], v[144:147], v[148:151], v[64:79]
    ds_read_b64_tr_b16 v[184:185], v241 offset:6144
    ds_read_b64_tr_b16 v[186:187], v241 offset:6656
    ds_read_b64_tr_b16 v[188:189], v240 offset:22528
    ds_read_b64_tr_b16 v[190:191], v240 offset:23040
    s_add_u32 m0, s39, 65536
    s_add_u32 s40, s44, 3211264
    v_mfma_f32_32x32x16_bf16 v[64:79], v[152:155], v[156:159], v[64:79]
    buffer_load_dwordx4 v4, s[8:11], s40 offen lds
    buffer_load_dwordx4 v5, s[8:11], s40 offen offset:1024 lds
    s_add_u32 m0, s39, 81920
    s_add_u32 s41, s45, 917504
    buffer_load_dwordx4 v2, s[12:15], s41 offen sc1 lds
    buffer_load_dwordx4 v3, s[12:15], s41 offen offset:1024 sc1 lds
    s_waitcnt vmcnt(12) lgkmcnt(0)
    s_barrier
    v_add_u32 v240, 131072, v6
    v_add_u32 v241, 131072, v7
    v_mfma_f32_32x32x16_bf16 v[64:79], v[160:163], v[164:167], v[64:79]
    ds_read_b64_tr_b16 v[128:129], v241 offset:0
    ds_read_b64_tr_b16 v[130:131], v241 offset:512
    ds_read_b64_tr_b16 v[132:133], v240 offset:16384
    ds_read_b64_tr_b16 v[134:135], v240 offset:16896
    ds_read_b64_tr_b16 v[136:137], v241 offset:2048
    ds_read_b64_tr_b16 v[138:139], v241 offset:2560
    v_mfma_f32_32x32x16_bf16 v[64:79], v[168:171], v[172:175], v[64:79]
    ds_read_b64_tr_b16 v[140:141], v240 offset:18432
    ds_read_b64_tr_b16 v[142:143], v240 offset:18944
    ds_read_b64_tr_b16 v[144:145], v241 offset:4096
    ds_read_b64_tr_b16 v[146:147], v241 offset:4608
    ds_read_b64_tr_b16 v[148:149], v240 offset:20480
    ds_read_b64_tr_b16 v[150:151], v240 offset:20992
    v_mfma_f32_32x32x16_bf16 v[64:79], v[176:179], v[180:183], v[64:79]
    ds_read_b64_tr_b16 v[152:153], v241 offset:6144
    ds_read_b64_tr_b16 v[154:155], v241 offset:6656
    ds_read_b64_tr_b16 v[156:157], v240 offset:22528
    ds_read_b64_tr_b16 v[158:159], v240 offset:23040
    s_add_u32 m0, s39, 98304
    s_add_u32 s40, s44, 3670016
    v_mfma_f32_32x32x16_bf16 v[64:79], v[184:187], v[188:191], v[64:79]
    buffer_load_dwordx4 v4, s[8:11], s40 offen lds
    buffer_load_dwordx4 v5, s[8:11], s40 offen offset:1024 lds
    s_add_u32 m0, s39, 114688
    s_add_u32 s41, s45, 1048576
    buffer_load_dwordx4 v2, s[12:15], s41 offen sc1 lds
    buffer_load_dwordx4 v3, s[12:15], s41 offen offset:1024 sc1 lds
    s_waitcnt vmcnt(12) lgkmcnt(0)
    s_barrier
    v_add_u32 v240, 0, v6
    v_add_u32 v241, 0, v7
    v_mfma_f32_32x32x16_bf16 v[64:79], v[128:131], v[132:135], v[64:79]
    ds_read_b64_tr_b16 v[160:161], v241 offset:0
    ds_read_b64_tr_b16 v[162:163], v241 offset:512
    ds_read_b64_tr_b16 v[164:165], v240 offset:16384
    ds_read_b64_tr_b16 v[166:167], v240 offset:16896
    ds_read_b64_tr_b16 v[168:169], v241 offset:2048
    ds_read_b64_tr_b16 v[170:171], v241 offset:2560
    v_mfma_f32_32x32x16_bf16 v[64:79], v[136:139], v[140:143], v[64:79]
    ds_read_b64_tr_b16 v[172:173], v240 offset:18432
    ds_read_b64_tr_b16 v[174:175], v240 offset:18944
    ds_read_b64_tr_b16 v[176:177], v241 offset:4096
    ds_read_b64_tr_b16 v[178:179], v241 offset:4608
    ds_read_b64_tr_b16 v[180:181], v240 offset:20480
    ds_read_b64_tr_b16 v[182:183], v240 offset:20992
    v_mfma_f32_32x32x16_bf16 v[64:79], v[144:147], v[148:151], v[64:79]
    ds_read_b64_tr_b16 v[184:185], v241 offset:6144
    ds_read_b64_tr_b16 v[186:187], v241 offset:6656
    ds_read_b64_tr_b16 v[188:189], v240 offset:22528
    ds_read_b64_tr_b16 v[190:191], v240 offset:23040
    s_add_u32 m0, s39, 131072
    s_add_u32 s40, s44, 4128768
    v_mfma_f32_32x32x16_bf16 v[64:79], v[152:155], v[156:159], v[64:79]
    buffer_load_dwordx4 v4, s[8:11], s40 offen lds
    buffer_load_dwordx4 v5, s[8:11], s40 offen offset:1024 lds
    s_add_u32 m0, s39, 147456
    s_add_u32 s41, s45, 1179648
    buffer_load_dwordx4 v2, s[12:15], s41 offen sc1 lds
    buffer_load_dwordx4 v3, s[12:15], s41 offen offset:1024 sc1 lds
    s_waitcnt vmcnt(12) lgkmcnt(0)
    s_barrier
    v_add_u32 v240, 32768, v6
    v_add_u32 v241, 32768, v7
    v_mfma_f32_32x32x16_bf16 v[64:79], v[160:163], v[164:167], v[64:79]
    ds_read_b64_tr_b16 v[128:129], v241 offset:0
    ds_read_b64_tr_b16 v[130:131], v241 offset:512
    ds_read_b64_tr_b16 v[132:133], v240 offset:16384
    ds_read_b64_tr_b16 v[134:135], v240 offset:16896
    ds_read_b64_tr_b16 v[136:137], v241 offset:2048
    ds_read_b64_tr_b16 v[138:139], v241 offset:2560
    v_mfma_f32_32x32x16_bf16 v[64:79], v[168:171], v[172:175], v[64:79]
    ds_read_b64_tr_b16 v[140:141], v240 offset:18432
    ds_read_b64_tr_b16 v[142:143], v240 offset:18944
    ds_read_b64_tr_b16 v[144:145], v241 offset:4096
    ds_read_b64_tr_b16 v[146:147], v241 offset:4608
    ds_read_b64_tr_b16 v[148:149], v240 offset:20480
    ds_read_b64_tr_b16 v[150:151], v240 offset:20992
    v_mfma_f32_32x32x16_bf16 v[64:79], v[176:179], v[180:183], v[64:79]
    ds_read_b64_tr_b16 v[152:153], v241 offset:6144
    ds_read_b64_tr_b16 v[154:155], v241 offset:6656
    ds_read_b64_tr_b16 v[156:157], v240 offset:22528
    ds_read_b64_tr_b16 v[158:159], v240 offset:23040
    s_add_u32 m0, s39, 0
    s_add_u32 s40, s44, 4587520
    v_mfma_f32_32x32x16_bf16 v[64:79], v[184:187], v[188:191], v[64:79]
    buffer_load_dwordx4 v4, s[8:11], s40 offen lds
    buffer_load_dwordx4 v5, s[8:11], s40 offen offset:1024 lds
    s_add_u32 m0, s39, 16384
    s_add_u32 s41, s45, 1310720
    buffer_load_dwordx4 v2, s[12:15], s41 offen sc1 lds
    buffer_load_dwordx4 v3, s[12:15], s41 offen offset:1024 sc1 lds
    s_waitcnt vmcnt(12) lgkmcnt(0)
    s_barrier
    v_add_u32 v240, 65536, v6
    v_add_u32 v241, 65536, v7
    v_mfma_f32_32x32x16_bf16 v[64:79], v[128:131], v[132:135], v[64:79]
    ds_read_b64_tr_b16 v[160:161], v241 offset:0
    ds_read_b64_tr_b16 v[162:163], v241 offset:512
    ds_read_b64_tr_b16 v[164:165], v240 offset:16384
    ds_read_b64_tr_b16 v[166:167], v240 offset:16896
    ds_read_b64_tr_b16 v[168:169], v241 offset:2048
    ds_read_b64_tr_b16 v[170:171], v241 offset:2560
    v_mfma_f32_32x32x16_bf16 v[64:79], v[136:139], v[140:143], v[64:79]
    ds_read_b64_tr_b16 v[172:173], v240 offset:18432
    ds_read_b64_tr_b16 v[174:175], v240 offset:18944
    ds_read_b64_tr_b16 v[176:177], v241 offset:4096
    ds_read_b64_tr_b16 v[178:179], v241 offset:4608
    ds_read_b64_tr_b16 v[180:181], v240 offset:20480
    ds_read_b64_tr_b16 v[182:183], v240 offset:20992
    v_mfma_f32_32x32x16_bf16 v[64:79], v[144:147], v[148:151], v[64:79]
    ds_read_b64_tr_b16 v[184:185], v241 offset:6144
    ds_read_b64_tr_b16 v[186:187], v241 offset:6656
    ds_read_b64_tr_b16 v[188:189], v240 offset:22528
    ds_read_b64_tr_b16 v[190:191], v240 offset:23040
    s_add_u32 m0, s39, 32768
    s_add_u32 s40, s44, 5046272
    v_mfma_f32_32x32x16_bf16 v[64:79], v[152:155], v[156:159], v[64:79]
    buffer_load_dwordx4 v4, s[8:11], s40 offen lds
    buffer_load_dwordx4 v5, s[8:11], s40 offen offset:1024 lds
    s_add_u32 m0, s39, 49152
    s_add_u32 s41, s45, 1441792
    buffer_load_dwordx4 v2, s[12:15], s41 offen sc1 lds
    buffer_load_dwordx4 v3, s[12:15], s41 offen offset:1024 sc1 lds
    s_waitcnt vmcnt(12) lgkmcnt(0)
    s_barrier
    v_add_u32 v240, 98304, v6
    v_add_u32 v241, 98304, v7
    v_mfma_f32_32x32x16_bf16 v[64:79], v[160:163], v[164:167], v[64:79]
    ds_read_b64_tr_b16 v[128:129], v241 offset:0
    ds_read_b64_tr_b16 v[130:131], v241 offset:512
    ds_read_b64_tr_b16 v[132:133], v240 offset:16384
    ds_read_b64_tr_b16 v[134:135], v240 offset:16896
    ds_read_b64_tr_b16 v[136:137], v241 offset:2048
    ds_read_b64_tr_b16 v[138:139], v241 offset:2560
    v_mfma_f32_32x32x16_bf16 v[64:79], v[168:171], v[172:175], v[64:79]
    ds_read_b64_tr_b16 v[140:141], v240 offset:18432
    ds_read_b64_tr_b16 v[142:143], v240 offset:18944
    ds_read_b64_tr_b16 v[144:145], v241 offset:4096
    ds_read_b64_tr_b16 v[146:147], v241 offset:4608
    ds_read_b64_tr_b16 v[148:149], v240 offset:20480
    ds_read_b64_tr_b16 v[150:151], v240 offset:20992
    v_mfma_f32_32x32x16_bf16 v[64:79], v[176:179], v[180:183], v[64:79]
    ds_read_b64_tr_b16 v[152:153], v241 offset:6144
    ds_read_b64_tr_b16 v[154:155], v241 offset:6656
    ds_read_b64_tr_b16 v[156:157], v240 offset:22528
    ds_read_b64_tr_b16 v[158:159], v240 offset:23040
    s_add_u32 m0, s39, 65536
    s_add_u32 s40, s44, 5505024
    v_mfma_f32_32x32x16_bf16 v[64:79], v[184:187], v[188:191], v[64:79]
    buffer_load_dwordx4 v4, s[8:11], s40 offen lds
    buffer_load_dwordx4 v5, s[8:11], s40 offen offset:1024 lds
    s_add_u32 m0, s39, 81920
    s_add_u32 s41, s45, 1572864
    buffer_load_dwordx4 v2, s[12:15], s41 offen sc1 lds
    buffer_load_dwordx4 v3, s[12:15], s41 offen offset:1024 sc1 lds
    s_waitcnt vmcnt(12) lgkmcnt(0)
    s_barrier
    v_add_u32 v240, 131072, v6
    v_add_u32 v241, 131072, v7
    v_mfma_f32_32x32x16_bf16 v[64:79], v[128:131], v[132:135], v[64:79]
    ds_read_b64_tr_b16 v[160:161], v241 offset:0
    ds_read_b64_tr_b16 v[162:163], v241 offset:512
    ds_read_b64_tr_b16 v[164:165], v240 offset:16384
    ds_read_b64_tr_b16 v[166:167], v240 offset:16896
    ds_read_b64_tr_b16 v[168:169], v241 offset:2048
    ds_read_b64_tr_b16 v[170:171], v241 offset:2560
    v_mfma_f32_32x32x16_bf16 v[64:79], v[136:139], v[140:143], v[64:79]
    ds_read_b64_tr_b16 v[172:173], v240 offset:18432
    ds_read_b64_tr_b16 v[174:175], v240 offset:18944
    ds_read_b64_tr_b16 v[176:177], v241 offset:4096
    ds_read_b64_tr_b16 v[178:179], v241 offset:4608
    ds_read_b64_tr_b16 v[180:181], v240 offset:20480
    ds_read_b64_tr_b16 v[182:183], v240 offset:20992
    v_mfma_f32_32x32x16_bf16 v[64:79], v[144:147], v[148:151], v[64:79]
    ds_read_b64_tr_b16 v[184:185], v241 offset:6144
    ds_read_b64_tr_b16 v[186:187], v241 offset:6656
    ds_read_b64_tr_b16 v[188:189], v240 offset:22528
    ds_read_b64_tr_b16 v[190:191], v240 offset:23040
    s_add_u32 m0, s39, 98304
    s_add_u32 s40, s44, 5963776
    v_mfma_f32_32x32x16_bf16 v[64:79], v[152:155], v[156:159], v[64:79]
    buffer_load_dwordx4 v4, s[8:11], s40 offen lds
    buffer_load_dwordx4 v5, s[8:11], s40 offen offset:1024 lds
    s_add_u32 m0, s39, 114688
    s_add_u32 s41, s45, 1703936
    buffer_load_dwordx4 v2, s[12:15], s41 offen sc1 lds
    buffer_load_dwordx4 v3, s[12:15], s41 offen offset:1024 sc1 lds
    s_waitcnt vmcnt(12) lgkmcnt(0)
    s_barrier
    v_add_u32 v240, 0, v6
    v_add_u32 v241, 0, v7
    v_mfma_f32_32x32x16_bf16 v[64:79], v[160:163], v[164:167], v[64:79]
    ds_read_b64_tr_b16 v[128:129], v241 offset:0
    ds_read_b64_tr_b16 v[130:131], v241 offset:512
    ds_read_b64_tr_b16 v[132:133], v240 offset:16384
    ds_read_b64_tr_b16 v[134:135], v240 offset:16896
    ds_read_b64_tr_b16 v[136:137], v241 offset:2048
    ds_read_b64_tr_b16 v[138:139], v241 offset:2560
    v_mfma_f32_32x32x16_bf16 v[64:79], v[168:171], v[172:175], v[64:79]
    ds_read_b64_tr_b16 v[140:141], v240 offset:18432
    ds_read_b64_tr_b16 v[142:143], v240 offset:18944
    ds_read_b64_tr_b16 v[144:145], v241 offset:4096
    ds_read_b64_tr_b16 v[146:147], v241 offset:4608
    ds_read_b64_tr_b16 v[148:149], v240 offset:20480
    ds_read_b64_tr_b16 v[150:151], v240 offset:20992
    v_mfma_f32_32x32x16_bf16 v[64:79], v[176:179], v[180:183], v[64:79]
    ds_read_b64_tr_b16 v[152:153], v241 offset:6144
    ds_read_b64_tr_b16 v[154:155], v241 offset:6656
    ds_read_b64_tr_b16 v[156:157], v240 offset:22528
    ds_read_b64_tr_b16 v[158:159], v240 offset:23040
    s_add_u32 m0, s39, 131072
    s_add_u32 s40, s44, 6422528
    v_mfma_f32_32x32x16_bf16 v[64:79], v[184:187], v[188:191], v[64:79]
    buffer_load_dwordx4 v4, s[8:11], s40 offen lds
    buffer_load_dwordx4 v5, s[8:11], s40 offen offset:1024 lds
    s_add_u32 m0, s39, 147456
    s_add_u32 s41, s45, 1835008
    buffer_load_dwordx4 v2, s[12:15], s41 offen sc1 lds
    buffer_load_dwordx4 v3, s[12:15], s41 offen offset:1024 sc1 lds
    s_waitcnt vmcnt(12) lgkmcnt(0)
    s_barrier
    v_add_u32 v240, 32768, v6
    v_add_u32 v241, 32768, v7
    v_mfma_f32_32x32x16_bf16 v[64:79], v[128:131], v[132:135], v[64:79]
    ds_read_b64_tr_b16 v[160:161], v241 offset:0
    ds_read_b64_tr_b16 v[162:163], v241 offset:512
    ds_read_b64_tr_b16 v[164:165], v240 offset:16384
    ds_read_b64_tr_b16 v[166:167], v240 offset:16896
    ds_read_b64_tr_b16 v[168:169], v241 offset:2048
    ds_read_b64_tr_b16 v[170:171], v241 offset:2560
    v_mfma_f32_32x32x16_bf16 v[64:79], v[136:139], v[140:143], v[64:79]
    ds_read_b64_tr_b16 v[172:173], v240 offset:18432
    ds_read_b64_tr_b16 v[174:175], v240 offset:18944
    ds_read_b64_tr_b16 v[176:177], v241 offset:4096
    ds_read_b64_tr_b16 v[178:179], v241 offset:4608
    ds_read_b64_tr_b16 v[180:181], v240 offset:20480
    ds_read_b64_tr_b16 v[182:183], v240 offset:20992
    v_mfma_f32_32x32x16_bf16 v[64:79], v[144:147], v[148:151], v[64:79]
    ds_read_b64_tr_b16 v[184:185], v241 offset:6144
    ds_read_b64_tr_b16 v[186:187], v241 offset:6656
    ds_read_b64_tr_b16 v[188:189], v240 offset:22528
    ds_read_b64_tr_b16 v[190:191], v240 offset:23040
    s_add_u32 m0, s39, 0
    s_add_u32 s40, s44, 6881280
    v_mfma_f32_32x32x16_bf16 v[64:79], v[152:155], v[156:159], v[64:79]
    buffer_load_dwordx4 v4, s[8:11], s40 offen lds
    buffer_load_dwordx4 v5, s[8:11], s40 offen offset:1024 lds
    s_add_u32 m0, s39, 16384
    s_add_u32 s41, s45, 1966080
    buffer_load_dwordx4 v2, s[12:15], s41 offen sc1 lds
    buffer_load_dwordx4 v3, s[12:15], s41 offen offset:1024 sc1 lds
    s_waitcnt vmcnt(12) lgkmcnt(0)
    s_barrier
    v_add_u32 v240, 65536, v6
    v_add_u32 v241, 65536, v7
    v_mfma_f32_32x32x16_bf16 v[64:79], v[160:163], v[164:167], v[64:79]
    ds_read_b64_tr_b16 v[128:129], v241 offset:0
    ds_read_b64_tr_b16 v[130:131], v241 offset:512
    ds_read_b64_tr_b16 v[132:133], v240 offset:16384
    ds_read_b64_tr_b16 v[134:135], v240 offset:16896
    v_mfma_f32_32x32x16_bf16 v[64:79], v[168:171], v[172:175], v[64:79]
    ds_read_b64_tr_b16 v[136:137], v241 offset:2048
    ds_read_b64_tr_b16 v[138:139], v241 offset:2560
    ds_read_b64_tr_b16 v[140:141], v240 offset:18432
    ds_read_b64_tr_b16 v[142:143], v240 offset:18944
    v_mfma_f32_32x32x16_bf16 v[64:79], v[176:179], v[180:183], v[64:79]
    ds_read_b64_tr_b16 v[144:145], v241 offset:4096
    ds_read_b64_tr_b16 v[146:147], v241 offset:4608
    ds_read_b64_tr_b16 v[148:149], v240 offset:20480
    ds_read_b64_tr_b16 v[150:151], v240 offset:20992
    v_mfma_f32_32x32x16_bf16 v[64:79], v[184:187], v[188:191], v[64:79]
    ds_read_b64_tr_b16 v[152:153], v241 offset:6144
    ds_read_b64_tr_b16 v[154:155], v241 offset:6656
    ds_read_b64_tr_b16 v[156:157], v240 offset:22528
    ds_read_b64_tr_b16 v[158:159], v240 offset:23040
    s_waitcnt vmcnt(8) lgkmcnt(0)
    s_barrier
    v_add_u32 v240, 98304, v6
    v_add_u32 v241, 98304, v7
    v_mfma_f32_32x32x16_bf16 v[64:79], v[128:131], v[132:135], v[64:79]
    ds_read_b64_tr_b16 v[160:161], v241 offset:0
    ds_read_b64_tr_b16 v[162:163], v241 offset:512
    ds_read_b64_tr_b16 v[164:165], v240 offset:16384
    ds_read_b64_tr_b16 v[166:167], v240 offset:16896
    v_mfma_f32_32x32x16_bf16 v[64:79], v[136:139], v[140:143], v[64:79]
    ds_read_b64_tr_b16 v[168:169], v241 offset:2048
    ds_read_b64_tr_b16 v[170:171], v241 offset:2560
    ds_read_b64_tr_b16 v[172:173], v240 offset:18432
    ds_read_b64_tr_b16 v[174:175], v240 offset:18944
    v_mfma_f32_32x32x16_bf16 v[64:79], v[144:147], v[148:151], v[64:79]
    ds_read_b64_tr_b16 v[176:177], v241 offset:4096
    ds_read_b64_tr_b16 v[178:179], v241 offset:4608
    ds_read_b64_tr_b16 v[180:181], v240 offset:20480
    ds_read_b64_tr_b16 v[182:183], v240 offset:20992
    v_mfma_f32_32x32x16_bf16 v[64:79], v[152:155], v[156:159], v[64:79]
    ds_read_b64_tr_b16 v[184:185], v241 offset:6144
    ds_read_b64_tr_b16 v[186:187], v241 offset:6656
    ds_read_b64_tr_b16 v[188:189], v240 offset:22528
    ds_read_b64_tr_b16 v[190:191], v240 offset:23040
    s_waitcnt vmcnt(4) lgkmcnt(0)
    s_barrier
    v_add_u32 v240, 131072, v6
    v_add_u32 v241, 131072, v7
    v_mfma_f32_32x32x16_bf16 v[64:79], v[160:163], v[164:167], v[64:79]
    ds_read_b64_tr_b16 v[128:129], v241 offset:0
    ds_read_b64_tr_b16 v[130:131], v241 offset:512
    ds_read_b64_tr_b16 v[132:133], v240 offset:16384
    ds_read_b64_tr_b16 v[134:135], v240 offset:16896
    v_mfma_f32_32x32x16_bf16 v[64:79], v[168:171], v[172:175], v[64:79]
    ds_read_b64_tr_b16 v[136:137], v241 offset:2048
    ds_read_b64_tr_b16 v[138:139], v241 offset:2560
    ds_read_b64_tr_b16 v[140:141], v240 offset:18432
    ds_read_b64_tr_b16 v[142:143], v240 offset:18944
    v_mfma_f32_32x32x16_bf16 v[64:79], v[176:179], v[180:183], v[64:79]
    ds_read_b64_tr_b16 v[144:145], v241 offset:4096
    ds_read_b64_tr_b16 v[146:147], v241 offset:4608
    ds_read_b64_tr_b16 v[148:149], v240 offset:20480
    ds_read_b64_tr_b16 v[150:151], v240 offset:20992
    v_mfma_f32_32x32x16_bf16 v[64:79], v[184:187], v[188:191], v[64:79]
    ds_read_b64_tr_b16 v[152:153], v241 offset:6144
    ds_read_b64_tr_b16 v[154:155], v241 offset:6656
    ds_read_b64_tr_b16 v[156:157], v240 offset:22528
    ds_read_b64_tr_b16 v[158:159], v240 offset:23040
    s_waitcnt vmcnt(0) lgkmcnt(0)
    s_barrier
    v_add_u32 v240, 0, v6
    v_add_u32 v241, 0, v7
    v_mfma_f32_32x32x16_bf16 v[64:79], v[128:131], v[132:135], v[64:79]
    ds_read_b64_tr_b16 v[160:161], v241 offset:0
    ds_read_b64_tr_b16 v[162:163], v241 offset:512
    ds_read_b64_tr_b16 v[164:165], v240 offset:16384
    ds_read_b64_tr_b16 v[166:167], v240 offset:16896
    ds_read_b64_tr_b16 v[168:169], v241 offset:2048
    ds_read_b64_tr_b16 v[170:171], v241 offset:2560
    ds_read_b64_tr_b16 v[172:173], v240 offset:18432
    v_mfma_f32_32x32x16_bf16 v[64:79], v[136:139], v[140:143], v[64:79]
    ds_read_b64_tr_b16 v[174:175], v240 offset:18944
    ds_read_b64_tr_b16 v[176:177], v241 offset:4096
    ds_read_b64_tr_b16 v[178:179], v241 offset:4608
    ds_read_b64_tr_b16 v[180:181], v240 offset:20480
    ds_read_b64_tr_b16 v[182:183], v240 offset:20992
    ds_read_b64_tr_b16 v[184:185], v241 offset:6144
    ds_read_b64_tr_b16 v[186:187], v241 offset:6656
    v_mfma_f32_32x32x16_bf16 v[64:79], v[144:147], v[148:151], v[64:79]
    ds_read_b64_tr_b16 v[188:189], v240 offset:22528
    ds_read_b64_tr_b16 v[190:191], v240 offset:23040
    s_lshr_b32 s42, s3, 3
    s_lshl_b32 s42, s42, 3
    s_add_u32 s42, s42, s34
    s_lshl_b32 s42, s42, 15
    s_and_b32 s43, s3, 3
    v_mfma_f32_32x32x16_bf16 v[64:79], v[152:155], v[156:159], v[64:79]
    s_lshl_b32 s43, s43, 10
    s_add_u32 s42, s42, s43
    v_lshrrev_b32 v252, 3, v1
    v_and_b32 v253, 7, v1
    v_lshlrev_b32 v253, 7, v253
    v_lshl_add_u32 v252, v252, 12, v253
    buffer_load_dword v22, v252, s[24:27], s42 offen
    s_waitcnt lgkmcnt(12)
    v_mfma_f32_32x32x16_bf16 v[64:79], v[160:163], v[164:167], v[64:79]
    s_waitcnt lgkmcnt(8)
    v_mfma_f32_32x32x16_bf16 v[64:79], v[168:171], v[172:175], v[64:79]
    s_waitcnt lgkmcnt(4)
    v_mfma_f32_32x32x16_bf16 v[64:79], v[176:179], v[180:183], v[64:79]
    s_waitcnt lgkmcnt(0)
    v_mfma_f32_32x32x16_bf16 v[64:79], v[184:187], v[188:191], v[64:79]
    s_lshl_b32 s38, s34, 12
    v_lshlrev_b32 v252, 4, v1
    v_add_u32 v253, s38, v252
    v_add_u32 v253, 32768, v253
    s_nop 7
    ds_write_b128 v253, v[64:67] offset:0
    ds_write_b128 v253, v[68:71] offset:1024
    ds_write_b128 v253, v[72:75] offset:2048
    ds_write_b128 v253, v[76:79] offset:3072
    s_and_b32 s38, s34, 3
    s_lshl_b32 s38, s38, 12
    s_lshl_b32 s40, s37, 11
    s_add_u32 s38, s38, s40
    v_add_u32 v253, s38, v252
    v_add_u32 v253, 32768, v253
    s_waitcnt lgkmcnt(0)
    s_barrier
    ds_read_b128 v[64:67], v253
    ds_read_b128 v[68:71], v253 offset:1024
    ds_read_b128 v[72:75], v253 offset:16384
    ds_read_b128 v[76:79], v253 offset:17408
    s_waitcnt lgkmcnt(1)
    v_add_f32 v64, v64, v72
    v_add_f32 v65, v65, v73
    v_add_f32 v66, v66, v74
    v_add_f32 v67, v67, v75
    s_waitcnt lgkmcnt(0)
    v_add_f32 v68, v68, v76
    v_add_f32 v69, v69, v77
    v_add_f32 v70, v70, v78
    v_add_f32 v71, v71, v79
    s_mov_b32 s40, 0xffff0000
    s_mov_b32 s41, 0xc0135761
    s_mov_b32 s42, 0xbdd2d3e8
    v_lshlrev_b32 v72, 16, v16
    v_and_b32 v73, s40, v16
    v_lshlrev_b32 v74, 16, v17
    v_and_b32 v75, s40, v17
    v_lshlrev_b32 v76, 16, v18
    v_and_b32 v77, s40, v18
    v_lshlrev_b32 v78, 16, v19
    v_and_b32 v79, s40, v19
    v_add_f32 v64, v64, v72
    v_add_f32 v65, v65, v73
    v_add_f32 v66, v66, v74
    v_add_f32 v67, v67, v75
    v_add_f32 v68, v68, v76
    v_add_f32 v69, v69, v77
    v_add_f32 v70, v70, v78
    v_add_f32 v71, v71, v79
    v_mul_f32 v72, v64, v64
    v_mul_f32 v73, v65, v65
    v_mul_f32 v74, v66, v66
    v_mul_f32 v75, v67, v67
    v_mul_f32 v76, v68, v68
    v_mul_f32 v77, v69, v69
    v_mul_f32 v78, v70, v70
    v_mul_f32 v79, v71, v71
    v_mov_b32 v21, s41
    v_fma_f32 v72, v72, s42, v21
    v_fma_f32 v73, v73, s42, v21
    v_fma_f32 v74, v74, s42, v21
    v_fma_f32 v75, v75, s42, v21
    v_fma_f32 v76, v76, s42, v21
    v_fma_f32 v77, v77, s42, v21
    v_fma_f32 v78, v78, s42, v21
    v_fma_f32 v79, v79, s42, v21
    v_mul_f32 v72, v72, v64
    v_mul_f32 v73, v73, v65
    v_mul_f32 v74, v74, v66
    v_mul_f32 v75, v75, v67
    v_mul_f32 v76, v76, v68
    v_mul_f32 v77, v77, v69
    v_mul_f32 v78, v78, v70
    v_mul_f32 v79, v79, v71
    v_exp_f32 v72, v72
    v_exp_f32 v73, v73
    v_exp_f32 v74, v74
    v_exp_f32 v75, v75
    v_exp_f32 v76, v76
    v_exp_f32 v77, v77
    v_exp_f32 v78, v78
    v_exp_f32 v79, v79
    v_add_f32 v72, 1.0, v72
    v_add_f32 v73, 1.0, v73
    v_add_f32 v74, 1.0, v74
    v_add_f32 v75, 1.0, v75
    v_add_f32 v76, 1.0, v76
    v_add_f32 v77, 1.0, v77
    v_add_f32 v78, 1.0, v78
    v_add_f32 v79, 1.0, v79
    v_rcp_f32 v72, v72
    v_rcp_f32 v73, v73
    v_rcp_f32 v74, v74
    v_rcp_f32 v75, v75
    v_rcp_f32 v76, v76
    v_rcp_f32 v77, v77
    v_rcp_f32 v78, v78
    v_rcp_f32 v79, v79
    v_mul_f32 v64, v64, v72
    v_mul_f32 v65, v65, v73
    v_mul_f32 v66, v66, v74
    v_mul_f32 v67, v67, v75
    v_mul_f32 v68, v68, v76
    v_mul_f32 v69, v69, v77
    v_mul_f32 v70, v70, v78
    v_mul_f32 v71, v71, v79
    v_cvt_pk_bf16_f32 v80, v64, v65
    v_cvt_pk_bf16_f32 v81, v66, v67
    v_cvt_pk_bf16_f32 v82, v68, v69
    v_cvt_pk_bf16_f32 v83, v70, v71
    v_and_b32 v252, 31, v1
    s_lshl_b32 s40, s32, 6
    s_lshl_b32 s41, s36, 5
    s_add_u32 s40, s40, s41
    v_add_u32 v252, s40, v252
    s_mov_b32 s41, 3584
    v_mul_lo_u32 v252, v252, s41
    v_add_u32 v252, v252, v20
    buffer_store_dwordx4 v[80:83], v252, s[20:23], s46 offen
L_main_done:
    s_endpgm

.globl final_kernel
.p2align 8
.type final_kernel,@function
final_kernel:
    s_cmp_ge_u32 s2, 256
    s_cbranch_scc1 L_fin_done
    s_lshr_b32 s3, s2, 3
    s_bfe_u32 s32, s2, 0x10002
    s_lshl_b32 s32, s32, 2
    s_lshr_b32 s33, s3, 3
    s_add_u32 s32, s32, s33
    s_and_b32 s33, s2, 3
    s_lshl_b32 s33, s33, 3
    s_and_b32 s40, s3, 7
    s_add_u32 s33, s33, s40
    s_load_dwordx2 s[4:5], s[0:1], 0
    s_load_dwordx4 s[44:47], s[0:1], 64
    s_load_dwordx2 s[6:7], s[0:1], 80
    s_load_dwordx2 s[48:49], s[0:1], 96
    v_and_b32 v1, 63, v0
    v_lshrrev_b32 v252, 6, v0
    s_nop 0
    v_readfirstlane_b32 s34, v252
    s_waitcnt lgkmcnt(0)
    s_add_u32 s8, s48, 4194304
    s_addc_u32 s9, s49, 0
    s_and_b32 s9, s9, 0xffff
    s_mov_b32 s10, 1835008
    s_mov_b32 s11, 0x20000
    s_mov_b32 s12, s44
    s_and_b32 s13, s45, 0xffff
    s_mov_b32 s14, 7340032
    s_mov_b32 s15, 0x20000
    s_mov_b32 s16, s46
    s_and_b32 s17, s47, 0xffff
    s_mov_b32 s18, 4096
    s_mov_b32 s19, 0x20000
    s_mov_b32 s20, s4
    s_and_b32 s21, s5, 0xffff
    s_mov_b32 s22, 2097152
    s_mov_b32 s23, 0x20000
    s_mov_b32 s24, s6
    s_and_b32 s25, s7, 0xffff
    s_mov_b32 s26, 2097152
    s_mov_b32 s27, 0x20000
    s_add_u32 s28, s48, 8388608
    s_addc_u32 s29, s49, 0
    s_and_b32 s29, s29, 0xffff
    s_mov_b32 s30, 16777216
    s_mov_b32 s31, 0x20000
    s_lshl_b32 s40, s32, 6
    s_lshl_b32 s41, s34, 3
    s_add_u32 s40, s40, s41
    s_mul_i32 s52, s40, 3584
    s_lshl_b32 s53, s34, 16
    s_lshl_b32 s40, s33, 7
    s_add_u32 s53, s53, s40
    s_lshr_b32 s37, s34, 2
    s_bfe_u32 s35, s34, 0x10001
    s_and_b32 s36, s34, 1
    v_lshrrev_b32 v252, 3, v1
    v_and_b32 v253, 7, v1
    v_bfe_u32 v254, v1, 4, 1
    v_lshlrev_b32 v254, 2, v254
    v_xor_b32 v253, v253, v254
    s_mov_b32 s38, 4096
    v_mul_lo_u32 v252, v252, s38
    v_lshl_add_u32 v2, v253, 4, v252
    v_add_u32 v3, 31744, v2
    v_lshrrev_b32 v252, 4, v1
    s_and_b32 s38, s34, 1
    s_lshl_b32 s38, s38, 3
    v_and_b32 v253, 15, v1
    s_mov_b32 s39, 3584
    v_add_u32 v254, 0, v252
    v_add_u32 v255, s38, v254
    v_xor_b32 v255, v253, v255
    v_mul_lo_u32 v254, v254, s39
    v_lshl_add_u32 v4, v255, 4, v254
    v_add_u32 v254, 4, v252
    v_add_u32 v255, s38, v254
    v_xor_b32 v255, v253, v255
    v_mul_lo_u32 v254, v254, s39
    v_lshl_add_u32 v5, v255, 4, v254
    v_subrev_u32 v5, 1024, v5
    s_lshl_b32 s39, s34, 11
    s_add_u32 m0, s39, 0
    s_add_u32 s40, s52, 0
    buffer_load_dwordx4 v4, s[8:11], s40 offen lds
    buffer_load_dwordx4 v5, s[8:11], s40 offen offset:1024 lds
    s_add_u32 m0, s39, 16384
    s_add_u32 s41, s53, 0
    buffer_load_dwordx4 v2, s[12:15], s41 offen lds
    buffer_load_dwordx4 v3, s[12:15], s41 offen offset:1024 lds
    s_add_u32 m0, s39, 32768
    s_add_u32 s40, s52, 256
    buffer_load_dwordx4 v4, s[8:11], s40 offen lds
    buffer_load_dwordx4 v5, s[8:11], s40 offen offset:1024 lds
    s_add_u32 m0, s39, 49152
    s_add_u32 s41, s53, 524288
    buffer_load_dwordx4 v2, s[12:15], s41 offen lds
    buffer_load_dwordx4 v3, s[12:15], s41 offen offset:1024 lds
    s_add_u32 m0, s39, 65536
    s_add_u32 s40, s52, 512
    buffer_load_dwordx4 v4, s[8:11], s40 offen lds
    buffer_load_dwordx4 v5, s[8:11], s40 offen offset:1024 lds
    s_add_u32 m0, s39, 81920
    s_add_u32 s41, s53, 1048576
    buffer_load_dwordx4 v2, s[12:15], s41 offen lds
    buffer_load_dwordx4 v3, s[12:15], s41 offen offset:1024 lds
    s_add_u32 m0, s39, 98304
    s_add_u32 s40, s52, 768
    buffer_load_dwordx4 v4, s[8:11], s40 offen lds
    buffer_load_dwordx4 v5, s[8:11], s40 offen offset:1024 lds
    s_add_u32 m0, s39, 114688
    s_add_u32 s41, s53, 1572864
    buffer_load_dwordx4 v2, s[12:15], s41 offen lds
    buffer_load_dwordx4 v3, s[12:15], s41 offen offset:1024 lds
    s_bfe_u32 s40, s2, 0x10002
    s_lshl_b32 s40, s40, 8
    s_lshl_b32 s41, s3, 3
    s_add_u32 s40, s40, s41
    s_add_u32 s40, s40, s34
    s_mul_i32 s40, s40, 3584
    v_min_u32 v252, 27, v1
    v_lshlrev_b32 v252, 7, v252
    buffer_load_dword v23, v252, s[8:11], s40 offen
    v_and_b32 v252, 31, v1
    s_lshl_b32 s40, s33, 6
    s_lshl_b32 s41, s36, 5
    s_add_u32 s55, s40, s41
    v_add_u32 v253, s55, v252
    v_lshlrev_b32 v24, 1, v253
    s_lshl_b32 s41, s32, 7
    s_lshl_b32 s42, s35, 6
    s_add_u32 s41, s41, s42
    s_lshl_b32 s42, s37, 5
    s_add_u32 s54, s41, s42
    v_lshrrev_b32 v254, 5, v1
    v_lshlrev_b32 v254, 4, v254
    v_lshl_add_u32 v21, v253, 10, v254
    s_lshl_b32 s55, s55, 10
    s_lshl_b32 s41, s54, 5
    s_add_u32 s55, s55, s41
    v_lshlrev_b32 v25, 4, v1
    v_lshrrev_b32 v252, 5, v1
    v_lshlrev_b32 v252, 3, v252
    v_bfe_u32 v254, v1, 2, 2
    v_add_u32 v252, v252, v254
    v_lshlrev_b32 v252, 7, v252
    v_bfe_u32 v253, v1, 4, 1
    v_lshlrev_b32 v253, 5, v253
    v_and_b32 v254, 3, v1
    v_lshl_add_u32 v253, v254, 3, v253
    s_lshl_b32 s38, s36, 6
    v_add_u32 v253, s38, v253
    v_bfe_u32 v254, v1, 3, 1
    v_lshlrev_b32 v254, 6, v254
    v_xor_b32 v253, v253, v254
    v_add_u32 v6, v252, v253
    s_lshl_b32 s38, s37, 13
    v_add_u32 v6, s38, v6
    v_and_b32 v252, 19, v1
    v_bfe_u32 v253, v1, 2, 1
    v_lshl_add_u32 v252, v253, 3, v252
    v_bfe_u32 v253, v1, 3, 1
    v_lshl_add_u32 v252, v253, 2, v252
    s_lshl_b32 s42, s35, 5
    v_add_u32 v252, s42, v252
    v_and_b32 v253, 15, v252
    v_lshrrev_b32 v254, 5, v1
    v_xor_b32 v253, v253, v254
    s_lshl_b32 s42, s37, 3
    v_xor_b32 v253, s42, v253
    v_lshlrev_b32 v253, 4, v253
    v_lshl_add_u32 v252, v252, 8, v253
    v_xor_b32 v7, 0, v252
    v_xor_b32 v8, 32, v252
    v_xor_b32 v9, 64, v252
    v_xor_b32 v10, 96, v252
    s_waitcnt vmcnt(13) lgkmcnt(0)
    s_barrier
    v_add_u32 v240, 0, v6
    v_add_u32 v241, 0, v7
    v_add_u32 v242, 0, v8
    v_add_u32 v243, 0, v9
    v_add_u32 v244, 0, v10
    ds_read_b128 v[128:131], v241
    ds_read_b64_tr_b16 v[132:133], v240 offset:16384
    ds_read_b64_tr_b16 v[134:135], v240 offset:16896
    ds_read_b128 v[136:139], v242
    ds_read_b64_tr_b16 v[140:141], v240 offset:18432
    ds_read_b64_tr_b16 v[142:143], v240 offset:18944
    ds_read_b128 v[144:147], v243
    ds_read_b64_tr_b16 v[148:149], v240 offset:20480
    ds_read_b64_tr_b16 v[150:151], v240 offset:20992
    ds_read_b128 v[152:155], v244
    ds_read_b64_tr_b16 v[156:157], v240 offset:22528
    ds_read_b64_tr_b16 v[158:159], v240 offset:23040
    s_add_u32 m0, s39, 131072
    s_add_u32 s40, s52, 1024
    buffer_load_dwordx4 v4, s[8:11], s40 offen lds
    buffer_load_dwordx4 v5, s[8:11], s40 offen offset:1024 lds
    s_add_u32 m0, s39, 147456
    s_add_u32 s41, s53, 2097152
    buffer_load_dwordx4 v2, s[12:15], s41 offen lds
    buffer_load_dwordx4 v3, s[12:15], s41 offen offset:1024 lds
    s_waitcnt vmcnt(13) lgkmcnt(0)
    s_barrier
    v_add_u32 v240, 32768, v6
    v_add_u32 v241, 32768, v7
    v_add_u32 v242, 32768, v8
    v_add_u32 v243, 32768, v9
    v_add_u32 v244, 32768, v10
    v_mfma_f32_32x32x16_bf16 v[64:79], v[128:131], v[132:135], 0
    ds_read_b128 v[160:163], v241
    ds_read_b64_tr_b16 v[164:165], v240 offset:16384
    ds_read_b64_tr_b16 v[166:167], v240 offset:16896
    ds_read_b128 v[168:171], v242
    ds_read_b64_tr_b16 v[172:173], v240 offset:18432
    ds_read_b64_tr_b16 v[174:175], v240 offset:18944
    v_mfma_f32_32x32x16_bf16 v[64:79], v[136:139], v[140:143], v[64:79]
    ds_read_b128 v[176:179], v243
    ds_read_b64_tr_b16 v[180:181], v240 offset:20480
    ds_read_b64_tr_b16 v[182:183], v240 offset:20992
    ds_read_b128 v[184:187], v244
    ds_read_b64_tr_b16 v[188:189], v240 offset:22528
    v_mfma_f32_32x32x16_bf16 v[64:79], v[144:147], v[148:151], v[64:79]
    ds_read_b64_tr_b16 v[190:191], v240 offset:23040
    s_add_u32 m0, s39, 0
    s_add_u32 s40, s52, 1280
    buffer_load_dwordx4 v4, s[8:11], s40 offen lds
    buffer_load_dwordx4 v5, s[8:11], s40 offen offset:1024 lds
    s_add_u32 m0, s39, 16384
    v_mfma_f32_32x32x16_bf16 v[64:79], v[152:155], v[156:159], v[64:79]
    s_add_u32 s41, s53, 2621440
    buffer_load_dwordx4 v2, s[12:15], s41 offen lds
    buffer_load_dwordx4 v3, s[12:15], s41 offen offset:1024 lds
    buffer_load_ushort v20, v24, s[16:19], 0 offen
    buffer_load_dwordx4 v[16:19], v21, s[20:23], s54 offen
    s_waitcnt vmcnt(15) lgkmcnt(0)
    s_barrier
    v_add_u32 v240, 65536, v6
    v_add_u32 v241, 65536, v7
    v_add_u32 v242, 65536, v8
    v_add_u32 v243, 65536, v9
    v_add_u32 v244, 65536, v10
    v_mfma_f32_32x32x16_bf16 v[64:79], v[160:163], v[164:167], v[64:79]
    ds_read_b128 v[128:131], v241
    ds_read_b64_tr_b16 v[132:133], v240 offset:16384
    ds_read_b64_tr_b16 v[134:135], v240 offset:16896
    ds_read_b128 v[136:139], v242
    ds_read_b64_tr_b16 v[140:141], v240 offset:18432
    v_mfma_f32_32x32x16_bf16 v[64:79], v[168:171], v[172:175], v[64:79]
    ds_read_b64_tr_b16 v[142:143], v240 offset:18944
    ds_read_b128 v[144:147], v243
    ds_read_b64_tr_b16 v[148:149], v240 offset:20480
    ds_read_b64_tr_b16 v[150:151], v240 offset:20992
    ds_read_b128 v[152:155], v244
    v_mfma_f32_32x32x16_bf16 v[64:79], v[176:179], v[180:183], v[64:79]
    ds_read_b64_tr_b16 v[156:157], v240 offset:22528
    ds_read_b64_tr_b16 v[158:159], v240 offset:23040
    s_add_u32 m0, s39, 32768
    s_add_u32 s40, s52, 1536
    buffer_load_dwordx4 v4, s[8:11], s40 offen lds
    v_mfma_f32_32x32x16_bf16 v[64:79], v[184:187], v[188:191], v[64:79]
    buffer_load_dwordx4 v5, s[8:11], s40 offen offset:1024 lds
    s_add_u32 m0, s39, 49152
    s_add_u32 s41, s53, 3145728
    buffer_load_dwordx4 v2, s[12:15], s41 offen lds
    buffer_load_dwordx4 v3, s[12:15], s41 offen offset:1024 lds
    s_waitcnt vmcnt(15) lgkmcnt(0)
    s_barrier
    v_add_u32 v240, 98304, v6
    v_add_u32 v241, 98304, v7
    v_add_u32 v242, 98304, v8
    v_add_u32 v243, 98304, v9
    v_add_u32 v244, 98304, v10
    v_mfma_f32_32x32x16_bf16 v[64:79], v[128:131], v[132:135], v[64:79]
    ds_read_b128 v[160:163], v241
    ds_read_b64_tr_b16 v[164:165], v240 offset:16384
    ds_read_b64_tr_b16 v[166:167], v240 offset:16896
    ds_read_b128 v[168:171], v242
    ds_read_b64_tr_b16 v[172:173], v240 offset:18432
    v_mfma_f32_32x32x16_bf16 v[64:79], v[136:139], v[140:143], v[64:79]
    ds_read_b64_tr_b16 v[174:175], v240 offset:18944
    ds_read_b128 v[176:179], v243
    ds_read_b64_tr_b16 v[180:181], v240 offset:20480
    ds_read_b64_tr_b16 v[182:183], v240 offset:20992
    ds_read_b128 v[184:187], v244
    v_mfma_f32_32x32x16_bf16 v[64:79], v[144:147], v[148:151], v[64:79]
    ds_read_b64_tr_b16 v[188:189], v240 offset:22528
    ds_read_b64_tr_b16 v[190:191], v240 offset:23040
    s_add_u32 m0, s39, 65536
    s_add_u32 s40, s52, 1792
    buffer_load_dwordx4 v4, s[8:11], s40 offen lds
    v_mfma_f32_32x32x16_bf16 v[64:79], v[152:155], v[156:159], v[64:79]
    buffer_load_dwordx4 v5, s[8:11], s40 offen offset:1024 lds
    s_add_u32 m0, s39, 81920
    s_add_u32 s41, s53, 3670016
    buffer_load_dwordx4 v2, s[12:15], s41 offen lds
    buffer_load_dwordx4 v3, s[12:15], s41 offen offset:1024 lds
    s_waitcnt vmcnt(14) lgkmcnt(0)
    s_barrier
    v_add_u32 v240, 131072, v6
    v_add_u32 v241, 131072, v7
    v_add_u32 v242, 131072, v8
    v_add_u32 v243, 131072, v9
    v_add_u32 v244, 131072, v10
    v_mfma_f32_32x32x16_bf16 v[64:79], v[160:163], v[164:167], v[64:79]
    ds_read_b128 v[128:131], v241
    ds_read_b64_tr_b16 v[132:133], v240 offset:16384
    ds_read_b64_tr_b16 v[134:135], v240 offset:16896
    ds_read_b128 v[136:139], v242
    ds_read_b64_tr_b16 v[140:141], v240 offset:18432
    ds_read_b64_tr_b16 v[142:143], v240 offset:18944
    v_mfma_f32_32x32x16_bf16 v[64:79], v[168:171], v[172:175], v[64:79]
    ds_read_b128 v[144:147], v243
    ds_read_b64_tr_b16 v[148:149], v240 offset:20480
    ds_read_b64_tr_b16 v[150:151], v240 offset:20992
    ds_read_b128 v[152:155], v244
    ds_read_b64_tr_b16 v[156:157], v240 offset:22528
    v_mfma_f32_32x32x16_bf16 v[64:79], v[176:179], v[180:183], v[64:79]
    ds_read_b64_tr_b16 v[158:159], v240 offset:23040
    s_add_u32 m0, s39, 98304
    s_add_u32 s40, s52, 2048
    buffer_load_dwordx4 v4, s[8:11], s40 offen lds
    buffer_load_dwordx4 v5, s[8:11], s40 offen offset:1024 lds
    s_add_u32 m0, s39, 114688
    v_mfma_f32_32x32x16_bf16 v[64:79], v[184:187], v[188:191], v[64:79]
    s_add_u32 s41, s53, 4194304
    buffer_load_dwordx4 v2, s[12:15], s41 offen lds
    buffer_load_dwordx4 v3, s[12:15], s41 offen offset:1024 lds
    s_add_u32 s42, s55, 0
    buffer_load_dwordx4 v[96:99], v25, s[28:31], s42 offen
    s_waitcnt vmcnt(15) lgkmcnt(0)
    s_barrier
    v_add_u32 v240, 0, v6
    v_add_u32 v241, 0, v7
    v_add_u32 v242, 0, v8
    v_add_u32 v243, 0, v9
    v_add_u32 v244, 0, v10
    v_mfma_f32_32x32x16_bf16 v[64:79], v[128:131], v[132:135], v[64:79]
    ds_read_b128 v[160:163], v241
    ds_read_b64_tr_b16 v[164:165], v240 offset:16384
    ds_read_b64_tr_b16 v[166:167], v240 offset:16896
    ds_read_b128 v[168:171], v242
    ds_read_b64_tr_b16 v[172:173], v240 offset:18432
    ds_read_b64_tr_b16 v[174:175], v240 offset:18944
    v_mfma_f32_32x32x16_bf16 v[64:79], v[136:139], v[140:143], v[64:79]
    ds_read_b128 v[176:179], v243
    ds_read_b64_tr_b16 v[180:181], v240 offset:20480
    ds_read_b64_tr_b16 v[182:183], v240 offset:20992
    ds_read_b128 v[184:187], v244
    ds_read_b64_tr_b16 v[188:189], v240 offset:22528
    v_mfma_f32_32x32x16_bf16 v[64:79], v[144:147], v[148:151], v[64:79]
    ds_read_b64_tr_b16 v[190:191], v240 offset:23040
    s_add_u32 m0, s39, 131072
    s_add_u32 s40, s52, 2304
    buffer_load_dwordx4 v4, s[8:11], s40 offen lds
    buffer_load_dwordx4 v5, s[8:11], s40 offen offset:1024 lds
    s_add_u32 m0, s39, 147456
    v_mfma_f32_32x32x16_bf16 v[64:79], v[152:155], v[156:159], v[64:79]
    s_add_u32 s41, s53, 4718592
    buffer_load_dwordx4 v2, s[12:15], s41 offen lds
    buffer_load_dwordx4 v3, s[12:15], s41 offen offset:1024 lds
    s_add_u32 s42, s55, 2097152
    buffer_load_dwordx4 v[100:103], v25, s[28:31], s42 offen
    s_waitcnt vmcnt(14) lgkmcnt(0)
    s_barrier
    v_add_u32 v240, 32768, v6
    v_add_u32 v241, 32768, v7
    v_add_u32 v242, 32768, v8
    v_add_u32 v243, 32768, v9
    v_add_u32 v244, 32768, v10
    v_mfma_f32_32x32x16_bf16 v[64:79], v[160:163], v[164:167], v[64:79]
    ds_read_b128 v[128:131], v241
    ds_read_b64_tr_b16 v[132:133], v240 offset:16384
    ds_read_b64_tr_b16 v[134:135], v240 offset:16896
    ds_read_b128 v[136:139], v242
    ds_read_b64_tr_b16 v[140:141], v240 offset:18432
    ds_read_b64_tr_b16 v[142:143], v240 offset:18944
    v_mfma_f32_32x32x16_bf16 v[64:79], v[168:171], v[172:175], v[64:79]
    ds_read_b128 v[144:147], v243
    ds_read_b64_tr_b16 v[148:149], v240 offset:20480
    ds_read_b64_tr_b16 v[150:151], v240 offset:20992
    ds_read_b128 v[152:155], v244
    ds_read_b64_tr_b16 v[156:157], v240 offset:22528
    v_mfma_f32_32x32x16_bf16 v[64:79], v[176:179], v[180:183], v[64:79]
    ds_read_b64_tr_b16 v[158:159], v240 offset:23040
    s_add_u32 m0, s39, 0
    s_add_u32 s40, s52, 2560
    buffer_load_dwordx4 v4, s[8:11], s40 offen lds
    buffer_load_dwordx4 v5, s[8:11], s40 offen offset:1024 lds
    s_add_u32 m0, s39, 16384
    v_mfma_f32_32x32x16_bf16 v[64:79], v[184:187], v[188:191], v[64:79]
    s_add_u32 s41, s53, 5242880
    buffer_load_dwordx4 v2, s[12:15], s41 offen lds
    buffer_load_dwordx4 v3, s[12:15], s41 offen offset:1024 lds
    s_add_u32 s42, s55, 4194304
    buffer_load_dwordx4 v[104:107], v25, s[28:31], s42 offen
    s_waitcnt vmcnt(15) lgkmcnt(0)
    s_barrier
    v_add_u32 v240, 65536, v6
    v_add_u32 v241, 65536, v7
    v_add_u32 v242, 65536, v8
    v_add_u32 v243, 65536, v9
    v_add_u32 v244, 65536, v10
    v_mfma_f32_32x32x16_bf16 v[64:79], v[128:131], v[132:135], v[64:79]
    ds_read_b128 v[160:163], v241
    ds_read_b64_tr_b16 v[164:165], v240 offset:16384
    ds_read_b64_tr_b16 v[166:167], v240 offset:16896
    ds_read_b128 v[168:171], v242
    ds_read_b64_tr_b16 v[172:173], v240 offset:18432
    ds_read_b64_tr_b16 v[174:175], v240 offset:18944
    v_mfma_f32_32x32x16_bf16 v[64:79], v[136:139], v[140:143], v[64:79]
    ds_read_b128 v[176:179], v243
    ds_read_b64_tr_b16 v[180:181], v240 offset:20480
    ds_read_b64_tr_b16 v[182:183], v240 offset:20992
    ds_read_b128 v[184:187], v244
    ds_read_b64_tr_b16 v[188:189], v240 offset:22528
    v_mfma_f32_32x32x16_bf16 v[64:79], v[144:147], v[148:151], v[64:79]
    ds_read_b64_tr_b16 v[190:191], v240 offset:23040
    s_add_u32 m0, s39, 32768
    s_add_u32 s40, s52, 2816
    buffer_load_dwordx4 v4, s[8:11], s40 offen lds
    buffer_load_dwordx4 v5, s[8:11], s40 offen offset:1024 lds
    s_add_u32 m0, s39, 49152
    v_mfma_f32_32x32x16_bf16 v[64:79], v[152:155], v[156:159], v[64:79]
    s_add_u32 s41, s53, 5767168
    buffer_load_dwordx4 v2, s[12:15], s41 offen lds
    buffer_load_dwordx4 v3, s[12:15], s41 offen offset:1024 lds
    s_add_u32 s42, s55, 6291456
    buffer_load_dwordx4 v[108:111], v25, s[28:31], s42 offen
    s_waitcnt vmcnt(16) lgkmcnt(0)
    s_barrier
    v_add_u32 v240, 98304, v6
    v_add_u32 v241, 98304, v7
    v_add_u32 v242, 98304, v8
    v_add_u32 v243, 98304, v9
    v_add_u32 v244, 98304, v10
    v_mfma_f32_32x32x16_bf16 v[64:79], v[160:163], v[164:167], v[64:79]
    ds_read_b128 v[128:131], v241
    ds_read_b64_tr_b16 v[132:133], v240 offset:16384
    ds_read_b64_tr_b16 v[134:135], v240 offset:16896
    ds_read_b128 v[136:139], v242
    ds_read_b64_tr_b16 v[140:141], v240 offset:18432
    ds_read_b64_tr_b16 v[142:143], v240 offset:18944
    v_mfma_f32_32x32x16_bf16 v[64:79], v[168:171], v[172:175], v[64:79]
    ds_read_b128 v[144:147], v243
    ds_read_b64_tr_b16 v[148:149], v240 offset:20480
    ds_read_b64_tr_b16 v[150:151], v240 offset:20992
    ds_read_b128 v[152:155], v244
    ds_read_b64_tr_b16 v[156:157], v240 offset:22528
    v_mfma_f32_32x32x16_bf16 v[64:79], v[176:179], v[180:183], v[64:79]
    ds_read_b64_tr_b16 v[158:159], v240 offset:23040
    s_add_u32 m0, s39, 65536
    s_add_u32 s40, s52, 3072
    buffer_load_dwordx4 v4, s[8:11], s40 offen lds
    buffer_load_dwordx4 v5, s[8:11], s40 offen offset:1024 lds
    s_add_u32 m0, s39, 81920
    v_mfma_f32_32x32x16_bf16 v[64:79], v[184:187], v[188:191], v[64:79]
    s_add_u32 s41, s53, 6291456
    buffer_load_dwordx4 v2, s[12:15], s41 offen lds
    buffer_load_dwordx4 v3, s[12:15], s41 offen offset:1024 lds
    s_add_u32 s42, s55, 8388608
    buffer_load_dwordx4 v[112:115], v25, s[28:31], s42 offen
    s_waitcnt vmcnt(16) lgkmcnt(0)
    s_barrier
    v_add_u32 v240, 131072, v6
    v_add_u32 v241, 131072, v7
    v_add_u32 v242, 131072, v8
    v_add_u32 v243, 131072, v9
    v_add_u32 v244, 131072, v10
    v_mfma_f32_32x32x16_bf16 v[64:79], v[128:131], v[132:135], v[64:79]
    ds_read_b128 v[160:163], v241
    ds_read_b64_tr_b16 v[164:165], v240 offset:16384
    ds_read_b64_tr_b16 v[166:167], v240 offset:16896
    ds_read_b128 v[168:171], v242
    ds_read_b64_tr_b16 v[172:173], v240 offset:18432
    ds_read_b64_tr_b16 v[174:175], v240 offset:18944
    v_mfma_f32_32x32x16_bf16 v[64:79], v[136:139], v[140:143], v[64:79]
    ds_read_b128 v[176:179], v243
    ds_read_b64_tr_b16 v[180:181], v240 offset:20480
    ds_read_b64_tr_b16 v[182:183], v240 offset:20992
    ds_read_b128 v[184:187], v244
    ds_read_b64_tr_b16 v[188:189], v240 offset:22528
    v_mfma_f32_32x32x16_bf16 v[64:79], v[144:147], v[148:151], v[64:79]
    ds_read_b64_tr_b16 v[190:191], v240 offset:23040
    s_add_u32 m0, s39, 98304
    s_add_u32 s40, s52, 3328
    buffer_load_dwordx4 v4, s[8:11], s40 offen lds
    buffer_load_dwordx4 v5, s[8:11], s40 offen offset:1024 lds
    s_add_u32 m0, s39, 114688
    v_mfma_f32_32x32x16_bf16 v[64:79], v[152:155], v[156:159], v[64:79]
    s_add_u32 s41, s53, 6815744
    buffer_load_dwordx4 v2, s[12:15], s41 offen lds
    buffer_load_dwordx4 v3, s[12:15], s41 offen offset:1024 lds
    s_add_u32 s42, s55, 10485760
    buffer_load_dwordx4 v[116:119], v25, s[28:31], s42 offen
    s_waitcnt vmcnt(16) lgkmcnt(0)
    s_barrier
    v_add_u32 v240, 0, v6
    v_add_u32 v241, 0, v7
    v_add_u32 v242, 0, v8
    v_add_u32 v243, 0, v9
    v_add_u32 v244, 0, v10
    v_mfma_f32_32x32x16_bf16 v[64:79], v[160:163], v[164:167], v[64:79]
    ds_read_b128 v[128:131], v241
    ds_read_b64_tr_b16 v[132:133], v240 offset:16384
    ds_read_b64_tr_b16 v[134:135], v240 offset:16896
    ds_read_b128 v[136:139], v242
    v_mfma_f32_32x32x16_bf16 v[64:79], v[168:171], v[172:175], v[64:79]
    ds_read_b64_tr_b16 v[140:141], v240 offset:18432
    ds_read_b64_tr_b16 v[142:143], v240 offset:18944
    ds_read_b128 v[144:147], v243
    v_mfma_f32_32x32x16_bf16 v[64:79], v[176:179], v[180:183], v[64:79]
    ds_read_b64_tr_b16 v[148:149], v240 offset:20480
    ds_read_b64_tr_b16 v[150:151], v240 offset:20992
    ds_read_b128 v[152:155], v244
    ds_read_b64_tr_b16 v[156:157], v240 offset:22528
    v_mfma_f32_32x32x16_bf16 v[64:79], v[184:187], v[188:191], v[64:79]
    ds_read_b64_tr_b16 v[158:159], v240 offset:23040
    s_add_u32 s42, s55, 12582912
    buffer_load_dwordx4 v[120:123], v25, s[28:31], s42 offen
    s_waitcnt vmcnt(12) lgkmcnt(0)
    s_barrier
    v_add_u32 v240, 32768, v6
    v_add_u32 v241, 32768, v7
    v_add_u32 v242, 32768, v8
    v_add_u32 v243, 32768, v9
    v_add_u32 v244, 32768, v10
    v_mfma_f32_32x32x16_bf16 v[64:79], v[128:131], v[132:135], v[64:79]
    ds_read_b128 v[160:163], v241
    ds_read_b64_tr_b16 v[164:165], v240 offset:16384
    ds_read_b64_tr_b16 v[166:167], v240 offset:16896
    ds_read_b128 v[168:171], v242
    v_mfma_f32_32x32x16_bf16 v[64:79], v[136:139], v[140:143], v[64:79]
    ds_read_b64_tr_b16 v[172:173], v240 offset:18432
    ds_read_b64_tr_b16 v[174:175], v240 offset:18944
    ds_read_b128 v[176:179], v243
    v_mfma_f32_32x32x16_bf16 v[64:79], v[144:147], v[148:151], v[64:79]
    ds_read_b64_tr_b16 v[180:181], v240 offset:20480
    ds_read_b64_tr_b16 v[182:183], v240 offset:20992
    ds_read_b128 v[184:187], v244
    ds_read_b64_tr_b16 v[188:189], v240 offset:22528
    v_mfma_f32_32x32x16_bf16 v[64:79], v[152:155], v[156:159], v[64:79]
    ds_read_b64_tr_b16 v[190:191], v240 offset:23040
    s_add_u32 s42, s55, 14680064
    buffer_load_dwordx4 v[124:127], v25, s[28:31], s42 offen
    s_waitcnt vmcnt(8) lgkmcnt(0)
    s_barrier
    v_add_u32 v240, 65536, v6
    v_add_u32 v241, 65536, v7
    v_add_u32 v242, 65536, v8
    v_add_u32 v243, 65536, v9
    v_add_u32 v244, 65536, v10
    v_mfma_f32_32x32x16_bf16 v[64:79], v[160:163], v[164:167], v[64:79]
    ds_read_b128 v[128:131], v241
    ds_read_b64_tr_b16 v[132:133], v240 offset:16384
    ds_read_b64_tr_b16 v[134:135], v240 offset:16896
    v_mfma_f32_32x32x16_bf16 v[64:79], v[168:171], v[172:175], v[64:79]
    ds_read_b128 v[136:139], v242
    ds_read_b64_tr_b16 v[140:141], v240 offset:18432
    ds_read_b64_tr_b16 v[142:143], v240 offset:18944
    v_mfma_f32_32x32x16_bf16 v[64:79], v[176:179], v[180:183], v[64:79]
    ds_read_b128 v[144:147], v243
    ds_read_b64_tr_b16 v[148:149], v240 offset:20480
    ds_read_b64_tr_b16 v[150:151], v240 offset:20992
    v_mfma_f32_32x32x16_bf16 v[64:79], v[184:187], v[188:191], v[64:79]
    ds_read_b128 v[152:155], v244
    ds_read_b64_tr_b16 v[156:157], v240 offset:22528
    ds_read_b64_tr_b16 v[158:159], v240 offset:23040
    s_waitcnt vmcnt(3) lgkmcnt(0)
    s_barrier
    v_add_u32 v240, 98304, v6
    v_add_u32 v241, 98304, v7
    v_add_u32 v242, 98304, v8
    v_add_u32 v243, 98304, v9
    v_add_u32 v244, 98304, v10
    v_mfma_f32_32x32x16_bf16 v[64:79], v[128:131], v[132:135], v[64:79]
    ds_read_b128 v[160:163], v241
    ds_read_b64_tr_b16 v[164:165], v240 offset:16384
    ds_read_b64_tr_b16 v[166:167], v240 offset:16896
    v_mfma_f32_32x32x16_bf16 v[64:79], v[136:139], v[140:143], v[64:79]
    ds_read_b128 v[168:171], v242
    ds_read_b64_tr_b16 v[172:173], v240 offset:18432
    ds_read_b64_tr_b16 v[174:175], v240 offset:18944
    v_mfma_f32_32x32x16_bf16 v[64:79], v[144:147], v[148:151], v[64:79]
    ds_read_b128 v[176:179], v243
    ds_read_b64_tr_b16 v[180:181], v240 offset:20480
    ds_read_b64_tr_b16 v[182:183], v240 offset:20992
    v_mfma_f32_32x32x16_bf16 v[64:79], v[152:155], v[156:159], v[64:79]
    ds_read_b128 v[184:187], v244
    ds_read_b64_tr_b16 v[188:189], v240 offset:22528
    ds_read_b64_tr_b16 v[190:191], v240 offset:23040
    s_waitcnt lgkmcnt(9)
    v_mfma_f32_32x32x16_bf16 v[64:79], v[160:163], v[164:167], v[64:79]
    s_waitcnt lgkmcnt(6)
    v_mfma_f32_32x32x16_bf16 v[64:79], v[168:171], v[172:175], v[64:79]
    s_waitcnt lgkmcnt(3)
    v_mfma_f32_32x32x16_bf16 v[64:79], v[176:179], v[180:183], v[64:79]
    s_waitcnt lgkmcnt(0)
    v_mfma_f32_32x32x16_bf16 v[64:79], v[184:187], v[188:191], v[64:79]
    s_lshl_b32 s38, s34, 12
    v_lshlrev_b32 v252, 4, v1
    v_add_u32 v253, s38, v252
    v_add_u32 v253, 131072, v253
    s_nop 7
    ds_write_b128 v253, v[64:67] offset:0
    ds_write_b128 v253, v[68:71] offset:1024
    ds_write_b128 v253, v[72:75] offset:2048
    ds_write_b128 v253, v[76:79] offset:3072
    s_and_b32 s38, s34, 3
    s_lshl_b32 s38, s38, 12
    s_lshl_b32 s40, s37, 11
    s_add_u32 s38, s38, s40
    v_add_u32 v253, s38, v252
    v_add_u32 v253, 131072, v253
    s_waitcnt lgkmcnt(0)
    s_barrier
    ds_read_b128 v[64:67], v253
    ds_read_b128 v[68:71], v253 offset:1024
    ds_read_b128 v[72:75], v253 offset:16384
    ds_read_b128 v[76:79], v253 offset:17408
    s_waitcnt lgkmcnt(1)
    v_add_f32 v64, v64, v72
    v_add_f32 v65, v65, v73
    v_add_f32 v66, v66, v74
    v_add_f32 v67, v67, v75
    s_waitcnt lgkmcnt(0)
    v_add_f32 v68, v68, v76
    v_add_f32 v69, v69, v77
    v_add_f32 v70, v70, v78
    v_add_f32 v71, v71, v79
    s_mov_b32 s40, 0xffff0000
    s_mov_b32 s41, 0xbfb8aa3b
    v_lshlrev_b32 v20, 16, v20
    v_add_f32 v64, v64, v20
    v_add_f32 v65, v65, v20
    v_add_f32 v66, v66, v20
    v_add_f32 v67, v67, v20
    v_add_f32 v68, v68, v20
    v_add_f32 v69, v69, v20
    v_add_f32 v70, v70, v20
    v_add_f32 v71, v71, v20
    v_mul_f32 v72, s41, v64
    v_mul_f32 v73, s41, v65
    v_mul_f32 v74, s41, v66
    v_mul_f32 v75, s41, v67
    v_mul_f32 v76, s41, v68
    v_mul_f32 v77, s41, v69
    v_mul_f32 v78, s41, v70
    v_mul_f32 v79, s41, v71
    v_exp_f32 v72, v72
    v_exp_f32 v73, v73
    v_exp_f32 v74, v74
    v_exp_f32 v75, v75
    v_exp_f32 v76, v76
    v_exp_f32 v77, v77
    v_exp_f32 v78, v78
    v_exp_f32 v79, v79
    v_add_f32 v72, 1.0, v72
    v_add_f32 v73, 1.0, v73
    v_add_f32 v74, 1.0, v74
    v_add_f32 v75, 1.0, v75
    v_add_f32 v76, 1.0, v76
    v_add_f32 v77, 1.0, v77
    v_add_f32 v78, 1.0, v78
    v_add_f32 v79, 1.0, v79
    v_rcp_f32 v72, v72
    v_rcp_f32 v73, v73
    v_rcp_f32 v74, v74
    v_rcp_f32 v75, v75
    v_rcp_f32 v76, v76
    v_rcp_f32 v77, v77
    v_rcp_f32 v78, v78
    v_rcp_f32 v79, v79
    v_mul_f32 v64, v64, v72
    v_mul_f32 v65, v65, v73
    v_mul_f32 v66, v66, v74
    v_mul_f32 v67, v67, v75
    v_mul_f32 v68, v68, v76
    v_mul_f32 v69, v69, v77
    v_mul_f32 v70, v70, v78
    v_mul_f32 v71, v71, v79
    v_lshlrev_b32 v72, 16, v96
    v_and_b32 v73, s40, v96
    v_lshlrev_b32 v74, 16, v97
    v_and_b32 v75, s40, v97
    v_lshlrev_b32 v76, 16, v98
    v_and_b32 v77, s40, v98
    v_lshlrev_b32 v78, 16, v99
    v_and_b32 v79, s40, v99
    v_lshlrev_b32 v80, 16, v100
    v_and_b32 v81, s40, v100
    v_lshlrev_b32 v82, 16, v101
    v_and_b32 v83, s40, v101
    v_lshlrev_b32 v84, 16, v102
    v_and_b32 v85, s40, v102
    v_lshlrev_b32 v86, 16, v103
    v_and_b32 v87, s40, v103
    v_add_f32 v72, v72, v80
    v_add_f32 v73, v73, v81
    v_add_f32 v74, v74, v82
    v_add_f32 v75, v75, v83
    v_add_f32 v76, v76, v84
    v_add_f32 v77, v77, v85
    v_add_f32 v78, v78, v86
    v_add_f32 v79, v79, v87
    v_lshlrev_b32 v80, 16, v104
    v_and_b32 v81, s40, v104
    v_lshlrev_b32 v82, 16, v105
    v_and_b32 v83, s40, v105
    v_lshlrev_b32 v84, 16, v106
    v_and_b32 v85, s40, v106
    v_lshlrev_b32 v86, 16, v107
    v_and_b32 v87, s40, v107
    v_add_f32 v72, v72, v80
    v_add_f32 v73, v73, v81
    v_add_f32 v74, v74, v82
    v_add_f32 v75, v75, v83
    v_add_f32 v76, v76, v84
    v_add_f32 v77, v77, v85
    v_add_f32 v78, v78, v86
    v_add_f32 v79, v79, v87
    v_lshlrev_b32 v80, 16, v108
    v_and_b32 v81, s40, v108
    v_lshlrev_b32 v82, 16, v109
    v_and_b32 v83, s40, v109
    v_lshlrev_b32 v84, 16, v110
    v_and_b32 v85, s40, v110
    v_lshlrev_b32 v86, 16, v111
    v_and_b32 v87, s40, v111
    v_add_f32 v72, v72, v80
    v_add_f32 v73, v73, v81
    v_add_f32 v74, v74, v82
    v_add_f32 v75, v75, v83
    v_add_f32 v76, v76, v84
    v_add_f32 v77, v77, v85
    v_add_f32 v78, v78, v86
    v_add_f32 v79, v79, v87
    v_lshlrev_b32 v80, 16, v112
    v_and_b32 v81, s40, v112
    v_lshlrev_b32 v82, 16, v113
    v_and_b32 v83, s40, v113
    v_lshlrev_b32 v84, 16, v114
    v_and_b32 v85, s40, v114
    v_lshlrev_b32 v86, 16, v115
    v_and_b32 v87, s40, v115
    v_add_f32 v72, v72, v80
    v_add_f32 v73, v73, v81
    v_add_f32 v74, v74, v82
    v_add_f32 v75, v75, v83
    v_add_f32 v76, v76, v84
    v_add_f32 v77, v77, v85
    v_add_f32 v78, v78, v86
    v_add_f32 v79, v79, v87
    s_waitcnt vmcnt(2)
    v_lshlrev_b32 v80, 16, v116
    v_and_b32 v81, s40, v116
    v_lshlrev_b32 v82, 16, v117
    v_and_b32 v83, s40, v117
    v_lshlrev_b32 v84, 16, v118
    v_and_b32 v85, s40, v118
    v_lshlrev_b32 v86, 16, v119
    v_and_b32 v87, s40, v119
    v_add_f32 v72, v72, v80
    v_add_f32 v73, v73, v81
    v_add_f32 v74, v74, v82
    v_add_f32 v75, v75, v83
    v_add_f32 v76, v76, v84
    v_add_f32 v77, v77, v85
    v_add_f32 v78, v78, v86
    v_add_f32 v79, v79, v87
    s_waitcnt vmcnt(1)
    v_lshlrev_b32 v80, 16, v120
    v_and_b32 v81, s40, v120
    v_lshlrev_b32 v82, 16, v121
    v_and_b32 v83, s40, v121
    v_lshlrev_b32 v84, 16, v122
    v_and_b32 v85, s40, v122
    v_lshlrev_b32 v86, 16, v123
    v_and_b32 v87, s40, v123
    v_add_f32 v72, v72, v80
    v_add_f32 v73, v73, v81
    v_add_f32 v74, v74, v82
    v_add_f32 v75, v75, v83
    v_add_f32 v76, v76, v84
    v_add_f32 v77, v77, v85
    v_add_f32 v78, v78, v86
    v_add_f32 v79, v79, v87
    s_waitcnt vmcnt(0)
    v_lshlrev_b32 v80, 16, v124
    v_and_b32 v81, s40, v124
    v_lshlrev_b32 v82, 16, v125
    v_and_b32 v83, s40, v125
    v_lshlrev_b32 v84, 16, v126
    v_and_b32 v85, s40, v126
    v_lshlrev_b32 v86, 16, v127
    v_and_b32 v87, s40, v127
    v_add_f32 v72, v72, v80
    v_add_f32 v73, v73, v81
    v_add_f32 v74, v74, v82
    v_add_f32 v75, v75, v83
    v_add_f32 v76, v76, v84
    v_add_f32 v77, v77, v85
    v_add_f32 v78, v78, v86
    v_add_f32 v79, v79, v87
    v_lshlrev_b32 v80, 16, v16
    v_and_b32 v81, s40, v16
    v_lshlrev_b32 v82, 16, v17
    v_and_b32 v83, s40, v17
    v_lshlrev_b32 v84, 16, v18
    v_and_b32 v85, s40, v18
    v_lshlrev_b32 v86, 16, v19
    v_and_b32 v87, s40, v19
    v_fma_f32 v80, v72, v64, v80
    v_fma_f32 v81, v73, v65, v81
    v_fma_f32 v82, v74, v66, v82
    v_fma_f32 v83, v75, v67, v83
    v_fma_f32 v84, v76, v68, v84
    v_fma_f32 v85, v77, v69, v85
    v_fma_f32 v86, v78, v70, v86
    v_fma_f32 v87, v79, v71, v87
    v_cvt_pk_bf16_f32 v88, v80, v81
    v_cvt_pk_bf16_f32 v89, v82, v83
    v_cvt_pk_bf16_f32 v90, v84, v85
    v_cvt_pk_bf16_f32 v91, v86, v87
    buffer_store_dwordx4 v[88:91], v21, s[24:27], s54 offen
L_fin_done:
    s_endpgm

.section .rodata,"a"
.p2align 6
.amdhsa_kernel main_kernel
  .amdhsa_next_free_vgpr 256
  .amdhsa_next_free_sgpr 102
  .amdhsa_accum_offset 256
  .amdhsa_group_segment_fixed_size 0
  .amdhsa_kernarg_size 104
  .amdhsa_user_sgpr_count 2
  .amdhsa_user_sgpr_kernarg_segment_ptr 1
  .amdhsa_system_sgpr_workgroup_id_x 1
.end_amdhsa_kernel

.p2align 6
.amdhsa_kernel final_kernel
  .amdhsa_next_free_vgpr 256
  .amdhsa_next_free_sgpr 80
  .amdhsa_accum_offset 256
  .amdhsa_group_segment_fixed_size 0
  .amdhsa_kernarg_size 104
  .amdhsa_user_sgpr_count 2
  .amdhsa_user_sgpr_kernarg_segment_ptr 1
  .amdhsa_system_sgpr_workgroup_id_x 1
.end_amdhsa_kernel
```
